```python
import torch

def _softmax(x, axis=-1):
    return torch.softmax(x, dim=axis)
def _gelu(x):
    return torch.nn.functional.gelu(x, approximate="tanh")
def _silu(x):
    return torch.nn.functional.silu(x)
def _sigmoid(x):
    return torch.sigmoid(x)
def _layernorm(x, axis=-1, eps=1e-5):
    m = x.mean(dim=axis, keepdim=True)
    v = x.var(dim=axis, keepdim=True, unbiased=False)
    return (x - m) / torch.sqrt(v + eps)
def _scatter_add(tgt, idx, src, axis=0):
    return tgt.clone().index_add_(axis, idx, src)
def _segment_sum(src, seg, n):
    out = torch.zeros((n,) + src.shape[1:], dtype=src.dtype)
    return out.index_add_(0, seg, src)
def _pad(x, pw):
    flat = tuple(v for pair in reversed(pw) for v in pair)
    return torch.nn.functional.pad(x, flat)

kernel_name = 'interleave_layers__mha_block__glu_gated_reglu__prompt'

def setup_inputs():

    _w = (lambda a: (lambda t: t.to(torch.bfloat16) if t.is_floating_point() else t)(torch.as_tensor(a)))
    def _A_setup():
        B, S, D, H = 1, 2048, 640, 32
        return {
            "x": _w((lambda *s: torch.randn(*s, dtype=torch.bfloat16) * 0.05)(B, S, D)),
            "wqkv": _w((lambda *s: torch.randn(*s, dtype=torch.bfloat16) * 0.05)(D, 3 * D)),
            "wo": _w((lambda *s: torch.randn(*s, dtype=torch.bfloat16) * 0.05)(D, D)),
        }
    _A_in = _A_setup()

    def _B_setup():
        B, S, D, F = 1, 2048, 640, 1728
        return {
            "x": _w((lambda *s: torch.randn(*s, dtype=torch.bfloat16) * 0.05)(B, S, D)),
            "W_gate": _w((lambda *s: torch.randn(*s, dtype=torch.bfloat16) * 0.8)(D, F) * (2.0 / D) ** 0.5),
            "W_up": _w((lambda *s: torch.randn(*s, dtype=torch.bfloat16) * 0.8)(D, F) * (2.0 / D) ** 0.5),
            "W_down": _w((lambda *s: torch.randn(*s, dtype=torch.bfloat16) * 0.8)(F, D) * (1.0 / F) ** 0.5),
        }
    _B_in = _B_setup()

    return {
        "A_x": _A_in["x"],
        "A_wqkv": _A_in["wqkv"],
        "A_wo": _A_in["wo"],
        "B_x": _B_in["x"],
        "B_W_gate": _B_in["W_gate"],
        "B_W_up": _B_in["W_up"],
        "B_W_down": _B_in["W_down"],
    }

def reference(A_x, A_wqkv, A_wo, B_x, B_W_gate, B_W_up, B_W_down):
    def _A_ref(x, wqkv, wo):
        B, S, D = x.shape
        H = 32
        Dh = D // H
        qkv = (lambda x, *d: x.permute(*d))((x @ wqkv).reshape(B, S, 3, H, Dh), 2, 0, 3, 1, 4)
        q, k, v = qkv[0], qkv[1], qkv[2]
        scores = torch.einsum("bhqd,bhkd->bhqk", q, k) * (Dh ** -0.5)
        p = _softmax(scores, axis=-1)
        o = torch.einsum("bhqk,bhkd->bhqd", p, v)
        return (lambda x, *d: x.permute(*d))(o, 0, 2, 1, 3).reshape(B, S, D) @ wo

    def _B_ref(x, W_gate, W_up, W_down):
        gate = torch.einsum("bsd,df->bsf", x, W_gate)
        up = torch.einsum("bsd,df->bsf", x, W_up)
        gate = gate * (lambda x, dt: x.to(dt))(gate > 0, gate.dtype)
        h = gate * up
        return torch.einsum("bsf,fd->bsd", h, W_down)

    x = A_x
    x = x + _A_ref(_layernorm(x, axis=-1), A_wqkv, A_wo)
    x = x + _B_ref(_layernorm(x, axis=-1), B_W_gate, B_W_up, B_W_down)
    x = x + _A_ref(_layernorm(x, axis=-1), A_wqkv, A_wo)
    x = x + _B_ref(_layernorm(x, axis=-1), B_W_gate, B_W_up, B_W_down)
    return x
```

```asm
; @launch kernel=mega_kernel grid=(256,1,1) block=(512,1,1) lds=163840
.amdgcn_target "amdgcn-amd-amdhsa--gfx950"
.text
.globl mega_kernel
.p2align 8
.type mega_kernel,@function
mega_kernel:
    s_cmp_ge_u32 s2, 256
    s_cbranch_scc1 L_mega_end
    s_getpc_b64 s[30:31]
    s_lshr_b32 s28, s2, 3
    s_mul_i32 s28, s28, 1536
    v_lshl_add_u32 v4, v0, 7, s28
    v_min_u32 v4, L_mega_last - mega_kernel - 128, v4
    v_cmp_gt_u32 vcc, 12, v0
    s_and_saveexec_b64 s[28:29], vcc
    s_cbranch_execz L_nocode
    global_load_dword v16, v4, s[30:31]
L_nocode:
    s_mov_b64 exec, s[28:29]
    s_load_dwordx2 s[4:5], s[0:1], 72
    s_load_dwordx2 s[6:7], s[0:1], 56
    s_load_dwordx2 s[86:87], s[0:1], 16
    s_load_dwordx4 s[88:91], s[0:1], 32
    s_load_dwordx2 s[92:93], s[0:1], 48
    s_load_dwordx4 s[32:35], s[0:1], 0
    s_load_dwordx2 s[36:37], s[0:1], 64
    v_and_b32 v1, 63, v0
    v_lshrrev_b32 v2, 6, v0
    v_lshlrev_b32 v3, 4, v1
    v_readfirstlane_b32 s12, v2
    s_and_b32 s13, s2, 1
    s_lshl_b32 s13, s13, 3
    s_bfe_u32 s28, s2, 0x30003
    s_add_u32 s13, s13, s28
    s_bfe_u32 s14, s2, 0x20001
    s_lshl_b32 s14, s14, 2
    s_lshr_b32 s28, s2, 6
    s_add_u32 s14, s14, s28
    s_mov_b32 s19, 0
    s_mov_b32 s21, 0
    s_lshl_b32 s22, s2, 10
    s_add_u32 s22, s22, 0x8000000
    s_waitcnt lgkmcnt(0)
    s_mov_b32 s8, s4
    s_mov_b32 s9, s5
    s_mov_b32 s10, 0x10000000
    s_mov_b32 s11, 0x00020000
    s_mov_b32 s24, s6
    s_mov_b32 s25, s7
    s_mov_b32 s26, 0x280000
    s_mov_b32 s27, 0x00020000
    s_mov_b32 s68, s32
    s_mov_b32 s69, s33
    s_mov_b32 s70, 0x280000
    s_mov_b32 s71, 0x00020000
    s_mov_b32 s72, s34
    s_mov_b32 s73, s35
    s_mov_b32 s74, 0x258000
    s_mov_b32 s75, 0x00020000
    s_mov_b32 s76, s36
    s_mov_b32 s77, s37
    s_mov_b32 s78, 0x100
    s_mov_b32 s79, 0x00020000
    s_mov_b64 s[32:33], s[34:35]
    s_mul_i32 s47, s14, 240
    s_lshl_b32 s28, s14, 8
    s_sub_u32 s28, s28, 256
    s_cmp_ge_u32 s14, 11
    s_cselect_b32 s47, s28, s47
    v_mov_b32 v15, 1
    s_mov_b32 s23, 0
    s_cmp_lt_u32 s12, 4
    s_cbranch_scc1 L_comp
    s_mov_b32 s23, 1
    s_sub_u32 s12, s12, 4
    s_setprio 0
    s_lshr_b32 s28, s12, 1
    s_mul_i32 s28, s28, 16384
    s_and_b32 s29, s12, 1
    s_lshl_b32 s30, s29, 12
    s_add_u32 s40, s28, s30
    s_mul_i32 s30, s29, 4096
    s_add_u32 s41, s28, s30
    s_add_u32 s41, s41, 8192
    s_mul_i32 s42, s12, 9216
    s_add_u32 s43, s42, 4096
    s_lshr_b32 s28, s12, 1
    s_mul_i32 s28, s28, 22528
    s_and_b32 s29, s12, 1
    s_lshl_b32 s30, s29, 12
    s_add_u32 s44, s28, s30
    s_mul_i32 s30, s29, 7168
    s_add_u32 s45, s28, s30
    s_add_u32 s45, s45, 8192
    v_lshrrev_b32 v8, 3, v1
    v_and_b32 v9, 7, v1
    v_lshrrev_b32 v10, 4, v1
    v_xor_b32 v9, v9, v10
    v_mul_u32_u24 v8, 1280, v8
    s_lshl_b32 s28, s13, 2
    s_add_u32 s28, s28, s12
    s_mul_i32 s28, s28, 40960
    v_xor_b32 v11, 0, v9
    v_lshl_add_u32 v11, v11, 4, v8
    s_add_u32 s29, s28, 0
    v_add_u32 v32, s29, v11
    v_xor_b32 v11, 4, v9
    v_lshl_add_u32 v11, v11, 4, v8
    s_add_u32 s29, s28, 9216
    v_add_u32 v33, s29, v11
    v_xor_b32 v11, 0, v9
    v_lshl_add_u32 v11, v11, 4, v8
    s_add_u32 s29, s28, 18432
    v_add_u32 v34, s29, v11
    v_xor_b32 v11, 4, v9
    v_lshl_add_u32 v11, v11, 4, v8
    s_add_u32 s29, s28, 27648
    v_add_u32 v35, s29, v11
    v_and_b32 v9, 15, v1
    v_lshlrev_b32 v11, 1, v10
    v_xor_b32 v9, v9, v11
    v_mul_u32_u24 v8, 3840, v10
    s_mul_i32 s28, s12, 61440
    s_add_u32 s28, s28, s47
    v_xor_b32 v11, 0, v9
    v_lshl_add_u32 v11, v11, 4, v8
    s_add_u32 s29, s28, 0
    v_add_u32 v36, s29, v11
    v_xor_b32 v11, 0, v9
    v_lshl_add_u32 v11, v11, 4, v8
    s_add_u32 s29, s28, 14336
    v_add_u32 v37, s29, v11
    v_xor_b32 v11, 8, v9
    v_lshl_add_u32 v11, v11, 4, v8
    s_add_u32 s29, s28, 28672
    v_add_u32 v38, s29, v11
    v_xor_b32 v11, 8, v9
    v_lshl_add_u32 v11, v11, 4, v8
    s_add_u32 s29, s28, 43008
    v_add_u32 v39, s29, v11
    s_lshl_b32 s30, s12, 12
    s_mov_b32 s38, 0x38058350
    s_and_b32 s28, s2, 7
    s_lshl_b32 s28, s28, 2
    s_lshr_b32 s38, s38, s28
    s_and_b32 s38, s38, 15
    s_bfe_u32 s28, s2, 0x10003
    s_mul_i32 s28, s28, 1
    s_add_u32 s38, s38, s28
    s_sub_u32 s28, s38, 10
    s_cmp_ge_u32 s38, 10
    s_cselect_b32 s38, s28, s38
    s_add_u32 m0, s30, 16384
    s_mul_i32 s35, s38, 245760
    buffer_load_dwordx4 v36, s[72:75], s35 offen offset:0 lds
    buffer_load_dwordx4 v37, s[72:75], s35 offen offset:1024 lds
    buffer_load_dwordx4 v38, s[72:75], s35 offen offset:2048 lds
    buffer_load_dwordx4 v39, s[72:75], s35 offen offset:3072 lds
    s_add_u32 m0, s30, 0
    s_lshl_b32 s35, s38, 7
    buffer_load_dwordx4 v32, s[68:71], s35 offen offset:0 lds
    buffer_load_dwordx4 v33, s[68:71], s35 offen offset:1024 lds
    buffer_load_dwordx4 v34, s[68:71], s35 offen offset:2048 lds
    buffer_load_dwordx4 v35, s[68:71], s35 offen offset:3072 lds
    s_add_u32 s38, s38, 1
    s_cmp_eq_u32 s38, 10
    s_cselect_b32 s38, 0, s38
    s_add_u32 m0, s30, 49152
    s_mul_i32 s35, s38, 245760
    buffer_load_dwordx4 v36, s[72:75], s35 offen offset:0 lds
    buffer_load_dwordx4 v37, s[72:75], s35 offen offset:1024 lds
    buffer_load_dwordx4 v38, s[72:75], s35 offen offset:2048 lds
    buffer_load_dwordx4 v39, s[72:75], s35 offen offset:3072 lds
    s_add_u32 m0, s30, 32768
    s_lshl_b32 s35, s38, 7
    buffer_load_dwordx4 v32, s[68:71], s35 offen offset:0 lds
    buffer_load_dwordx4 v33, s[68:71], s35 offen offset:1024 lds
    buffer_load_dwordx4 v34, s[68:71], s35 offen offset:2048 lds
    buffer_load_dwordx4 v35, s[68:71], s35 offen offset:3072 lds
    s_add_u32 s38, s38, 1
    s_cmp_eq_u32 s38, 10
    s_cselect_b32 s38, 0, s38
    s_waitcnt vmcnt(8)
    s_barrier
    s_add_u32 m0, s30, 81920
    s_mul_i32 s35, s38, 245760
    buffer_load_dwordx4 v36, s[72:75], s35 offen offset:0 lds
    buffer_load_dwordx4 v37, s[72:75], s35 offen offset:1024 lds
    buffer_load_dwordx4 v38, s[72:75], s35 offen offset:2048 lds
    buffer_load_dwordx4 v39, s[72:75], s35 offen offset:3072 lds
    s_add_u32 m0, s30, 65536
    s_lshl_b32 s35, s38, 7
    buffer_load_dwordx4 v32, s[68:71], s35 offen offset:0 lds
    buffer_load_dwordx4 v33, s[68:71], s35 offen offset:1024 lds
    buffer_load_dwordx4 v34, s[68:71], s35 offen offset:2048 lds
    buffer_load_dwordx4 v35, s[68:71], s35 offen offset:3072 lds
    s_add_u32 s38, s38, 1
    s_cmp_eq_u32 s38, 10
    s_cselect_b32 s38, 0, s38
    s_add_u32 m0, s30, 114688
    s_mul_i32 s35, s38, 245760
    buffer_load_dwordx4 v36, s[72:75], s35 offen offset:0 lds
    buffer_load_dwordx4 v37, s[72:75], s35 offen offset:1024 lds
    buffer_load_dwordx4 v38, s[72:75], s35 offen offset:2048 lds
    buffer_load_dwordx4 v39, s[72:75], s35 offen offset:3072 lds
    s_add_u32 m0, s30, 98304
    s_lshl_b32 s35, s38, 7
    buffer_load_dwordx4 v32, s[68:71], s35 offen offset:0 lds
    buffer_load_dwordx4 v33, s[68:71], s35 offen offset:1024 lds
    buffer_load_dwordx4 v34, s[68:71], s35 offen offset:2048 lds
    buffer_load_dwordx4 v35, s[68:71], s35 offen offset:3072 lds
    s_add_u32 s38, s38, 1
    s_cmp_eq_u32 s38, 10
    s_cselect_b32 s38, 0, s38
    s_waitcnt vmcnt(16)
    s_barrier
    s_add_u32 m0, s30, 16384
    s_mul_i32 s35, s38, 245760
    buffer_load_dwordx4 v36, s[72:75], s35 offen offset:0 lds
    buffer_load_dwordx4 v37, s[72:75], s35 offen offset:1024 lds
    buffer_load_dwordx4 v38, s[72:75], s35 offen offset:2048 lds
    buffer_load_dwordx4 v39, s[72:75], s35 offen offset:3072 lds
    s_add_u32 m0, s30, 0
    s_lshl_b32 s35, s38, 7
    buffer_load_dwordx4 v32, s[68:71], s35 offen offset:0 lds
    buffer_load_dwordx4 v33, s[68:71], s35 offen offset:1024 lds
    buffer_load_dwordx4 v34, s[68:71], s35 offen offset:2048 lds
    buffer_load_dwordx4 v35, s[68:71], s35 offen offset:3072 lds
    s_add_u32 s38, s38, 1
    s_cmp_eq_u32 s38, 10
    s_cselect_b32 s38, 0, s38
    s_waitcnt vmcnt(16)
    s_barrier
    s_add_u32 m0, s30, 49152
    s_mul_i32 s35, s38, 245760
    buffer_load_dwordx4 v36, s[72:75], s35 offen offset:0 lds
    buffer_load_dwordx4 v37, s[72:75], s35 offen offset:1024 lds
    buffer_load_dwordx4 v38, s[72:75], s35 offen offset:2048 lds
    buffer_load_dwordx4 v39, s[72:75], s35 offen offset:3072 lds
    s_add_u32 m0, s30, 32768
    s_lshl_b32 s35, s38, 7
    buffer_load_dwordx4 v32, s[68:71], s35 offen offset:0 lds
    buffer_load_dwordx4 v33, s[68:71], s35 offen offset:1024 lds
    buffer_load_dwordx4 v34, s[68:71], s35 offen offset:2048 lds
    buffer_load_dwordx4 v35, s[68:71], s35 offen offset:3072 lds
    s_add_u32 s38, s38, 1
    s_cmp_eq_u32 s38, 10
    s_cselect_b32 s38, 0, s38
    s_waitcnt vmcnt(16)
    s_barrier
    s_add_u32 m0, s30, 81920
    s_mul_i32 s35, s38, 245760
    buffer_load_dwordx4 v36, s[72:75], s35 offen offset:0 lds
    buffer_load_dwordx4 v37, s[72:75], s35 offen offset:1024 lds
    buffer_load_dwordx4 v38, s[72:75], s35 offen offset:2048 lds
    buffer_load_dwordx4 v39, s[72:75], s35 offen offset:3072 lds
    s_add_u32 m0, s30, 65536
    s_lshl_b32 s35, s38, 7
    buffer_load_dwordx4 v32, s[68:71], s35 offen offset:0 lds
    buffer_load_dwordx4 v33, s[68:71], s35 offen offset:1024 lds
    buffer_load_dwordx4 v34, s[68:71], s35 offen offset:2048 lds
    buffer_load_dwordx4 v35, s[68:71], s35 offen offset:3072 lds
    s_add_u32 s38, s38, 1
    s_cmp_eq_u32 s38, 10
    s_cselect_b32 s38, 0, s38
    s_waitcnt vmcnt(16)
    s_barrier
    s_add_u32 m0, s30, 114688
    s_mul_i32 s35, s38, 245760
    buffer_load_dwordx4 v36, s[72:75], s35 offen offset:0 lds
    buffer_load_dwordx4 v37, s[72:75], s35 offen offset:1024 lds
    buffer_load_dwordx4 v38, s[72:75], s35 offen offset:2048 lds
    buffer_load_dwordx4 v39, s[72:75], s35 offen offset:3072 lds
    s_add_u32 m0, s30, 98304
    s_lshl_b32 s35, s38, 7
    buffer_load_dwordx4 v32, s[68:71], s35 offen offset:0 lds
    buffer_load_dwordx4 v33, s[68:71], s35 offen offset:1024 lds
    buffer_load_dwordx4 v34, s[68:71], s35 offen offset:2048 lds
    buffer_load_dwordx4 v35, s[68:71], s35 offen offset:3072 lds
    s_add_u32 s38, s38, 1
    s_cmp_eq_u32 s38, 10
    s_cselect_b32 s38, 0, s38
    s_waitcnt vmcnt(16)
    s_barrier
    s_add_u32 m0, s30, 16384
    s_mul_i32 s35, s38, 245760
    buffer_load_dwordx4 v36, s[72:75], s35 offen offset:0 lds
    buffer_load_dwordx4 v37, s[72:75], s35 offen offset:1024 lds
    buffer_load_dwordx4 v38, s[72:75], s35 offen offset:2048 lds
    buffer_load_dwordx4 v39, s[72:75], s35 offen offset:3072 lds
    s_add_u32 m0, s30, 0
    s_lshl_b32 s35, s38, 7
    buffer_load_dwordx4 v32, s[68:71], s35 offen offset:0 lds
    buffer_load_dwordx4 v33, s[68:71], s35 offen offset:1024 lds
    buffer_load_dwordx4 v34, s[68:71], s35 offen offset:2048 lds
    buffer_load_dwordx4 v35, s[68:71], s35 offen offset:3072 lds
    s_add_u32 s38, s38, 1
    s_cmp_eq_u32 s38, 10
    s_cselect_b32 s38, 0, s38
    s_waitcnt vmcnt(16)
    s_barrier
    s_add_u32 m0, s30, 49152
    s_mul_i32 s35, s38, 245760
    buffer_load_dwordx4 v36, s[72:75], s35 offen offset:0 lds
    buffer_load_dwordx4 v37, s[72:75], s35 offen offset:1024 lds
    buffer_load_dwordx4 v38, s[72:75], s35 offen offset:2048 lds
    buffer_load_dwordx4 v39, s[72:75], s35 offen offset:3072 lds
    s_add_u32 m0, s30, 32768
    s_lshl_b32 s35, s38, 7
    buffer_load_dwordx4 v32, s[68:71], s35 offen offset:0 lds
    buffer_load_dwordx4 v33, s[68:71], s35 offen offset:1024 lds
    buffer_load_dwordx4 v34, s[68:71], s35 offen offset:2048 lds
    buffer_load_dwordx4 v35, s[68:71], s35 offen offset:3072 lds
    s_add_u32 s38, s38, 1
    s_cmp_eq_u32 s38, 10
    s_cselect_b32 s38, 0, s38
    s_waitcnt vmcnt(16)
    s_barrier
    s_waitcnt vmcnt(8)
    s_barrier
    s_waitcnt vmcnt(0)
    s_barrier
    s_barrier
    s_branch L_l_attn
L_l_after_attn:
    s_add_u32 m0, s43, 110592
    s_mov_b32 s35, 0
    buffer_load_dwordx4 v52, s[8:11], s35 offen offset:0  lds
    buffer_load_dwordx4 v53, s[8:11], s35 offen offset:1024  lds
    buffer_load_dwordx4 v54, s[8:11], s35 offen offset:2048  lds
    buffer_load_dwordx4 v55, s[8:11], s35 offen offset:3072  lds
    s_add_u32 m0, s43, 114688
    s_mov_b32 s35, 0
    buffer_load_dwordx4 v56, s[8:11], s35 offen offset:0  lds
    s_add_u32 m0, s43, 0
    s_mov_b32 s35, 4096
    buffer_load_dwordx4 v52, s[8:11], s35 offen offset:0  lds
    buffer_load_dwordx4 v53, s[8:11], s35 offen offset:1024  lds
    buffer_load_dwordx4 v54, s[8:11], s35 offen offset:2048  lds
    buffer_load_dwordx4 v55, s[8:11], s35 offen offset:3072  lds
    s_add_u32 m0, s43, 4096
    s_mov_b32 s35, 4096
    buffer_load_dwordx4 v56, s[8:11], s35 offen offset:0  lds
    s_add_u32 m0, s43, 36864
    s_mov_b32 s35, 8192
    buffer_load_dwordx4 v52, s[8:11], s35 offen offset:0  lds
    buffer_load_dwordx4 v53, s[8:11], s35 offen offset:1024  lds
    buffer_load_dwordx4 v54, s[8:11], s35 offen offset:2048  lds
    buffer_load_dwordx4 v55, s[8:11], s35 offen offset:3072  lds
    s_add_u32 m0, s43, 40960
    s_mov_b32 s35, 8192
    buffer_load_dwordx4 v56, s[8:11], s35 offen offset:0  lds
    s_add_u32 m0, s43, 73728
    s_mov_b32 s35, 12288
    buffer_load_dwordx4 v52, s[8:11], s35 offen offset:0  lds
    buffer_load_dwordx4 v53, s[8:11], s35 offen offset:1024  lds
    buffer_load_dwordx4 v54, s[8:11], s35 offen offset:2048  lds
    buffer_load_dwordx4 v55, s[8:11], s35 offen offset:3072  lds
    s_add_u32 m0, s43, 77824
    s_mov_b32 s35, 12288
    buffer_load_dwordx4 v56, s[8:11], s35 offen offset:0  lds
    s_barrier
    s_add_u32 m0, s42, 110592
    s_mov_b32 s35, 0
    buffer_load_dwordx4 v48, s[8:11], s35 offen offset:0 sc1 lds
    buffer_load_dwordx4 v49, s[8:11], s35 offen offset:1024 sc1 lds
    buffer_load_dwordx4 v50, s[8:11], s35 offen offset:2048 sc1 lds
    buffer_load_dwordx4 v51, s[8:11], s35 offen offset:3072 sc1 lds
    s_add_u32 m0, s42, 0
    s_mov_b32 s35, 4096
    buffer_load_dwordx4 v48, s[8:11], s35 offen offset:0 sc1 lds
    buffer_load_dwordx4 v49, s[8:11], s35 offen offset:1024 sc1 lds
    buffer_load_dwordx4 v50, s[8:11], s35 offen offset:2048 sc1 lds
    buffer_load_dwordx4 v51, s[8:11], s35 offen offset:3072 sc1 lds
    s_waitcnt vmcnt(4)
    s_barrier
    s_add_u32 m0, s42, 36864
    s_mov_b32 s35, 8192
    buffer_load_dwordx4 v48, s[8:11], s35 offen offset:0 sc1 lds
    buffer_load_dwordx4 v49, s[8:11], s35 offen offset:1024 sc1 lds
    buffer_load_dwordx4 v50, s[8:11], s35 offen offset:2048 sc1 lds
    buffer_load_dwordx4 v51, s[8:11], s35 offen offset:3072 sc1 lds
    s_add_u32 m0, s42, 73728
    s_mov_b32 s35, 12288
    buffer_load_dwordx4 v48, s[8:11], s35 offen offset:0 sc1 lds
    buffer_load_dwordx4 v49, s[8:11], s35 offen offset:1024 sc1 lds
    buffer_load_dwordx4 v50, s[8:11], s35 offen offset:2048 sc1 lds
    buffer_load_dwordx4 v51, s[8:11], s35 offen offset:3072 sc1 lds
    s_mul_i32 s28, s14, 301056
    s_lshr_b32 s29, s12, 1
    s_lshl_b32 s29, s29, 10
    s_add_u32 s28, s28, s29
    s_add_u32 s28, s28, 0x300000
    s_cmp_eq_u32 s14, 15
    s_cselect_b32 s30, 0xff0, 0
    s_and_b32 s29, s12, 1
    s_mul_i32 s29, s29, 7
    s_bitcmp1_b32 s30, s29
    s_cselect_b32 s31, 0, s29
    s_mul_i32 s31, s31, 21504
    s_add_u32 s31, s31, s28
    s_sub_u32 s31, s31, 0
    v_add_u32 v36, s31, v3
    s_add_u32 s29, s29, 1
    s_bitcmp1_b32 s30, s29
    s_cselect_b32 s31, 0, s29
    s_mul_i32 s31, s31, 21504
    s_add_u32 s31, s31, s28
    s_sub_u32 s31, s31, 1024
    v_add_u32 v37, s31, v3
    s_add_u32 s29, s29, 1
    s_bitcmp1_b32 s30, s29
    s_cselect_b32 s31, 0, s29
    s_mul_i32 s31, s31, 21504
    s_add_u32 s31, s31, s28
    s_sub_u32 s31, s31, 2048
    v_add_u32 v38, s31, v3
    s_add_u32 s29, s29, 1
    s_bitcmp1_b32 s30, s29
    s_cselect_b32 s31, 0, s29
    s_mul_i32 s31, s31, 21504
    s_add_u32 s31, s31, s28
    s_sub_u32 s31, s31, 3072
    v_add_u32 v39, s31, v3
    s_add_u32 s29, s29, 1
    s_bitcmp1_b32 s30, s29
    s_cselect_b32 s31, 0, s29
    s_mul_i32 s31, s31, 21504
    s_add_u32 s31, s31, s28
    s_sub_u32 s31, s31, 0
    v_add_u32 v40, s31, v3
    s_add_u32 s29, s29, 1
    s_bitcmp1_b32 s30, s29
    s_cselect_b32 s31, 0, s29
    s_mul_i32 s31, s31, 21504
    s_add_u32 s31, s31, s28
    s_sub_u32 s31, s31, 1024
    v_add_u32 v41, s31, v3
    s_add_u32 s29, s29, 1
    s_bitcmp1_b32 s30, s29
    s_cselect_b32 s31, 0, s29
    s_mul_i32 s31, s31, 21504
    s_add_u32 s31, s31, s28
    s_sub_u32 s31, s31, 2048
    v_add_u32 v42, s31, v3
    s_add_u32 s29, s29, 1
    s_waitcnt vmcnt(8)
    s_barrier
    s_add_u32 m0, s43, 110592
    s_mov_b32 s35, 16384
    buffer_load_dwordx4 v52, s[8:11], s35 offen offset:0  lds
    buffer_load_dwordx4 v53, s[8:11], s35 offen offset:1024  lds
    buffer_load_dwordx4 v54, s[8:11], s35 offen offset:2048  lds
    buffer_load_dwordx4 v55, s[8:11], s35 offen offset:3072  lds
    s_add_u32 m0, s43, 114688
    s_mov_b32 s35, 16384
    buffer_load_dwordx4 v56, s[8:11], s35 offen offset:0  lds
    s_add_u32 m0, s42, 110592
    s_mov_b32 s35, 16384
    buffer_load_dwordx4 v48, s[8:11], s35 offen offset:0 sc1 lds
    buffer_load_dwordx4 v49, s[8:11], s35 offen offset:1024 sc1 lds
    buffer_load_dwordx4 v50, s[8:11], s35 offen offset:2048 sc1 lds
    buffer_load_dwordx4 v51, s[8:11], s35 offen offset:3072 sc1 lds
    s_waitcnt vmcnt(13)
    s_barrier
    s_waitcnt vmcnt(9)
    s_barrier
    s_add_u32 m0, s45, 0
    s_mov_b32 s35, 0
    buffer_load_dwordx4 v36, s[8:11], s35 offen offset:0  lds
    buffer_load_dwordx4 v37, s[8:11], s35 offen offset:1024  lds
    buffer_load_dwordx4 v38, s[8:11], s35 offen offset:2048  lds
    buffer_load_dwordx4 v39, s[8:11], s35 offen offset:3072  lds
    s_add_u32 m0, s45, 4096
    s_mov_b32 s35, 0
    buffer_load_dwordx4 v40, s[8:11], s35 offen offset:0  lds
    buffer_load_dwordx4 v41, s[8:11], s35 offen offset:1024  lds
    buffer_load_dwordx4 v42, s[8:11], s35 offen offset:2048  lds
    s_waitcnt vmcnt(7)
    s_barrier
    s_add_u32 m0, s45, 45056
    s_mov_b32 s35, 2048
    buffer_load_dwordx4 v36, s[8:11], s35 offen offset:0  lds
    buffer_load_dwordx4 v37, s[8:11], s35 offen offset:1024  lds
    buffer_load_dwordx4 v38, s[8:11], s35 offen offset:2048  lds
    buffer_load_dwordx4 v39, s[8:11], s35 offen offset:3072  lds
    s_add_u32 m0, s45, 49152
    s_mov_b32 s35, 2048
    buffer_load_dwordx4 v40, s[8:11], s35 offen offset:0  lds
    buffer_load_dwordx4 v41, s[8:11], s35 offen offset:1024  lds
    buffer_load_dwordx4 v42, s[8:11], s35 offen offset:2048  lds
    s_mul_i32 s28, s13, 163840
    s_and_b32 s29, s12, 1
    s_mul_i32 s29, s29, 81920
    s_add_u32 s28, s28, s29
    s_lshr_b32 s29, s12, 1
    s_lshl_b32 s29, s29, 10
    s_add_u32 s28, s28, s29
    s_add_u32 s28, s28, 0x1000000
    v_add_u32 v32, s28, v3
    s_add_u32 s28, s28, 19456
    v_add_u32 v33, s28, v3
    s_add_u32 s28, s28, 19456
    v_add_u32 v34, s28, v3
    s_add_u32 s28, s28, 19456
    v_add_u32 v35, s28, v3
    s_barrier
    s_barrier
    s_add_u32 m0, s44, 0
    s_mov_b32 s35, 0
    buffer_load_dwordx4 v32, s[8:11], s35 offen offset:0 sc1 lds
    buffer_load_dwordx4 v33, s[8:11], s35 offen offset:1024 sc1 lds
    buffer_load_dwordx4 v34, s[8:11], s35 offen offset:2048 sc1 lds
    buffer_load_dwordx4 v35, s[8:11], s35 offen offset:3072 sc1 lds
    s_add_u32 m0, s44, 45056
    s_mov_b32 s35, 2048
    buffer_load_dwordx4 v32, s[8:11], s35 offen offset:0 sc1 lds
    buffer_load_dwordx4 v33, s[8:11], s35 offen offset:1024 sc1 lds
    buffer_load_dwordx4 v34, s[8:11], s35 offen offset:2048 sc1 lds
    buffer_load_dwordx4 v35, s[8:11], s35 offen offset:3072 sc1 lds
    s_waitcnt vmcnt(4)
    s_barrier
    s_add_u32 m0, s45, 90112
    s_mov_b32 s35, 4096
    buffer_load_dwordx4 v36, s[8:11], s35 offen offset:0  lds
    buffer_load_dwordx4 v37, s[8:11], s35 offen offset:1024  lds
    buffer_load_dwordx4 v38, s[8:11], s35 offen offset:2048  lds
    buffer_load_dwordx4 v39, s[8:11], s35 offen offset:3072  lds
    s_add_u32 m0, s45, 94208
    s_mov_b32 s35, 4096
    buffer_load_dwordx4 v40, s[8:11], s35 offen offset:0  lds
    buffer_load_dwordx4 v41, s[8:11], s35 offen offset:1024  lds
    buffer_load_dwordx4 v42, s[8:11], s35 offen offset:2048  lds
    s_add_u32 m0, s44, 90112
    s_mov_b32 s35, 4096
    buffer_load_dwordx4 v32, s[8:11], s35 offen offset:0 sc1 lds
    buffer_load_dwordx4 v33, s[8:11], s35 offen offset:1024 sc1 lds
    buffer_load_dwordx4 v34, s[8:11], s35 offen offset:2048 sc1 lds
    buffer_load_dwordx4 v35, s[8:11], s35 offen offset:3072 sc1 lds
    s_mul_i32 s28, s16, 276480
    s_lshr_b32 s29, s12, 0
    s_lshl_b32 s29, s29, 10
    s_add_u32 s28, s28, s29
    s_add_u32 s28, s28, 0x8ff800
    s_add_u32 s29, s28, 0
    v_add_u32 v52, s29, v3
    s_add_u32 s29, s28, 54272
    v_add_u32 v53, s29, v3
    s_add_u32 s29, s28, 108544
    v_add_u32 v54, s29, v3
    s_add_u32 s29, s28, 162816
    v_add_u32 v55, s29, v3
    s_add_u32 s29, s28, 221184
    v_add_u32 v56, s29, v3
    s_waitcnt vmcnt(11)
    s_barrier
    s_add_u32 m0, s45, 0
    s_mov_b32 s35, 6144
    buffer_load_dwordx4 v36, s[8:11], s35 offen offset:0  lds
    buffer_load_dwordx4 v37, s[8:11], s35 offen offset:1024  lds
    buffer_load_dwordx4 v38, s[8:11], s35 offen offset:2048  lds
    buffer_load_dwordx4 v39, s[8:11], s35 offen offset:3072  lds
    s_add_u32 m0, s45, 4096
    s_mov_b32 s35, 6144
    buffer_load_dwordx4 v40, s[8:11], s35 offen offset:0  lds
    buffer_load_dwordx4 v41, s[8:11], s35 offen offset:1024  lds
    buffer_load_dwordx4 v42, s[8:11], s35 offen offset:2048  lds
    s_add_u32 m0, s44, 0
    s_mov_b32 s35, 6144
    buffer_load_dwordx4 v32, s[8:11], s35 offen offset:0 sc1 lds
    buffer_load_dwordx4 v33, s[8:11], s35 offen offset:1024 sc1 lds
    buffer_load_dwordx4 v34, s[8:11], s35 offen offset:2048 sc1 lds
    buffer_load_dwordx4 v35, s[8:11], s35 offen offset:3072 sc1 lds
    s_waitcnt vmcnt(11)
    s_barrier
    s_add_u32 m0, s45, 45056
    s_mov_b32 s35, 8192
    buffer_load_dwordx4 v36, s[8:11], s35 offen offset:0  lds
    buffer_load_dwordx4 v37, s[8:11], s35 offen offset:1024  lds
    buffer_load_dwordx4 v38, s[8:11], s35 offen offset:2048  lds
    buffer_load_dwordx4 v39, s[8:11], s35 offen offset:3072  lds
    s_add_u32 m0, s45, 49152
    s_mov_b32 s35, 8192
    buffer_load_dwordx4 v40, s[8:11], s35 offen offset:0  lds
    buffer_load_dwordx4 v41, s[8:11], s35 offen offset:1024  lds
    buffer_load_dwordx4 v42, s[8:11], s35 offen offset:2048  lds
    s_add_u32 m0, s44, 45056
    s_mov_b32 s35, 8192
    buffer_load_dwordx4 v32, s[8:11], s35 offen offset:0 sc1 lds
    buffer_load_dwordx4 v33, s[8:11], s35 offen offset:1024 sc1 lds
    buffer_load_dwordx4 v34, s[8:11], s35 offen offset:2048 sc1 lds
    buffer_load_dwordx4 v35, s[8:11], s35 offen offset:3072 sc1 lds
    s_waitcnt vmcnt(11)
    s_barrier
    s_add_u32 m0, s45, 90112
    s_mov_b32 s35, 10240
    buffer_load_dwordx4 v36, s[8:11], s35 offen offset:0  lds
    buffer_load_dwordx4 v37, s[8:11], s35 offen offset:1024  lds
    buffer_load_dwordx4 v38, s[8:11], s35 offen offset:2048  lds
    buffer_load_dwordx4 v39, s[8:11], s35 offen offset:3072  lds
    s_add_u32 m0, s45, 94208
    s_mov_b32 s35, 10240
    buffer_load_dwordx4 v40, s[8:11], s35 offen offset:0  lds
    buffer_load_dwordx4 v41, s[8:11], s35 offen offset:1024  lds
    buffer_load_dwordx4 v42, s[8:11], s35 offen offset:2048  lds
    s_add_u32 m0, s44, 90112
    s_mov_b32 s35, 10240
    buffer_load_dwordx4 v32, s[8:11], s35 offen offset:0 sc1 lds
    buffer_load_dwordx4 v33, s[8:11], s35 offen offset:1024 sc1 lds
    buffer_load_dwordx4 v34, s[8:11], s35 offen offset:2048 sc1 lds
    buffer_load_dwordx4 v35, s[8:11], s35 offen offset:3072 sc1 lds
    s_waitcnt vmcnt(11)
    s_barrier
    s_add_u32 m0, s45, 0
    s_mov_b32 s35, 12288
    buffer_load_dwordx4 v36, s[8:11], s35 offen offset:0  lds
    buffer_load_dwordx4 v37, s[8:11], s35 offen offset:1024  lds
    buffer_load_dwordx4 v38, s[8:11], s35 offen offset:2048  lds
    buffer_load_dwordx4 v39, s[8:11], s35 offen offset:3072  lds
    s_add_u32 m0, s45, 4096
    s_mov_b32 s35, 12288
    buffer_load_dwordx4 v40, s[8:11], s35 offen offset:0  lds
    buffer_load_dwordx4 v41, s[8:11], s35 offen offset:1024  lds
    buffer_load_dwordx4 v42, s[8:11], s35 offen offset:2048  lds
    s_add_u32 m0, s44, 0
    s_mov_b32 s35, 12288
    buffer_load_dwordx4 v32, s[8:11], s35 offen offset:0 sc1 lds
    buffer_load_dwordx4 v33, s[8:11], s35 offen offset:1024 sc1 lds
    buffer_load_dwordx4 v34, s[8:11], s35 offen offset:2048 sc1 lds
    buffer_load_dwordx4 v35, s[8:11], s35 offen offset:3072 sc1 lds
    s_waitcnt vmcnt(11)
    s_barrier
    s_add_u32 m0, s45, 45056
    s_mov_b32 s35, 14336
    buffer_load_dwordx4 v36, s[8:11], s35 offen offset:0  lds
    buffer_load_dwordx4 v37, s[8:11], s35 offen offset:1024  lds
    buffer_load_dwordx4 v38, s[8:11], s35 offen offset:2048  lds
    buffer_load_dwordx4 v39, s[8:11], s35 offen offset:3072  lds
    s_add_u32 m0, s45, 49152
    s_mov_b32 s35, 14336
    buffer_load_dwordx4 v40, s[8:11], s35 offen offset:0  lds
    buffer_load_dwordx4 v41, s[8:11], s35 offen offset:1024  lds
    buffer_load_dwordx4 v42, s[8:11], s35 offen offset:2048  lds
    s_add_u32 m0, s44, 45056
    s_mov_b32 s35, 14336
    buffer_load_dwordx4 v32, s[8:11], s35 offen offset:0 sc1 lds
    buffer_load_dwordx4 v33, s[8:11], s35 offen offset:1024 sc1 lds
    buffer_load_dwordx4 v34, s[8:11], s35 offen offset:2048 sc1 lds
    buffer_load_dwordx4 v35, s[8:11], s35 offen offset:3072 sc1 lds
    s_waitcnt vmcnt(11)
    s_barrier
    s_add_u32 m0, s45, 90112
    s_mov_b32 s35, 16384
    buffer_load_dwordx4 v36, s[8:11], s35 offen offset:0  lds
    buffer_load_dwordx4 v37, s[8:11], s35 offen offset:1024  lds
    buffer_load_dwordx4 v38, s[8:11], s35 offen offset:2048  lds
    buffer_load_dwordx4 v39, s[8:11], s35 offen offset:3072  lds
    s_add_u32 m0, s45, 94208
    s_mov_b32 s35, 16384
    buffer_load_dwordx4 v40, s[8:11], s35 offen offset:0  lds
    buffer_load_dwordx4 v41, s[8:11], s35 offen offset:1024  lds
    buffer_load_dwordx4 v42, s[8:11], s35 offen offset:2048  lds
    s_add_u32 m0, s44, 90112
    s_mov_b32 s35, 16384
    buffer_load_dwordx4 v32, s[8:11], s35 offen offset:0 sc1 lds
    buffer_load_dwordx4 v33, s[8:11], s35 offen offset:1024 sc1 lds
    buffer_load_dwordx4 v34, s[8:11], s35 offen offset:2048 sc1 lds
    buffer_load_dwordx4 v35, s[8:11], s35 offen offset:3072 sc1 lds
    s_waitcnt vmcnt(11)
    s_barrier
    s_add_u32 m0, s45, 0
    s_mov_b32 s35, 18432
    buffer_load_dwordx4 v36, s[8:11], s35 offen offset:0  lds
    buffer_load_dwordx4 v37, s[8:11], s35 offen offset:1024  lds
    buffer_load_dwordx4 v38, s[8:11], s35 offen offset:2048  lds
    buffer_load_dwordx4 v39, s[8:11], s35 offen offset:3072  lds
    s_add_u32 m0, s45, 4096
    s_mov_b32 s35, 18432
    buffer_load_dwordx4 v40, s[8:11], s35 offen offset:0  lds
    buffer_load_dwordx4 v41, s[8:11], s35 offen offset:1024  lds
    buffer_load_dwordx4 v42, s[8:11], s35 offen offset:2048  lds
    s_add_u32 m0, s44, 0
    s_mov_b32 s35, 18432
    buffer_load_dwordx4 v32, s[8:11], s35 offen offset:0 sc1 lds
    buffer_load_dwordx4 v33, s[8:11], s35 offen offset:1024 sc1 lds
    buffer_load_dwordx4 v34, s[8:11], s35 offen offset:2048 sc1 lds
    buffer_load_dwordx4 v35, s[8:11], s35 offen offset:3072 sc1 lds
    s_waitcnt vmcnt(11)
    s_barrier
    s_add_u32 m0, s43, 49152
    s_mov_b32 s35, 4096
    buffer_load_dwordx4 v52, s[8:11], s35 offen offset:0  lds
    buffer_load_dwordx4 v53, s[8:11], s35 offen offset:1024  lds
    buffer_load_dwordx4 v54, s[8:11], s35 offen offset:2048  lds
    buffer_load_dwordx4 v55, s[8:11], s35 offen offset:3072  lds
    s_add_u32 m0, s43, 53248
    s_mov_b32 s35, 4096
    buffer_load_dwordx4 v56, s[8:11], s35 offen offset:0  lds
    s_waitcnt vmcnt(5)
    s_barrier
    s_lshl_b32 s28, s13, 2
    s_add_u32 s28, s28, s12
    s_mul_i32 s28, s28, 110592
    s_add_u32 s28, s28, 0x2300000
    s_mul_i32 s29, s14, 3072
    s_add_u32 s30, s28, s29
    s_lshl_b32 s29, s14, 9
    s_add_u32 s29, s28, s29
    s_add_u32 s29, s29, 47104
    s_cmp_eq_u32 s14, 15
    s_cselect_b32 s31, 0, 1024
    v_add_u32 v24, s31, v3
    v_add_u32 v25, s31, v24
    buffer_load_dwordx4 v[20:23], v3, s[8:11], s30 offen sc1
    buffer_load_dwordx4 v[20:23], v24, s[8:11], s30 offen sc1
    buffer_load_dwordx4 v[20:23], v25, s[8:11], s30 offen sc1
    s_mov_b32 exec_hi, 0
    buffer_load_dwordx4 v[20:23], v3, s[8:11], s29 offen sc1
    s_mov_b64 exec, -1
    s_add_u32 s30, s30, 55296
    s_add_u32 s29, s29, 55296
    buffer_load_dwordx4 v[20:23], v3, s[8:11], s30 offen sc1
    buffer_load_dwordx4 v[20:23], v24, s[8:11], s30 offen sc1
    buffer_load_dwordx4 v[20:23], v25, s[8:11], s30 offen sc1
    s_mov_b32 exec_hi, 0
    buffer_load_dwordx4 v[20:23], v3, s[8:11], s29 offen sc1
    s_mov_b64 exec, -1
    s_cmp_lt_u32 s12, 2
    s_cbranch_scc1 L_mega_1
    s_add_u32 m0, s43, 90112
    s_mov_b32 s35, 0
    buffer_load_dwordx4 v52, s[8:11], s35 offen offset:0  lds
    buffer_load_dwordx4 v53, s[8:11], s35 offen offset:1024  lds
    buffer_load_dwordx4 v54, s[8:11], s35 offen offset:2048  lds
    buffer_load_dwordx4 v55, s[8:11], s35 offen offset:3072  lds
    s_add_u32 m0, s43, 94208
    s_mov_b32 s35, 0
    buffer_load_dwordx4 v56, s[8:11], s35 offen offset:0  lds
L_mega_1:
    s_add_u32 m0, s43, 126976
    s_mov_b32 s35, 8192
    buffer_load_dwordx4 v52, s[8:11], s35 offen offset:0  lds
    buffer_load_dwordx4 v53, s[8:11], s35 offen offset:1024  lds
    buffer_load_dwordx4 v54, s[8:11], s35 offen offset:2048  lds
    buffer_load_dwordx4 v55, s[8:11], s35 offen offset:3072  lds
    s_add_u32 m0, s43, 131072
    s_mov_b32 s35, 8192
    buffer_load_dwordx4 v56, s[8:11], s35 offen offset:0  lds
    s_mul_i32 s28, s15, 221184
    s_mov_b32 s29, s12
    s_lshl_b32 s29, s29, 10
    s_add_u32 s28, s28, s29
    s_add_u32 s28, s28, 0x22ff800
    v_add_u32 v48, s28, v3
    s_add_u32 s28, s28, 54272
    v_add_u32 v49, s28, v3
    s_add_u32 s28, s28, 54272
    v_add_u32 v50, s28, v3
    s_add_u32 s28, s28, 54272
    v_add_u32 v51, s28, v3
    s_barrier
    s_barrier
    s_cmp_lt_u32 s12, 2
    s_cbranch_scc1 L_mega_2
    s_add_u32 m0, s42, 90112
    s_mov_b32 s35, 0
    buffer_load_dwordx4 v48, s[8:11], s35 offen offset:0 sc1 lds
    buffer_load_dwordx4 v49, s[8:11], s35 offen offset:1024 sc1 lds
    buffer_load_dwordx4 v50, s[8:11], s35 offen offset:2048 sc1 lds
    buffer_load_dwordx4 v51, s[8:11], s35 offen offset:3072 sc1 lds
L_mega_2:
    s_add_u32 m0, s42, 49152
    s_mov_b32 s35, 4096
    buffer_load_dwordx4 v48, s[8:11], s35 offen offset:0 sc1 lds
    buffer_load_dwordx4 v49, s[8:11], s35 offen offset:1024 sc1 lds
    buffer_load_dwordx4 v50, s[8:11], s35 offen offset:2048 sc1 lds
    buffer_load_dwordx4 v51, s[8:11], s35 offen offset:3072 sc1 lds
    s_waitcnt vmcnt(4)
    s_barrier
    s_add_u32 m0, s42, 126976
    s_mov_b32 s35, 8192
    buffer_load_dwordx4 v48, s[8:11], s35 offen offset:0 sc1 lds
    buffer_load_dwordx4 v49, s[8:11], s35 offen offset:1024 sc1 lds
    buffer_load_dwordx4 v50, s[8:11], s35 offen offset:2048 sc1 lds
    buffer_load_dwordx4 v51, s[8:11], s35 offen offset:3072 sc1 lds
    s_add_u32 m0, s43, 0
    s_mov_b32 s35, 12288
    buffer_load_dwordx4 v52, s[8:11], s35 offen offset:0  lds
    buffer_load_dwordx4 v53, s[8:11], s35 offen offset:1024  lds
    buffer_load_dwordx4 v54, s[8:11], s35 offen offset:2048  lds
    buffer_load_dwordx4 v55, s[8:11], s35 offen offset:3072  lds
    s_add_u32 m0, s43, 4096
    s_mov_b32 s35, 12288
    buffer_load_dwordx4 v56, s[8:11], s35 offen offset:0  lds
    s_add_u32 m0, s42, 0
    s_mov_b32 s35, 12288
    buffer_load_dwordx4 v48, s[8:11], s35 offen offset:0 sc1 lds
    buffer_load_dwordx4 v49, s[8:11], s35 offen offset:1024 sc1 lds
    buffer_load_dwordx4 v50, s[8:11], s35 offen offset:2048 sc1 lds
    buffer_load_dwordx4 v51, s[8:11], s35 offen offset:3072 sc1 lds
    s_mul_i32 s28, s14, 172032
    s_lshr_b32 s29, s12, 1
    s_lshl_b32 s29, s29, 10
    s_add_u32 s28, s28, s29
    s_add_u32 s28, s28, 0x1000
    s_cmp_eq_u32 s14, 10
    s_cselect_b32 s30, 0xb0, 0
    s_and_b32 s29, s12, 1
    s_mul_i32 s29, s29, 4
    s_bitcmp1_b32 s30, s29
    s_cselect_b32 s31, 0, s29
    s_mul_i32 s31, s31, 21504
    s_add_u32 s31, s31, s28
    s_sub_u32 s31, s31, 0
    v_add_u32 v36, s31, v3
    s_add_u32 s29, s29, 1
    s_bitcmp1_b32 s30, s29
    s_cselect_b32 s31, 0, s29
    s_mul_i32 s31, s31, 21504
    s_add_u32 s31, s31, s28
    s_sub_u32 s31, s31, 1024
    v_add_u32 v37, s31, v3
    s_add_u32 s29, s29, 1
    s_bitcmp1_b32 s30, s29
    s_cselect_b32 s31, 0, s29
    s_mul_i32 s31, s31, 21504
    s_add_u32 s31, s31, s28
    s_sub_u32 s31, s31, 2048
    v_add_u32 v38, s31, v3
    s_add_u32 s29, s29, 1
    s_bitcmp1_b32 s30, s29
    s_cselect_b32 s31, 0, s29
    s_mul_i32 s31, s31, 21504
    s_add_u32 s31, s31, s28
    s_sub_u32 s31, s31, 3072
    v_add_u32 v39, s31, v3
    s_add_u32 s29, s29, 1
    s_cmp_lt_u32 s14, 11
    s_cselect_b32 s30, 0x80, 0
    s_cmp_eq_u32 s29, 8
    s_cselect_b32 s30, s30, 0
    v_and_b32 v4, s30, v3
    v_sub_u32 v39, v39, v4
    s_cmp_lg_u32 s19, 0
    s_cbranch_scc1 L_mega_3
    s_lshl_b32 s28, s15, 2
    s_add_u32 s28, s28, s12
    s_mul_i32 s29, s28, 20480
    s_add_u32 s29, s29, 0x1000000
    s_lshl_b32 s30, s16, 11
    s_add_u32 s30, s30, s29
    s_lshl_b32 s31, s16, 9
    s_add_u32 s31, s31, s29
    s_add_u32 s31, s31, 16384
    buffer_load_dwordx4 v[20:23], v3, s[8:11], s30 offen sc1
    buffer_load_dwordx4 v[20:23], v3, s[8:11], s30 offen offset:1024 sc1
    s_mov_b32 exec_hi, 0
    buffer_load_dwordx4 v[20:23], v3, s[8:11], s31 offen sc1
    s_lshl_b32 s29, s16, 14
    s_lshl_b32 s28, s28, 7
    s_add_u32 s29, s29, s28
    s_add_u32 s29, s29, 0x1280000
    s_mov_b64 exec, 1
    buffer_load_dwordx4 v[20:23], v3, s[8:11], s29 offen sc1
    s_mov_b64 exec, -1
L_mega_3:
    s_waitcnt vmcnt(13)
    s_barrier
    s_add_u32 m0, s43, 90112
    s_mov_b32 s35, 16384
    buffer_load_dwordx4 v52, s[8:11], s35 offen offset:0  lds
    buffer_load_dwordx4 v53, s[8:11], s35 offen offset:1024  lds
    buffer_load_dwordx4 v54, s[8:11], s35 offen offset:2048  lds
    buffer_load_dwordx4 v55, s[8:11], s35 offen offset:3072  lds
    s_add_u32 m0, s43, 94208
    s_mov_b32 s35, 16384
    buffer_load_dwordx4 v56, s[8:11], s35 offen offset:0  lds
    s_add_u32 m0, s42, 90112
    s_mov_b32 s35, 16384
    buffer_load_dwordx4 v48, s[8:11], s35 offen offset:0 sc1 lds
    buffer_load_dwordx4 v49, s[8:11], s35 offen offset:1024 sc1 lds
    buffer_load_dwordx4 v50, s[8:11], s35 offen offset:2048 sc1 lds
    buffer_load_dwordx4 v51, s[8:11], s35 offen offset:3072 sc1 lds
    s_waitcnt vmcnt(18)
    s_barrier
    s_add_u32 m0, s43, 49152
    s_mov_b32 s35, 20480
    buffer_load_dwordx4 v52, s[8:11], s35 offen offset:0  lds
    buffer_load_dwordx4 v53, s[8:11], s35 offen offset:1024  lds
    buffer_load_dwordx4 v54, s[8:11], s35 offen offset:2048  lds
    buffer_load_dwordx4 v55, s[8:11], s35 offen offset:3072  lds
    s_add_u32 m0, s43, 53248
    s_mov_b32 s35, 20480
    buffer_load_dwordx4 v56, s[8:11], s35 offen offset:0  lds
    s_add_u32 m0, s42, 49152
    s_mov_b32 s35, 20480
    buffer_load_dwordx4 v48, s[8:11], s35 offen offset:0 sc1 lds
    buffer_load_dwordx4 v49, s[8:11], s35 offen offset:1024 sc1 lds
    buffer_load_dwordx4 v50, s[8:11], s35 offen offset:2048 sc1 lds
    buffer_load_dwordx4 v51, s[8:11], s35 offen offset:3072 sc1 lds
    s_waitcnt vmcnt(18)
    s_barrier
    s_add_u32 m0, s43, 126976
    s_mov_b32 s35, 24576
    buffer_load_dwordx4 v52, s[8:11], s35 offen offset:0  lds
    buffer_load_dwordx4 v53, s[8:11], s35 offen offset:1024  lds
    buffer_load_dwordx4 v54, s[8:11], s35 offen offset:2048  lds
    buffer_load_dwordx4 v55, s[8:11], s35 offen offset:3072  lds
    s_add_u32 m0, s43, 131072
    s_mov_b32 s35, 24576
    buffer_load_dwordx4 v56, s[8:11], s35 offen offset:0  lds
    s_add_u32 m0, s42, 126976
    s_mov_b32 s35, 24576
    buffer_load_dwordx4 v48, s[8:11], s35 offen offset:0 sc1 lds
    buffer_load_dwordx4 v49, s[8:11], s35 offen offset:1024 sc1 lds
    buffer_load_dwordx4 v50, s[8:11], s35 offen offset:2048 sc1 lds
    buffer_load_dwordx4 v51, s[8:11], s35 offen offset:3072 sc1 lds
    s_waitcnt vmcnt(18)
    s_barrier
    s_add_u32 m0, s43, 0
    s_mov_b32 s35, 28672
    buffer_load_dwordx4 v52, s[8:11], s35 offen offset:0  lds
    buffer_load_dwordx4 v53, s[8:11], s35 offen offset:1024  lds
    buffer_load_dwordx4 v54, s[8:11], s35 offen offset:2048  lds
    buffer_load_dwordx4 v55, s[8:11], s35 offen offset:3072  lds
    s_add_u32 m0, s43, 4096
    s_mov_b32 s35, 28672
    buffer_load_dwordx4 v56, s[8:11], s35 offen offset:0  lds
    s_add_u32 m0, s42, 0
    s_mov_b32 s35, 28672
    buffer_load_dwordx4 v48, s[8:11], s35 offen offset:0 sc1 lds
    buffer_load_dwordx4 v49, s[8:11], s35 offen offset:1024 sc1 lds
    buffer_load_dwordx4 v50, s[8:11], s35 offen offset:2048 sc1 lds
    buffer_load_dwordx4 v51, s[8:11], s35 offen offset:3072 sc1 lds
    s_waitcnt vmcnt(18)
    s_barrier
    s_add_u32 m0, s43, 90112
    s_mov_b32 s35, 32768
    buffer_load_dwordx4 v52, s[8:11], s35 offen offset:0  lds
    buffer_load_dwordx4 v53, s[8:11], s35 offen offset:1024  lds
    buffer_load_dwordx4 v54, s[8:11], s35 offen offset:2048  lds
    buffer_load_dwordx4 v55, s[8:11], s35 offen offset:3072  lds
    s_add_u32 m0, s43, 94208
    s_mov_b32 s35, 32768
    buffer_load_dwordx4 v56, s[8:11], s35 offen offset:0  lds
    s_add_u32 m0, s42, 90112
    s_mov_b32 s35, 32768
    buffer_load_dwordx4 v48, s[8:11], s35 offen offset:0 sc1 lds
    buffer_load_dwordx4 v49, s[8:11], s35 offen offset:1024 sc1 lds
    buffer_load_dwordx4 v50, s[8:11], s35 offen offset:2048 sc1 lds
    buffer_load_dwordx4 v51, s[8:11], s35 offen offset:3072 sc1 lds
    s_waitcnt vmcnt(18)
    s_barrier
    s_add_u32 m0, s43, 49152
    s_mov_b32 s35, 36864
    buffer_load_dwordx4 v52, s[8:11], s35 offen offset:0  lds
    buffer_load_dwordx4 v53, s[8:11], s35 offen offset:1024  lds
    buffer_load_dwordx4 v54, s[8:11], s35 offen offset:2048  lds
    buffer_load_dwordx4 v55, s[8:11], s35 offen offset:3072  lds
    s_add_u32 m0, s43, 53248
    s_mov_b32 s35, 36864
    buffer_load_dwordx4 v56, s[8:11], s35 offen offset:0  lds
    s_add_u32 m0, s42, 49152
    s_mov_b32 s35, 36864
    buffer_load_dwordx4 v48, s[8:11], s35 offen offset:0 sc1 lds
    buffer_load_dwordx4 v49, s[8:11], s35 offen offset:1024 sc1 lds
    buffer_load_dwordx4 v50, s[8:11], s35 offen offset:2048 sc1 lds
    buffer_load_dwordx4 v51, s[8:11], s35 offen offset:3072 sc1 lds
    s_waitcnt vmcnt(18)
    s_barrier
    s_add_u32 m0, s43, 126976
    s_mov_b32 s35, 40960
    buffer_load_dwordx4 v52, s[8:11], s35 offen offset:0  lds
    buffer_load_dwordx4 v53, s[8:11], s35 offen offset:1024  lds
    buffer_load_dwordx4 v54, s[8:11], s35 offen offset:2048  lds
    buffer_load_dwordx4 v55, s[8:11], s35 offen offset:3072  lds
    s_add_u32 m0, s43, 131072
    s_mov_b32 s35, 40960
    buffer_load_dwordx4 v56, s[8:11], s35 offen offset:0  lds
    s_add_u32 m0, s42, 126976
    s_mov_b32 s35, 40960
    buffer_load_dwordx4 v48, s[8:11], s35 offen offset:0 sc1 lds
    buffer_load_dwordx4 v49, s[8:11], s35 offen offset:1024 sc1 lds
    buffer_load_dwordx4 v50, s[8:11], s35 offen offset:2048 sc1 lds
    buffer_load_dwordx4 v51, s[8:11], s35 offen offset:3072 sc1 lds
    s_waitcnt vmcnt(18)
    s_barrier
    s_add_u32 m0, s43, 0
    s_mov_b32 s35, 45056
    buffer_load_dwordx4 v52, s[8:11], s35 offen offset:0  lds
    buffer_load_dwordx4 v53, s[8:11], s35 offen offset:1024  lds
    buffer_load_dwordx4 v54, s[8:11], s35 offen offset:2048  lds
    buffer_load_dwordx4 v55, s[8:11], s35 offen offset:3072  lds
    s_add_u32 m0, s43, 4096
    s_mov_b32 s35, 45056
    buffer_load_dwordx4 v56, s[8:11], s35 offen offset:0  lds
    s_add_u32 m0, s42, 0
    s_mov_b32 s35, 45056
    buffer_load_dwordx4 v48, s[8:11], s35 offen offset:0 sc1 lds
    buffer_load_dwordx4 v49, s[8:11], s35 offen offset:1024 sc1 lds
    buffer_load_dwordx4 v50, s[8:11], s35 offen offset:2048 sc1 lds
    buffer_load_dwordx4 v51, s[8:11], s35 offen offset:3072 sc1 lds
    s_waitcnt vmcnt(18)
    s_barrier
    s_add_u32 m0, s43, 90112
    s_mov_b32 s35, 49152
    buffer_load_dwordx4 v52, s[8:11], s35 offen offset:0  lds
    buffer_load_dwordx4 v53, s[8:11], s35 offen offset:1024  lds
    buffer_load_dwordx4 v54, s[8:11], s35 offen offset:2048  lds
    buffer_load_dwordx4 v55, s[8:11], s35 offen offset:3072  lds
    s_add_u32 m0, s43, 94208
    s_mov_b32 s35, 49152
    buffer_load_dwordx4 v56, s[8:11], s35 offen offset:0  lds
    s_add_u32 m0, s42, 90112
    s_mov_b32 s35, 49152
    buffer_load_dwordx4 v48, s[8:11], s35 offen offset:0 sc1 lds
    buffer_load_dwordx4 v49, s[8:11], s35 offen offset:1024 sc1 lds
    buffer_load_dwordx4 v50, s[8:11], s35 offen offset:2048 sc1 lds
    buffer_load_dwordx4 v51, s[8:11], s35 offen offset:3072 sc1 lds
    s_waitcnt vmcnt(18)
    s_barrier
    s_add_u32 m0, s43, 49152
    s_mov_b32 s35, 53248
    buffer_load_dwordx4 v52, s[8:11], s35 offen offset:0  lds
    buffer_load_dwordx4 v53, s[8:11], s35 offen offset:1024  lds
    buffer_load_dwordx4 v54, s[8:11], s35 offen offset:2048  lds
    buffer_load_dwordx4 v55, s[8:11], s35 offen offset:3072  lds
    s_add_u32 m0, s43, 53248
    s_mov_b32 s35, 53248
    buffer_load_dwordx4 v56, s[8:11], s35 offen offset:0  lds
    s_add_u32 m0, s42, 49152
    s_mov_b32 s35, 53248
    buffer_load_dwordx4 v48, s[8:11], s35 offen offset:0 sc1 lds
    buffer_load_dwordx4 v49, s[8:11], s35 offen offset:1024 sc1 lds
    buffer_load_dwordx4 v50, s[8:11], s35 offen offset:2048 sc1 lds
    buffer_load_dwordx4 v51, s[8:11], s35 offen offset:3072 sc1 lds
    s_waitcnt vmcnt(18)
    s_barrier
    s_waitcnt vmcnt(9)
    s_barrier
    s_cmp_eq_u32 s19, 0
    s_cbranch_scc1 L_mega_4
    s_waitcnt vmcnt(0)
    s_barrier
    s_endpgm
L_mega_4:
    s_add_u32 m0, s41, 0
    s_mov_b32 s35, 0
    buffer_load_dwordx4 v36, s[8:11], s35 offen offset:0  lds
    buffer_load_dwordx4 v37, s[8:11], s35 offen offset:1024  lds
    buffer_load_dwordx4 v38, s[8:11], s35 offen offset:2048  lds
    buffer_load_dwordx4 v39, s[8:11], s35 offen offset:3072  lds
    s_add_u32 m0, s41, 126976
    s_mov_b32 s35, 2048
    buffer_load_dwordx4 v36, s[8:11], s35 offen offset:0  lds
    buffer_load_dwordx4 v37, s[8:11], s35 offen offset:1024  lds
    buffer_load_dwordx4 v38, s[8:11], s35 offen offset:2048  lds
    buffer_load_dwordx4 v39, s[8:11], s35 offen offset:3072  lds
    s_waitcnt vmcnt(8)
    s_barrier
    s_add_u32 m0, s41, 90112
    s_mov_b32 s35, 4096
    buffer_load_dwordx4 v36, s[8:11], s35 offen offset:0  lds
    buffer_load_dwordx4 v37, s[8:11], s35 offen offset:1024  lds
    buffer_load_dwordx4 v38, s[8:11], s35 offen offset:2048  lds
    buffer_load_dwordx4 v39, s[8:11], s35 offen offset:3072  lds
    s_mov_b32 s19, 0x2000000
    s_add_u32 s22, s22, 320
    s_mul_i32 s28, s13, 163840
    s_and_b32 s29, s12, 1
    s_mul_i32 s29, s29, 81920
    s_add_u32 s28, s28, s29
    s_lshr_b32 s29, s12, 1
    s_lshl_b32 s29, s29, 10
    s_add_u32 s28, s28, s29
    s_add_u32 s28, s28, 0x1000000
    v_add_u32 v32, s28, v3
    s_add_u32 s28, s28, 19456
    v_add_u32 v33, s28, v3
    s_add_u32 s28, s28, 19456
    v_add_u32 v34, s28, v3
    s_add_u32 s28, s28, 19456
    v_add_u32 v35, s28, v3
    s_barrier
    s_barrier
    s_add_u32 m0, s40, 0
    s_mov_b32 s35, 0
    buffer_load_dwordx4 v32, s[8:11], s35 offen offset:0 sc1 lds
    buffer_load_dwordx4 v33, s[8:11], s35 offen offset:1024 sc1 lds
    buffer_load_dwordx4 v34, s[8:11], s35 offen offset:2048 sc1 lds
    buffer_load_dwordx4 v35, s[8:11], s35 offen offset:3072 sc1 lds
    s_add_u32 m0, s40, 126976
    s_mov_b32 s35, 2048
    buffer_load_dwordx4 v32, s[8:11], s35 offen offset:0 sc1 lds
    buffer_load_dwordx4 v33, s[8:11], s35 offen offset:1024 sc1 lds
    buffer_load_dwordx4 v34, s[8:11], s35 offen offset:2048 sc1 lds
    buffer_load_dwordx4 v35, s[8:11], s35 offen offset:3072 sc1 lds
    s_waitcnt vmcnt(4)
    s_barrier
    s_add_u32 m0, s40, 90112
    s_mov_b32 s35, 4096
    buffer_load_dwordx4 v32, s[8:11], s35 offen offset:0 sc1 lds
    buffer_load_dwordx4 v33, s[8:11], s35 offen offset:1024 sc1 lds
    buffer_load_dwordx4 v34, s[8:11], s35 offen offset:2048 sc1 lds
    buffer_load_dwordx4 v35, s[8:11], s35 offen offset:3072 sc1 lds
    s_add_u32 m0, s41, 49152
    s_mov_b32 s35, 6144
    buffer_load_dwordx4 v36, s[8:11], s35 offen offset:0  lds
    buffer_load_dwordx4 v37, s[8:11], s35 offen offset:1024  lds
    buffer_load_dwordx4 v38, s[8:11], s35 offen offset:2048  lds
    buffer_load_dwordx4 v39, s[8:11], s35 offen offset:3072  lds
    s_add_u32 m0, s40, 49152
    s_mov_b32 s35, 6144
    buffer_load_dwordx4 v32, s[8:11], s35 offen offset:0 sc1 lds
    buffer_load_dwordx4 v33, s[8:11], s35 offen offset:1024 sc1 lds
    buffer_load_dwordx4 v34, s[8:11], s35 offen offset:2048 sc1 lds
    buffer_load_dwordx4 v35, s[8:11], s35 offen offset:3072 sc1 lds
    s_waitcnt vmcnt(12)
    s_barrier
    s_add_u32 m0, s41, 0
    s_mov_b32 s35, 8192
    buffer_load_dwordx4 v36, s[8:11], s35 offen offset:0  lds
    buffer_load_dwordx4 v37, s[8:11], s35 offen offset:1024  lds
    buffer_load_dwordx4 v38, s[8:11], s35 offen offset:2048  lds
    buffer_load_dwordx4 v39, s[8:11], s35 offen offset:3072  lds
    s_add_u32 m0, s40, 0
    s_mov_b32 s35, 8192
    buffer_load_dwordx4 v32, s[8:11], s35 offen offset:0 sc1 lds
    buffer_load_dwordx4 v33, s[8:11], s35 offen offset:1024 sc1 lds
    buffer_load_dwordx4 v34, s[8:11], s35 offen offset:2048 sc1 lds
    buffer_load_dwordx4 v35, s[8:11], s35 offen offset:3072 sc1 lds
    s_waitcnt vmcnt(16)
    s_barrier
    s_add_u32 m0, s41, 126976
    s_mov_b32 s35, 10240
    buffer_load_dwordx4 v36, s[8:11], s35 offen offset:0  lds
    buffer_load_dwordx4 v37, s[8:11], s35 offen offset:1024  lds
    buffer_load_dwordx4 v38, s[8:11], s35 offen offset:2048  lds
    buffer_load_dwordx4 v39, s[8:11], s35 offen offset:3072  lds
    s_add_u32 m0, s40, 126976
    s_mov_b32 s35, 10240
    buffer_load_dwordx4 v32, s[8:11], s35 offen offset:0 sc1 lds
    buffer_load_dwordx4 v33, s[8:11], s35 offen offset:1024 sc1 lds
    buffer_load_dwordx4 v34, s[8:11], s35 offen offset:2048 sc1 lds
    buffer_load_dwordx4 v35, s[8:11], s35 offen offset:3072 sc1 lds
    s_waitcnt vmcnt(16)
    s_barrier
    s_add_u32 m0, s41, 90112
    s_mov_b32 s35, 12288
    buffer_load_dwordx4 v36, s[8:11], s35 offen offset:0  lds
    buffer_load_dwordx4 v37, s[8:11], s35 offen offset:1024  lds
    buffer_load_dwordx4 v38, s[8:11], s35 offen offset:2048  lds
    buffer_load_dwordx4 v39, s[8:11], s35 offen offset:3072  lds
    s_add_u32 m0, s40, 90112
    s_mov_b32 s35, 12288
    buffer_load_dwordx4 v32, s[8:11], s35 offen offset:0 sc1 lds
    buffer_load_dwordx4 v33, s[8:11], s35 offen offset:1024 sc1 lds
    buffer_load_dwordx4 v34, s[8:11], s35 offen offset:2048 sc1 lds
    buffer_load_dwordx4 v35, s[8:11], s35 offen offset:3072 sc1 lds
    s_waitcnt vmcnt(16)
    s_barrier
    s_add_u32 m0, s41, 49152
    s_mov_b32 s35, 14336
    buffer_load_dwordx4 v36, s[8:11], s35 offen offset:0  lds
    buffer_load_dwordx4 v37, s[8:11], s35 offen offset:1024  lds
    buffer_load_dwordx4 v38, s[8:11], s35 offen offset:2048  lds
    buffer_load_dwordx4 v39, s[8:11], s35 offen offset:3072  lds
    s_add_u32 m0, s40, 49152
    s_mov_b32 s35, 14336
    buffer_load_dwordx4 v32, s[8:11], s35 offen offset:0 sc1 lds
    buffer_load_dwordx4 v33, s[8:11], s35 offen offset:1024 sc1 lds
    buffer_load_dwordx4 v34, s[8:11], s35 offen offset:2048 sc1 lds
    buffer_load_dwordx4 v35, s[8:11], s35 offen offset:3072 sc1 lds
    s_waitcnt vmcnt(16)
    s_barrier
    s_add_u32 m0, s41, 0
    s_mov_b32 s35, 16384
    buffer_load_dwordx4 v36, s[8:11], s35 offen offset:0  lds
    buffer_load_dwordx4 v37, s[8:11], s35 offen offset:1024  lds
    buffer_load_dwordx4 v38, s[8:11], s35 offen offset:2048  lds
    buffer_load_dwordx4 v39, s[8:11], s35 offen offset:3072  lds
    s_add_u32 m0, s40, 0
    s_mov_b32 s35, 16384
    buffer_load_dwordx4 v32, s[8:11], s35 offen offset:0 sc1 lds
    buffer_load_dwordx4 v33, s[8:11], s35 offen offset:1024 sc1 lds
    buffer_load_dwordx4 v34, s[8:11], s35 offen offset:2048 sc1 lds
    buffer_load_dwordx4 v35, s[8:11], s35 offen offset:3072 sc1 lds
    s_waitcnt vmcnt(16)
    s_barrier
    s_add_u32 m0, s41, 126976
    s_mov_b32 s35, 18432
    buffer_load_dwordx4 v36, s[8:11], s35 offen offset:0  lds
    buffer_load_dwordx4 v37, s[8:11], s35 offen offset:1024  lds
    buffer_load_dwordx4 v38, s[8:11], s35 offen offset:2048  lds
    buffer_load_dwordx4 v39, s[8:11], s35 offen offset:3072  lds
    s_add_u32 m0, s40, 126976
    s_mov_b32 s35, 18432
    buffer_load_dwordx4 v32, s[8:11], s35 offen offset:0 sc1 lds
    buffer_load_dwordx4 v33, s[8:11], s35 offen offset:1024 sc1 lds
    buffer_load_dwordx4 v34, s[8:11], s35 offen offset:2048 sc1 lds
    buffer_load_dwordx4 v35, s[8:11], s35 offen offset:3072 sc1 lds
    s_waitcnt vmcnt(16)
    s_barrier
    s_waitcnt vmcnt(8)
    s_barrier
    s_waitcnt vmcnt(0)
    s_barrier
    s_branch L_l_attn
L_l_done:
    s_waitcnt vmcnt(0)
    s_endpgm
L_comp:
    v_and_b32 v7, 15, v1
    v_lshrrev_b32 v8, 4, v1
    v_lshlrev_b32 v2, 7, v1
    s_cmp_lg_u32 s12, 3
    s_cbranch_scc1 L_c_layer2
    v_mov_b64 v[10:11], 0
    v_lshlrev_b32 v9, 3, v1
    s_lshl_b32 s28, s2, 9
    s_add_u32 s28, s28, 0xc00000
    buffer_store_dwordx2 v[10:11], v9, s[8:11], s28 offen sc0 sc1
    s_getreg_b32 s46, hwreg(HW_REG_XCC_ID)
    s_and_b32 s46, s46, 7
    s_lshl_b32 s28, s46, 5
    v_mov_b32 v2, 1
    s_waitcnt vmcnt(0)
    s_mov_b64 exec, 1
    buffer_atomic_add v2, off, s[76:79], s28 sc0 sc1
    s_mov_b64 exec, -1
    s_branch L_c_layer2
L_c_layer:
    s_barrier
    v_lshlrev_b32 v9, 15, v8
    v_lshl_add_u32 v9, v7, 3, v9
    s_lshl_b32 s28, s13, 2
    s_add_u32 s28, s28, s12
    s_lshl_b32 s28, s28, 8
    s_add_u32 s28, s28, 0x1280000
    s_add_u32 s29, s28, 16384
    buffer_load_dwordx2 v[248:249], v9, s[8:11], s28 offen offset:0 sc1
    buffer_load_dwordx2 v[250:251], v9, s[8:11], s29 offen offset:0 sc1
    buffer_load_dwordx2 v[252:253], v9, s[8:11], s28 offen offset:128 sc1
    buffer_load_dwordx2 v[254:255], v9, s[8:11], s29 offen offset:128 sc1
L_c_layer2:
    s_cmp_ge_u32 s14, 11
    s_cbranch_scc1 L_c_v
    v_and_b32 v9, 7, v7
    v_lshrrev_b32 v12, 3, v7
    v_lshl_add_u32 v9, v12, 4, v9
    v_lshrrev_b32 v12, 1, v8
    v_mul_u32_u24 v12, 163840, v12
    v_and_b32 v13, 1, v8
    v_lshl_add_u32 v12, v13, 9, v12
    v_lshl_add_u32 v12, v9, 4, v12
    v_mul_u32_u24 v13, 163840, v8
    v_lshl_add_u32 v13, v7, 4, v13
    s_mul_i32 s28, s14, 983040
    s_mul_i32 s29, s13, 10240
    s_add_u32 s28, s28, s29
    s_add_u32 s28, s28, s19
    s_add_u32 s28, s28, 0x1600000
    s_lshl_b32 s29, s12, 10
    s_add_u32 s30, s28, s29
    s_and_b32 s29, s12, 1
    s_lshl_b32 s29, s29, 9
    s_add_u32 s31, s28, s29
    s_lshr_b32 s29, s12, 1
    s_lshl_b32 s29, s29, 8
    s_add_u32 s31, s31, s29
    s_add_u32 s31, s31, 4096
    s_add_u32 s29, s31, 655360
    s_cmp_eq_u32 s19, 0
    s_cbranch_scc1 L_raw_qk
    s_mul_i32 s28, s12, 2048
    v_add_u32 v27, 0x0, v3
    v_add_u32 v4, s28, v27
    v_add_u32 v28, 0x1f000, v3
    v_add_u32 v5, s28, v28
    v_add_u32 v29, 0x16000, v3
    v_add_u32 v6, s28, v29
    v_add_u32 v31, 0xc000, v3
    v_add_u32 v30, s28, v31
    s_mov_b32 s36, 2
    s_barrier
    ds_read_b128 v[96:99], v4 offset:0
    ds_read_b128 v[100:103], v4 offset:1024
    ds_read_b128 v[112:115], v27 offset:8192
    ds_read_b128 v[116:119], v27 offset:9216
    ds_read_b128 v[120:123], v27 offset:10240
    ds_read_b128 v[124:127], v27 offset:11264
    ds_read_b128 v[128:131], v27 offset:12288
    ds_read_b128 v[132:135], v27 offset:13312
    ds_read_b128 v[136:139], v27 offset:14336
    ds_read_b128 v[140:143], v27 offset:15360
    s_waitcnt lgkmcnt(0)
    v_mfma_f32_16x16x32_bf16 v[32:35], v[112:115], v[96:99], 0
    ds_read_b128 v[104:107], v4 offset:16384
    v_mfma_f32_16x16x32_bf16 v[64:67], v[112:115], v[100:103], 0
    ds_read_b128 v[108:111], v4 offset:17408
    v_mfma_f32_16x16x32_bf16 v[36:39], v[116:119], v[96:99], 0
    ds_read_b128 v[144:147], v27 offset:24576
    v_mfma_f32_16x16x32_bf16 v[68:71], v[116:119], v[100:103], 0
    ds_read_b128 v[148:151], v27 offset:25600
    v_mfma_f32_16x16x32_bf16 v[40:43], v[120:123], v[96:99], 0
    ds_read_b128 v[152:155], v27 offset:26624
    v_mfma_f32_16x16x32_bf16 v[72:75], v[120:123], v[100:103], 0
    ds_read_b128 v[156:159], v27 offset:27648
    v_mfma_f32_16x16x32_bf16 v[44:47], v[124:127], v[96:99], 0
    ds_read_b128 v[160:163], v27 offset:28672
    v_mfma_f32_16x16x32_bf16 v[76:79], v[124:127], v[100:103], 0
    ds_read_b128 v[164:167], v27 offset:29696
    v_mfma_f32_16x16x32_bf16 v[48:51], v[128:131], v[96:99], 0
    ds_read_b128 v[168:171], v27 offset:30720
    v_mfma_f32_16x16x32_bf16 v[80:83], v[128:131], v[100:103], 0
    ds_read_b128 v[172:175], v27 offset:31744
    v_mfma_f32_16x16x32_bf16 v[52:55], v[132:135], v[96:99], 0
    v_mfma_f32_16x16x32_bf16 v[84:87], v[132:135], v[100:103], 0
    v_mfma_f32_16x16x32_bf16 v[56:59], v[136:139], v[96:99], 0
    v_mfma_f32_16x16x32_bf16 v[88:91], v[136:139], v[100:103], 0
    v_mfma_f32_16x16x32_bf16 v[60:63], v[140:143], v[96:99], 0
    v_mfma_f32_16x16x32_bf16 v[92:95], v[140:143], v[100:103], 0
    s_waitcnt lgkmcnt(0)
    s_barrier
    v_mfma_f32_16x16x32_bf16 v[32:35], v[144:147], v[104:107], v[32:35]
    ds_read_b128 v[96:99], v5 offset:0
    v_mfma_f32_16x16x32_bf16 v[64:67], v[144:147], v[108:111], v[64:67]
    ds_read_b128 v[100:103], v5 offset:1024
    v_mfma_f32_16x16x32_bf16 v[36:39], v[148:151], v[104:107], v[36:39]
    ds_read_b128 v[112:115], v28 offset:8192
    v_mfma_f32_16x16x32_bf16 v[68:71], v[148:151], v[108:111], v[68:71]
    ds_read_b128 v[116:119], v28 offset:9216
    v_mfma_f32_16x16x32_bf16 v[40:43], v[152:155], v[104:107], v[40:43]
    ds_read_b128 v[120:123], v28 offset:10240
    v_mfma_f32_16x16x32_bf16 v[72:75], v[152:155], v[108:111], v[72:75]
    ds_read_b128 v[124:127], v28 offset:11264
    v_mfma_f32_16x16x32_bf16 v[44:47], v[156:159], v[104:107], v[44:47]
    ds_read_b128 v[128:131], v28 offset:12288
    v_mfma_f32_16x16x32_bf16 v[76:79], v[156:159], v[108:111], v[76:79]
    ds_read_b128 v[132:135], v28 offset:13312
    v_mfma_f32_16x16x32_bf16 v[48:51], v[160:163], v[104:107], v[48:51]
    ds_read_b128 v[136:139], v28 offset:14336
    v_mfma_f32_16x16x32_bf16 v[80:83], v[160:163], v[108:111], v[80:83]
    ds_read_b128 v[140:143], v28 offset:15360
    v_mfma_f32_16x16x32_bf16 v[52:55], v[164:167], v[104:107], v[52:55]
    v_mfma_f32_16x16x32_bf16 v[84:87], v[164:167], v[108:111], v[84:87]
    v_mfma_f32_16x16x32_bf16 v[56:59], v[168:171], v[104:107], v[56:59]
    v_mfma_f32_16x16x32_bf16 v[88:91], v[168:171], v[108:111], v[88:91]
    v_mfma_f32_16x16x32_bf16 v[60:63], v[172:175], v[104:107], v[60:63]
    v_mfma_f32_16x16x32_bf16 v[92:95], v[172:175], v[108:111], v[92:95]
    .p2align 4
L_mega_5:
    s_waitcnt lgkmcnt(0)
    v_mfma_f32_16x16x32_bf16 v[32:35], v[112:115], v[96:99], v[32:35]
    ds_read_b128 v[104:107], v5 offset:16384
    v_mfma_f32_16x16x32_bf16 v[64:67], v[112:115], v[100:103], v[64:67]
    ds_read_b128 v[108:111], v5 offset:17408
    v_mfma_f32_16x16x32_bf16 v[36:39], v[116:119], v[96:99], v[36:39]
    ds_read_b128 v[144:147], v28 offset:24576
    v_mfma_f32_16x16x32_bf16 v[68:71], v[116:119], v[100:103], v[68:71]
    ds_read_b128 v[148:151], v28 offset:25600
    v_mfma_f32_16x16x32_bf16 v[40:43], v[120:123], v[96:99], v[40:43]
    ds_read_b128 v[152:155], v28 offset:26624
    v_mfma_f32_16x16x32_bf16 v[72:75], v[120:123], v[100:103], v[72:75]
    ds_read_b128 v[156:159], v28 offset:27648
    v_mfma_f32_16x16x32_bf16 v[44:47], v[124:127], v[96:99], v[44:47]
    ds_read_b128 v[160:163], v28 offset:28672
    v_mfma_f32_16x16x32_bf16 v[76:79], v[124:127], v[100:103], v[76:79]
    ds_read_b128 v[164:167], v28 offset:29696
    v_mfma_f32_16x16x32_bf16 v[48:51], v[128:131], v[96:99], v[48:51]
    ds_read_b128 v[168:171], v28 offset:30720
    v_mfma_f32_16x16x32_bf16 v[80:83], v[128:131], v[100:103], v[80:83]
    ds_read_b128 v[172:175], v28 offset:31744
    v_mfma_f32_16x16x32_bf16 v[52:55], v[132:135], v[96:99], v[52:55]
    v_mfma_f32_16x16x32_bf16 v[84:87], v[132:135], v[100:103], v[84:87]
    v_mfma_f32_16x16x32_bf16 v[56:59], v[136:139], v[96:99], v[56:59]
    v_mfma_f32_16x16x32_bf16 v[88:91], v[136:139], v[100:103], v[88:91]
    v_mfma_f32_16x16x32_bf16 v[60:63], v[140:143], v[96:99], v[60:63]
    v_mfma_f32_16x16x32_bf16 v[92:95], v[140:143], v[100:103], v[92:95]
    s_waitcnt lgkmcnt(0)
    s_barrier
    v_mfma_f32_16x16x32_bf16 v[32:35], v[144:147], v[104:107], v[32:35]
    ds_read_b128 v[96:99], v6 offset:0
    v_mfma_f32_16x16x32_bf16 v[64:67], v[144:147], v[108:111], v[64:67]
    ds_read_b128 v[100:103], v6 offset:1024
    v_mfma_f32_16x16x32_bf16 v[36:39], v[148:151], v[104:107], v[36:39]
    ds_read_b128 v[112:115], v29 offset:8192
    v_mfma_f32_16x16x32_bf16 v[68:71], v[148:151], v[108:111], v[68:71]
    ds_read_b128 v[116:119], v29 offset:9216
    v_mfma_f32_16x16x32_bf16 v[40:43], v[152:155], v[104:107], v[40:43]
    ds_read_b128 v[120:123], v29 offset:10240
    v_mfma_f32_16x16x32_bf16 v[72:75], v[152:155], v[108:111], v[72:75]
    ds_read_b128 v[124:127], v29 offset:11264
    v_mfma_f32_16x16x32_bf16 v[44:47], v[156:159], v[104:107], v[44:47]
    ds_read_b128 v[128:131], v29 offset:12288
    v_mfma_f32_16x16x32_bf16 v[76:79], v[156:159], v[108:111], v[76:79]
    ds_read_b128 v[132:135], v29 offset:13312
    v_mfma_f32_16x16x32_bf16 v[48:51], v[160:163], v[104:107], v[48:51]
    ds_read_b128 v[136:139], v29 offset:14336
    v_mfma_f32_16x16x32_bf16 v[80:83], v[160:163], v[108:111], v[80:83]
    ds_read_b128 v[140:143], v29 offset:15360
    v_mfma_f32_16x16x32_bf16 v[52:55], v[164:167], v[104:107], v[52:55]
    v_mfma_f32_16x16x32_bf16 v[84:87], v[164:167], v[108:111], v[84:87]
    v_mfma_f32_16x16x32_bf16 v[56:59], v[168:171], v[104:107], v[56:59]
    v_mfma_f32_16x16x32_bf16 v[88:91], v[168:171], v[108:111], v[88:91]
    v_mfma_f32_16x16x32_bf16 v[60:63], v[172:175], v[104:107], v[60:63]
    v_mfma_f32_16x16x32_bf16 v[92:95], v[172:175], v[108:111], v[92:95]
    s_waitcnt lgkmcnt(0)
    v_mfma_f32_16x16x32_bf16 v[32:35], v[112:115], v[96:99], v[32:35]
    ds_read_b128 v[104:107], v6 offset:16384
    v_mfma_f32_16x16x32_bf16 v[64:67], v[112:115], v[100:103], v[64:67]
    ds_read_b128 v[108:111], v6 offset:17408
    v_mfma_f32_16x16x32_bf16 v[36:39], v[116:119], v[96:99], v[36:39]
    ds_read_b128 v[144:147], v29 offset:24576
    v_mfma_f32_16x16x32_bf16 v[68:71], v[116:119], v[100:103], v[68:71]
    ds_read_b128 v[148:151], v29 offset:25600
    v_mfma_f32_16x16x32_bf16 v[40:43], v[120:123], v[96:99], v[40:43]
    ds_read_b128 v[152:155], v29 offset:26624
    v_mfma_f32_16x16x32_bf16 v[72:75], v[120:123], v[100:103], v[72:75]
    ds_read_b128 v[156:159], v29 offset:27648
    v_mfma_f32_16x16x32_bf16 v[44:47], v[124:127], v[96:99], v[44:47]
    ds_read_b128 v[160:163], v29 offset:28672
    v_mfma_f32_16x16x32_bf16 v[76:79], v[124:127], v[100:103], v[76:79]
    ds_read_b128 v[164:167], v29 offset:29696
    v_mfma_f32_16x16x32_bf16 v[48:51], v[128:131], v[96:99], v[48:51]
    ds_read_b128 v[168:171], v29 offset:30720
    v_mfma_f32_16x16x32_bf16 v[80:83], v[128:131], v[100:103], v[80:83]
    ds_read_b128 v[172:175], v29 offset:31744
    v_mfma_f32_16x16x32_bf16 v[52:55], v[132:135], v[96:99], v[52:55]
    v_mfma_f32_16x16x32_bf16 v[84:87], v[132:135], v[100:103], v[84:87]
    v_mfma_f32_16x16x32_bf16 v[56:59], v[136:139], v[96:99], v[56:59]
    v_mfma_f32_16x16x32_bf16 v[88:91], v[136:139], v[100:103], v[88:91]
    v_mfma_f32_16x16x32_bf16 v[60:63], v[140:143], v[96:99], v[60:63]
    v_mfma_f32_16x16x32_bf16 v[92:95], v[140:143], v[100:103], v[92:95]
    s_waitcnt lgkmcnt(0)
    s_barrier
    v_mfma_f32_16x16x32_bf16 v[32:35], v[144:147], v[104:107], v[32:35]
    ds_read_b128 v[96:99], v30 offset:0
    v_mfma_f32_16x16x32_bf16 v[64:67], v[144:147], v[108:111], v[64:67]
    ds_read_b128 v[100:103], v30 offset:1024
    v_mfma_f32_16x16x32_bf16 v[36:39], v[148:151], v[104:107], v[36:39]
    ds_read_b128 v[112:115], v31 offset:8192
    v_mfma_f32_16x16x32_bf16 v[68:71], v[148:151], v[108:111], v[68:71]
    ds_read_b128 v[116:119], v31 offset:9216
    v_mfma_f32_16x16x32_bf16 v[40:43], v[152:155], v[104:107], v[40:43]
    ds_read_b128 v[120:123], v31 offset:10240
    v_mfma_f32_16x16x32_bf16 v[72:75], v[152:155], v[108:111], v[72:75]
    ds_read_b128 v[124:127], v31 offset:11264
    v_mfma_f32_16x16x32_bf16 v[44:47], v[156:159], v[104:107], v[44:47]
    ds_read_b128 v[128:131], v31 offset:12288
    v_mfma_f32_16x16x32_bf16 v[76:79], v[156:159], v[108:111], v[76:79]
    ds_read_b128 v[132:135], v31 offset:13312
    v_mfma_f32_16x16x32_bf16 v[48:51], v[160:163], v[104:107], v[48:51]
    ds_read_b128 v[136:139], v31 offset:14336
    v_mfma_f32_16x16x32_bf16 v[80:83], v[160:163], v[108:111], v[80:83]
    ds_read_b128 v[140:143], v31 offset:15360
    v_mfma_f32_16x16x32_bf16 v[52:55], v[164:167], v[104:107], v[52:55]
    v_mfma_f32_16x16x32_bf16 v[84:87], v[164:167], v[108:111], v[84:87]
    v_mfma_f32_16x16x32_bf16 v[56:59], v[168:171], v[104:107], v[56:59]
    v_mfma_f32_16x16x32_bf16 v[88:91], v[168:171], v[108:111], v[88:91]
    v_mfma_f32_16x16x32_bf16 v[60:63], v[172:175], v[104:107], v[60:63]
    v_mfma_f32_16x16x32_bf16 v[92:95], v[172:175], v[108:111], v[92:95]
    s_waitcnt lgkmcnt(0)
    v_mfma_f32_16x16x32_bf16 v[32:35], v[112:115], v[96:99], v[32:35]
    ds_read_b128 v[104:107], v30 offset:16384
    v_mfma_f32_16x16x32_bf16 v[64:67], v[112:115], v[100:103], v[64:67]
    ds_read_b128 v[108:111], v30 offset:17408
    v_mfma_f32_16x16x32_bf16 v[36:39], v[116:119], v[96:99], v[36:39]
    ds_read_b128 v[144:147], v31 offset:24576
    v_mfma_f32_16x16x32_bf16 v[68:71], v[116:119], v[100:103], v[68:71]
    ds_read_b128 v[148:151], v31 offset:25600
    v_mfma_f32_16x16x32_bf16 v[40:43], v[120:123], v[96:99], v[40:43]
    ds_read_b128 v[152:155], v31 offset:26624
    v_mfma_f32_16x16x32_bf16 v[72:75], v[120:123], v[100:103], v[72:75]
    ds_read_b128 v[156:159], v31 offset:27648
    v_mfma_f32_16x16x32_bf16 v[44:47], v[124:127], v[96:99], v[44:47]
    ds_read_b128 v[160:163], v31 offset:28672
    v_mfma_f32_16x16x32_bf16 v[76:79], v[124:127], v[100:103], v[76:79]
    ds_read_b128 v[164:167], v31 offset:29696
    v_mfma_f32_16x16x32_bf16 v[48:51], v[128:131], v[96:99], v[48:51]
    ds_read_b128 v[168:171], v31 offset:30720
    v_mfma_f32_16x16x32_bf16 v[80:83], v[128:131], v[100:103], v[80:83]
    ds_read_b128 v[172:175], v31 offset:31744
    v_mfma_f32_16x16x32_bf16 v[52:55], v[132:135], v[96:99], v[52:55]
    v_mfma_f32_16x16x32_bf16 v[84:87], v[132:135], v[100:103], v[84:87]
    v_mfma_f32_16x16x32_bf16 v[56:59], v[136:139], v[96:99], v[56:59]
    v_mfma_f32_16x16x32_bf16 v[88:91], v[136:139], v[100:103], v[88:91]
    v_mfma_f32_16x16x32_bf16 v[60:63], v[140:143], v[96:99], v[60:63]
    v_mfma_f32_16x16x32_bf16 v[92:95], v[140:143], v[100:103], v[92:95]
    s_waitcnt lgkmcnt(0)
    s_barrier
    v_mfma_f32_16x16x32_bf16 v[32:35], v[144:147], v[104:107], v[32:35]
    ds_read_b128 v[96:99], v4 offset:0
    v_mfma_f32_16x16x32_bf16 v[64:67], v[144:147], v[108:111], v[64:67]
    ds_read_b128 v[100:103], v4 offset:1024
    v_mfma_f32_16x16x32_bf16 v[36:39], v[148:151], v[104:107], v[36:39]
    ds_read_b128 v[112:115], v27 offset:8192
    v_mfma_f32_16x16x32_bf16 v[68:71], v[148:151], v[108:111], v[68:71]
    ds_read_b128 v[116:119], v27 offset:9216
    v_mfma_f32_16x16x32_bf16 v[40:43], v[152:155], v[104:107], v[40:43]
    ds_read_b128 v[120:123], v27 offset:10240
    v_mfma_f32_16x16x32_bf16 v[72:75], v[152:155], v[108:111], v[72:75]
    ds_read_b128 v[124:127], v27 offset:11264
    v_mfma_f32_16x16x32_bf16 v[44:47], v[156:159], v[104:107], v[44:47]
    ds_read_b128 v[128:131], v27 offset:12288
    v_mfma_f32_16x16x32_bf16 v[76:79], v[156:159], v[108:111], v[76:79]
    ds_read_b128 v[132:135], v27 offset:13312
    v_mfma_f32_16x16x32_bf16 v[48:51], v[160:163], v[104:107], v[48:51]
    ds_read_b128 v[136:139], v27 offset:14336
    v_mfma_f32_16x16x32_bf16 v[80:83], v[160:163], v[108:111], v[80:83]
    ds_read_b128 v[140:143], v27 offset:15360
    v_mfma_f32_16x16x32_bf16 v[52:55], v[164:167], v[104:107], v[52:55]
    v_mfma_f32_16x16x32_bf16 v[84:87], v[164:167], v[108:111], v[84:87]
    v_mfma_f32_16x16x32_bf16 v[56:59], v[168:171], v[104:107], v[56:59]
    v_mfma_f32_16x16x32_bf16 v[88:91], v[168:171], v[108:111], v[88:91]
    v_mfma_f32_16x16x32_bf16 v[60:63], v[172:175], v[104:107], v[60:63]
    v_mfma_f32_16x16x32_bf16 v[92:95], v[172:175], v[108:111], v[92:95]
    s_waitcnt lgkmcnt(0)
    v_mfma_f32_16x16x32_bf16 v[32:35], v[112:115], v[96:99], v[32:35]
    ds_read_b128 v[104:107], v4 offset:16384
    v_mfma_f32_16x16x32_bf16 v[64:67], v[112:115], v[100:103], v[64:67]
    ds_read_b128 v[108:111], v4 offset:17408
    v_mfma_f32_16x16x32_bf16 v[36:39], v[116:119], v[96:99], v[36:39]
    ds_read_b128 v[144:147], v27 offset:24576
    v_mfma_f32_16x16x32_bf16 v[68:71], v[116:119], v[100:103], v[68:71]
    ds_read_b128 v[148:151], v27 offset:25600
    v_mfma_f32_16x16x32_bf16 v[40:43], v[120:123], v[96:99], v[40:43]
    ds_read_b128 v[152:155], v27 offset:26624
    v_mfma_f32_16x16x32_bf16 v[72:75], v[120:123], v[100:103], v[72:75]
    ds_read_b128 v[156:159], v27 offset:27648
    v_mfma_f32_16x16x32_bf16 v[44:47], v[124:127], v[96:99], v[44:47]
    ds_read_b128 v[160:163], v27 offset:28672
    v_mfma_f32_16x16x32_bf16 v[76:79], v[124:127], v[100:103], v[76:79]
    ds_read_b128 v[164:167], v27 offset:29696
    v_mfma_f32_16x16x32_bf16 v[48:51], v[128:131], v[96:99], v[48:51]
    ds_read_b128 v[168:171], v27 offset:30720
    v_mfma_f32_16x16x32_bf16 v[80:83], v[128:131], v[100:103], v[80:83]
    ds_read_b128 v[172:175], v27 offset:31744
    v_mfma_f32_16x16x32_bf16 v[52:55], v[132:135], v[96:99], v[52:55]
    v_mfma_f32_16x16x32_bf16 v[84:87], v[132:135], v[100:103], v[84:87]
    v_mfma_f32_16x16x32_bf16 v[56:59], v[136:139], v[96:99], v[56:59]
    v_mfma_f32_16x16x32_bf16 v[88:91], v[136:139], v[100:103], v[88:91]
    v_mfma_f32_16x16x32_bf16 v[60:63], v[140:143], v[96:99], v[60:63]
    v_mfma_f32_16x16x32_bf16 v[92:95], v[140:143], v[100:103], v[92:95]
    s_waitcnt lgkmcnt(0)
    s_barrier
    v_mfma_f32_16x16x32_bf16 v[32:35], v[144:147], v[104:107], v[32:35]
    ds_read_b128 v[96:99], v5 offset:0
    v_mfma_f32_16x16x32_bf16 v[64:67], v[144:147], v[108:111], v[64:67]
    ds_read_b128 v[100:103], v5 offset:1024
    v_mfma_f32_16x16x32_bf16 v[36:39], v[148:151], v[104:107], v[36:39]
    ds_read_b128 v[112:115], v28 offset:8192
    v_mfma_f32_16x16x32_bf16 v[68:71], v[148:151], v[108:111], v[68:71]
    ds_read_b128 v[116:119], v28 offset:9216
    v_mfma_f32_16x16x32_bf16 v[40:43], v[152:155], v[104:107], v[40:43]
    ds_read_b128 v[120:123], v28 offset:10240
    v_mfma_f32_16x16x32_bf16 v[72:75], v[152:155], v[108:111], v[72:75]
    ds_read_b128 v[124:127], v28 offset:11264
    v_mfma_f32_16x16x32_bf16 v[44:47], v[156:159], v[104:107], v[44:47]
    ds_read_b128 v[128:131], v28 offset:12288
    v_mfma_f32_16x16x32_bf16 v[76:79], v[156:159], v[108:111], v[76:79]
    ds_read_b128 v[132:135], v28 offset:13312
    v_mfma_f32_16x16x32_bf16 v[48:51], v[160:163], v[104:107], v[48:51]
    ds_read_b128 v[136:139], v28 offset:14336
    v_mfma_f32_16x16x32_bf16 v[80:83], v[160:163], v[108:111], v[80:83]
    ds_read_b128 v[140:143], v28 offset:15360
    v_mfma_f32_16x16x32_bf16 v[52:55], v[164:167], v[104:107], v[52:55]
    s_sub_u32 s36, s36, 1
    v_mfma_f32_16x16x32_bf16 v[84:87], v[164:167], v[108:111], v[84:87]
    s_cmp_lg_u32 s36, 0
    v_mfma_f32_16x16x32_bf16 v[56:59], v[168:171], v[104:107], v[56:59]
    v_mfma_f32_16x16x32_bf16 v[88:91], v[168:171], v[108:111], v[88:91]
    v_mfma_f32_16x16x32_bf16 v[60:63], v[172:175], v[104:107], v[60:63]
    v_mfma_f32_16x16x32_bf16 v[92:95], v[172:175], v[108:111], v[92:95]
    s_cbranch_scc1 L_mega_5
    s_waitcnt lgkmcnt(0)
    v_mfma_f32_16x16x32_bf16 v[32:35], v[112:115], v[96:99], v[32:35]
    ds_read_b128 v[104:107], v5 offset:16384
    s_waitcnt vmcnt(0)
    v_add_f32 v248, v248, v250
    v_mfma_f32_16x16x32_bf16 v[64:67], v[112:115], v[100:103], v[64:67]
    ds_read_b128 v[108:111], v5 offset:17408
    v_add_f32 v249, v249, v251
    v_add_f32 v252, v252, v254
    v_mfma_f32_16x16x32_bf16 v[36:39], v[116:119], v[96:99], v[36:39]
    ds_read_b128 v[144:147], v28 offset:24576
    v_add_f32 v253, v253, v255
    v_mov_b32 v250, v248
    v_mfma_f32_16x16x32_bf16 v[68:71], v[116:119], v[100:103], v[68:71]
    ds_read_b128 v[148:151], v28 offset:25600
    v_mov_b32 v251, v249
    v_mov_b32 v254, v252
    v_mfma_f32_16x16x32_bf16 v[40:43], v[120:123], v[96:99], v[40:43]
    ds_read_b128 v[152:155], v28 offset:26624
    v_mov_b32 v255, v253
    s_nop 1
    v_mfma_f32_16x16x32_bf16 v[72:75], v[120:123], v[100:103], v[72:75]
    ds_read_b128 v[156:159], v28 offset:27648
    v_permlane32_swap_b32 v248, v250
    v_permlane32_swap_b32 v249, v251
    v_mfma_f32_16x16x32_bf16 v[44:47], v[124:127], v[96:99], v[44:47]
    ds_read_b128 v[160:163], v28 offset:28672
    v_permlane32_swap_b32 v252, v254
    v_permlane32_swap_b32 v253, v255
    v_mfma_f32_16x16x32_bf16 v[76:79], v[124:127], v[100:103], v[76:79]
    ds_read_b128 v[164:167], v28 offset:29696
    s_nop 0
    v_add_f32 v248, v248, v250
    v_mfma_f32_16x16x32_bf16 v[48:51], v[128:131], v[96:99], v[48:51]
    ds_read_b128 v[168:171], v28 offset:30720
    v_add_f32 v249, v249, v251
    v_add_f32 v252, v252, v254
    v_mfma_f32_16x16x32_bf16 v[80:83], v[128:131], v[100:103], v[80:83]
    ds_read_b128 v[172:175], v28 offset:31744
    v_add_f32 v253, v253, v255
    v_mov_b32 v250, v248
    v_mfma_f32_16x16x32_bf16 v[52:55], v[132:135], v[96:99], v[52:55]
    v_mov_b32 v251, v249
    v_mov_b32 v254, v252
    v_mfma_f32_16x16x32_bf16 v[84:87], v[132:135], v[100:103], v[84:87]
    v_mov_b32 v255, v253
    s_nop 1
    v_mfma_f32_16x16x32_bf16 v[56:59], v[136:139], v[96:99], v[56:59]
    v_permlane16_swap_b32 v248, v250
    v_permlane16_swap_b32 v249, v251
    v_mfma_f32_16x16x32_bf16 v[88:91], v[136:139], v[100:103], v[88:91]
    v_permlane16_swap_b32 v252, v254
    v_permlane16_swap_b32 v253, v255
    v_mfma_f32_16x16x32_bf16 v[60:63], v[140:143], v[96:99], v[60:63]
    s_nop 0
    v_add_f32 v248, v248, v250
    v_mfma_f32_16x16x32_bf16 v[92:95], v[140:143], v[100:103], v[92:95]
    v_add_f32 v249, v249, v251
    v_add_f32 v252, v252, v254
    s_waitcnt lgkmcnt(0)
    v_mfma_f32_16x16x32_bf16 v[32:35], v[144:147], v[104:107], v[32:35]
    v_add_f32 v253, v253, v255
    v_mul_f32 v248, 0xbacccccd, v248
    v_mfma_f32_16x16x32_bf16 v[64:67], v[144:147], v[108:111], v[64:67]
    v_mul_f32 v249, 0x3acccccd, v249
    v_cvt_pk_bf16_f32 v250, v248, v248
    v_mfma_f32_16x16x32_bf16 v[36:39], v[148:151], v[104:107], v[36:39]
    v_fma_f32 v249, -v248, v248, v249
    v_and_b32 v251, 0xffff0000, v250
    v_mfma_f32_16x16x32_bf16 v[68:71], v[148:151], v[108:111], v[68:71]
    v_max_f32 v249, 0, v249
    v_sub_f32 v251, v248, v251
    v_mfma_f32_16x16x32_bf16 v[40:43], v[152:155], v[104:107], v[40:43]
    v_add_f32 v249, 0x3727c5ac, v249
    v_cvt_pk_bf16_f32 v251, v251, v251
    v_mfma_f32_16x16x32_bf16 v[72:75], v[152:155], v[108:111], v[72:75]
    v_rsq_f32 v10, v249
    v_mul_f32 v252, 0xbacccccd, v252
    v_mfma_f32_16x16x32_bf16 v[44:47], v[156:159], v[104:107], v[44:47]
    v_mul_f32 v253, 0x3acccccd, v253
    v_cvt_pk_bf16_f32 v254, v252, v252
    v_mfma_f32_16x16x32_bf16 v[76:79], v[156:159], v[108:111], v[76:79]
    v_fma_f32 v253, -v252, v252, v253
    v_and_b32 v255, 0xffff0000, v254
    v_mfma_f32_16x16x32_bf16 v[48:51], v[160:163], v[104:107], v[48:51]
    v_max_f32 v253, 0, v253
    v_sub_f32 v255, v252, v255
    v_mfma_f32_16x16x32_bf16 v[80:83], v[160:163], v[108:111], v[80:83]
    v_add_f32 v253, 0x3727c5ac, v253
    v_cvt_pk_bf16_f32 v255, v255, v255
    v_mfma_f32_16x16x32_bf16 v[52:55], v[164:167], v[104:107], v[52:55]
    v_rsq_f32 v11, v253
    s_nop 0
    v_mfma_f32_16x16x32_bf16 v[84:87], v[164:167], v[108:111], v[84:87]
    v_mul_f32 v10, 0x3f1166db, v10
    v_mul_f32 v11, 0x3f1166db, v11
    v_mfma_f32_16x16x32_bf16 v[56:59], v[168:171], v[104:107], v[56:59]
    v_mfma_f32_16x16x32_bf16 v[88:91], v[168:171], v[108:111], v[88:91]
    v_mfma_f32_16x16x32_bf16 v[60:63], v[172:175], v[104:107], v[60:63]
    v_mfma_f32_16x16x32_bf16 v[92:95], v[172:175], v[108:111], v[92:95]
    s_nop 2
L_join_qk:
    v_mfma_f32_16x16x16_bf16 v[32:35], v[216:217], v[250:251], v[32:35]
    v_mfma_f32_16x16x16_bf16 v[64:67], v[216:217], v[254:255], v[64:67]
    v_mfma_f32_16x16x16_bf16 v[36:39], v[218:219], v[250:251], v[36:39]
    v_mfma_f32_16x16x16_bf16 v[68:71], v[218:219], v[254:255], v[68:71]
    v_mfma_f32_16x16x16_bf16 v[40:43], v[220:221], v[250:251], v[40:43]
    v_mfma_f32_16x16x16_bf16 v[72:75], v[220:221], v[254:255], v[72:75]
    v_mfma_f32_16x16x16_bf16 v[44:47], v[222:223], v[250:251], v[44:47]
    v_mfma_f32_16x16x16_bf16 v[76:79], v[222:223], v[254:255], v[76:79]
    v_mfma_f32_16x16x16_bf16 v[56:59], v[228:229], v[250:251], v[56:59]
    v_mfma_f32_16x16x16_bf16 v[88:91], v[228:229], v[254:255], v[88:91]
    v_pk_mul_f32 v[32:33], v[32:33], v[10:11] op_sel:[0,0] op_sel_hi:[1,0]
    v_pk_mul_f32 v[34:35], v[34:35], v[10:11] op_sel:[0,0] op_sel_hi:[1,0]
    v_cvt_pk_bf16_f32 v96, v32, v33
    v_cvt_pk_bf16_f32 v97, v34, v35
    v_pk_mul_f32 v[36:37], v[36:37], v[10:11] op_sel:[0,0] op_sel_hi:[1,0]
    v_pk_mul_f32 v[38:39], v[38:39], v[10:11] op_sel:[0,0] op_sel_hi:[1,0]
    v_cvt_pk_bf16_f32 v98, v36, v37
    v_cvt_pk_bf16_f32 v99, v38, v39
    buffer_store_dwordx4 v[96:99], v12, s[8:11], s30 offen offset:0 sc0 sc1
    v_mfma_f32_16x16x16_bf16 v[48:51], v[224:225], v[250:251], v[48:51]
    v_mfma_f32_16x16x16_bf16 v[80:83], v[224:225], v[254:255], v[80:83]
    v_mfma_f32_16x16x16_bf16 v[52:55], v[226:227], v[250:251], v[52:55]
    v_mfma_f32_16x16x16_bf16 v[84:87], v[226:227], v[254:255], v[84:87]
    v_pk_mul_f32 v[64:65], v[64:65], v[10:11] op_sel:[0,1] op_sel_hi:[1,1]
    v_pk_mul_f32 v[66:67], v[66:67], v[10:11] op_sel:[0,1] op_sel_hi:[1,1]
    v_cvt_pk_bf16_f32 v100, v64, v65
    v_cvt_pk_bf16_f32 v101, v66, v67
    v_pk_mul_f32 v[68:69], v[68:69], v[10:11] op_sel:[0,1] op_sel_hi:[1,1]
    v_pk_mul_f32 v[70:71], v[70:71], v[10:11] op_sel:[0,1] op_sel_hi:[1,1]
    v_cvt_pk_bf16_f32 v102, v68, v69
    v_cvt_pk_bf16_f32 v103, v70, v71
    buffer_store_dwordx4 v[100:103], v12, s[8:11], s30 offen offset:128 sc0 sc1
    v_mfma_f32_16x16x16_bf16 v[60:63], v[230:231], v[250:251], v[60:63]
    v_mfma_f32_16x16x16_bf16 v[92:95], v[230:231], v[254:255], v[92:95]
    s_add_u32 s30, s30, 327680
    v_pk_mul_f32 v[40:41], v[40:41], v[10:11] op_sel:[0,0] op_sel_hi:[1,0]
    v_pk_mul_f32 v[42:43], v[42:43], v[10:11] op_sel:[0,0] op_sel_hi:[1,0]
    v_cvt_pk_bf16_f32 v104, v40, v41
    v_cvt_pk_bf16_f32 v105, v42, v43
    v_pk_mul_f32 v[44:45], v[44:45], v[10:11] op_sel:[0,0] op_sel_hi:[1,0]
    v_pk_mul_f32 v[46:47], v[46:47], v[10:11] op_sel:[0,0] op_sel_hi:[1,0]
    v_cvt_pk_bf16_f32 v106, v44, v45
    v_cvt_pk_bf16_f32 v107, v46, v47
    buffer_store_dwordx4 v[104:107], v12, s[8:11], s30 offen offset:0 sc0 sc1
    v_pk_mul_f32 v[72:73], v[72:73], v[10:11] op_sel:[0,1] op_sel_hi:[1,1]
    v_pk_mul_f32 v[74:75], v[74:75], v[10:11] op_sel:[0,1] op_sel_hi:[1,1]
    v_cvt_pk_bf16_f32 v108, v72, v73
    v_cvt_pk_bf16_f32 v109, v74, v75
    v_pk_mul_f32 v[76:77], v[76:77], v[10:11] op_sel:[0,1] op_sel_hi:[1,1]
    v_pk_mul_f32 v[78:79], v[78:79], v[10:11] op_sel:[0,1] op_sel_hi:[1,1]
    v_cvt_pk_bf16_f32 v110, v76, v77
    v_cvt_pk_bf16_f32 v111, v78, v79
    buffer_store_dwordx4 v[108:111], v12, s[8:11], s30 offen offset:128 sc0 sc1
    s_add_u32 s30, s30, 327680
    v_pk_mul_f32 v[56:57], v[56:57], v[10:11] op_sel:[0,0] op_sel_hi:[1,0]
    v_pk_mul_f32 v[58:59], v[58:59], v[10:11] op_sel:[0,0] op_sel_hi:[1,0]
    v_cvt_pk_bf16_f32 v120, v56, v57
    v_cvt_pk_bf16_f32 v121, v58, v59
    v_pk_mul_f32 v[88:89], v[88:89], v[10:11] op_sel:[0,1] op_sel_hi:[1,1]
    v_pk_mul_f32 v[90:91], v[90:91], v[10:11] op_sel:[0,1] op_sel_hi:[1,1]
    v_cvt_pk_bf16_f32 v122, v88, v89
    v_cvt_pk_bf16_f32 v123, v90, v91
    buffer_store_dwordx4 v[120:123], v13, s[8:11], s31 offen sc0 sc1
    s_cmp_eq_u32 s14, 10
    s_cbranch_scc1 L_c_qk_skip
    v_pk_mul_f32 v[48:49], v[48:49], v[10:11] op_sel:[0,0] op_sel_hi:[1,0]
    v_pk_mul_f32 v[50:51], v[50:51], v[10:11] op_sel:[0,0] op_sel_hi:[1,0]
    v_cvt_pk_bf16_f32 v112, v48, v49
    v_cvt_pk_bf16_f32 v113, v50, v51
    v_pk_mul_f32 v[52:53], v[52:53], v[10:11] op_sel:[0,0] op_sel_hi:[1,0]
    v_pk_mul_f32 v[54:55], v[54:55], v[10:11] op_sel:[0,0] op_sel_hi:[1,0]
    v_cvt_pk_bf16_f32 v114, v52, v53
    v_cvt_pk_bf16_f32 v115, v54, v55
    buffer_store_dwordx4 v[112:115], v12, s[8:11], s30 offen offset:0 sc0 sc1
    v_pk_mul_f32 v[80:81], v[80:81], v[10:11] op_sel:[0,1] op_sel_hi:[1,1]
    v_pk_mul_f32 v[82:83], v[82:83], v[10:11] op_sel:[0,1] op_sel_hi:[1,1]
    v_cvt_pk_bf16_f32 v116, v80, v81
    v_cvt_pk_bf16_f32 v117, v82, v83
    v_pk_mul_f32 v[84:85], v[84:85], v[10:11] op_sel:[0,1] op_sel_hi:[1,1]
    v_pk_mul_f32 v[86:87], v[86:87], v[10:11] op_sel:[0,1] op_sel_hi:[1,1]
    v_cvt_pk_bf16_f32 v118, v84, v85
    v_cvt_pk_bf16_f32 v119, v86, v87
    buffer_store_dwordx4 v[116:119], v12, s[8:11], s30 offen offset:128 sc0 sc1
    s_add_u32 s30, s30, 327680
    v_pk_mul_f32 v[60:61], v[60:61], v[10:11] op_sel:[0,0] op_sel_hi:[1,0]
    v_pk_mul_f32 v[62:63], v[62:63], v[10:11] op_sel:[0,0] op_sel_hi:[1,0]
    v_cvt_pk_bf16_f32 v124, v60, v61
    v_cvt_pk_bf16_f32 v125, v62, v63
    v_pk_mul_f32 v[92:93], v[92:93], v[10:11] op_sel:[0,1] op_sel_hi:[1,1]
    v_pk_mul_f32 v[94:95], v[94:95], v[10:11] op_sel:[0,1] op_sel_hi:[1,1]
    v_cvt_pk_bf16_f32 v126, v92, v93
    v_cvt_pk_bf16_f32 v127, v94, v95
    s_mov_b64 exec, 0xffffffff
    buffer_store_dwordx4 v[124:127], v13, s[8:11], s29 offen sc0 sc1
    s_mov_b64 exec, -1
L_c_qk_skip:
    v_lshrrev_b32 v9, 3, v1
    v_and_b32 v10, 7, v1
    s_mul_i32 s28, s14, 6
    v_add_u32 v14, s28, v9
    v_and_b32 v12, 31, v14
    v_lshl_add_u32 v12, v12, 3, v10
    v_lshlrev_b32 v12, 9, v12
    s_lshr_b32 s28, s13, 1
    v_cmp_eq_u32 s[30:31], s28, v10
    v_cmp_le_u32 vcc, 32, v14
    s_or_b64 s[30:31], s[30:31], vcc
    v_cmp_gt_u32 vcc, 64, v14
    s_and_b64 s[30:31], s[30:31], vcc
    v_cmp_gt_u32 vcc, 6, v9
    s_and_b64 s[54:55], s[30:31], vcc
    s_branch L_c_attn
L_c_v:
    s_mul_i32 s30, s13, 10240
    s_mul_i32 s29, s12, 1280
    s_add_u32 s30, s30, s29
    s_add_u32 s30, s30, s19
    s_add_u32 s30, s30, 0x1b01400
    s_sub_u32 s29, s14, 11
    s_lshl_b32 s29, s29, 7
    v_mul_u32_u24 v9, 320, v8
    v_add_u32 v10, s29, v7
    v_mul_u32_u24 v12, 3277, v10
    v_lshrrev_b32 v12, 16, v12
    v_mul_u32_u24 v13, 163520, v12
    v_lshl_add_u32 v13, v10, 4, v13
    v_add_u32 v184, v13, v9
    v_add_u32 v10, 16, v10
    v_mul_u32_u24 v12, 3277, v10
    v_lshrrev_b32 v12, 16, v12
    v_mul_u32_u24 v13, 163520, v12
    v_lshl_add_u32 v13, v10, 4, v13
    v_add_u32 v185, v13, v9
    v_add_u32 v10, 16, v10
    v_mul_u32_u24 v12, 3277, v10
    v_lshrrev_b32 v12, 16, v12
    v_mul_u32_u24 v13, 163520, v12
    v_lshl_add_u32 v13, v10, 4, v13
    v_add_u32 v186, v13, v9
    v_add_u32 v10, 16, v10
    v_mul_u32_u24 v12, 3277, v10
    v_lshrrev_b32 v12, 16, v12
    v_mul_u32_u24 v13, 163520, v12
    v_lshl_add_u32 v13, v10, 4, v13
    v_add_u32 v187, v13, v9
    v_add_u32 v10, 16, v10
    v_mul_u32_u24 v12, 3277, v10
    v_lshrrev_b32 v12, 16, v12
    v_mul_u32_u24 v13, 163520, v12
    v_lshl_add_u32 v13, v10, 4, v13
    v_add_u32 v188, v13, v9
    v_add_u32 v10, 16, v10
    v_mul_u32_u24 v12, 3277, v10
    v_lshrrev_b32 v12, 16, v12
    v_mul_u32_u24 v13, 163520, v12
    v_lshl_add_u32 v13, v10, 4, v13
    v_add_u32 v189, v13, v9
    v_add_u32 v10, 16, v10
    v_mul_u32_u24 v12, 3277, v10
    v_lshrrev_b32 v12, 16, v12
    v_mul_u32_u24 v13, 163520, v12
    v_lshl_add_u32 v13, v10, 4, v13
    v_add_u32 v190, v13, v9
    v_add_u32 v10, 16, v10
    v_mul_u32_u24 v12, 3277, v10
    v_lshrrev_b32 v12, 16, v12
    v_mul_u32_u24 v13, 163520, v12
    v_lshl_add_u32 v13, v10, 4, v13
    v_add_u32 v191, v13, v9
    v_add_u32 v10, 16, v10
    s_lshl_b32 s28, s12, 7
    s_add_u32 s28, s28, 159744
    v_lshl_add_u32 v12, v7, 2, s28
    v_lshl_add_u32 v13, v8, 4, s28
    s_cmp_eq_u32 s19, 0
    s_cbranch_scc1 L_raw_v
    s_mul_i32 s28, s12, 2048
    v_add_u32 v27, 0x0, v3
    v_add_u32 v4, s28, v27
    v_add_u32 v28, 0x1f000, v3
    v_add_u32 v5, s28, v28
    v_add_u32 v29, 0x16000, v3
    v_add_u32 v6, s28, v29
    v_add_u32 v31, 0xc000, v3
    v_add_u32 v30, s28, v31
    s_mov_b32 s36, 2
    s_barrier
    ds_read_b128 v[96:99], v4 offset:0
    ds_read_b128 v[100:103], v4 offset:1024
    ds_read_b128 v[112:115], v27 offset:8192
    ds_read_b128 v[116:119], v27 offset:9216
    ds_read_b128 v[120:123], v27 offset:10240
    ds_read_b128 v[124:127], v27 offset:11264
    ds_read_b128 v[128:131], v27 offset:12288
    ds_read_b128 v[132:135], v27 offset:13312
    ds_read_b128 v[136:139], v27 offset:14336
    ds_read_b128 v[140:143], v27 offset:15360
    s_waitcnt lgkmcnt(0)
    v_mfma_f32_16x16x32_bf16 v[32:35], v[96:99], v[112:115], 0
    ds_read_b128 v[104:107], v4 offset:16384
    v_mfma_f32_16x16x32_bf16 v[64:67], v[100:103], v[112:115], 0
    ds_read_b128 v[108:111], v4 offset:17408
    v_mfma_f32_16x16x32_bf16 v[36:39], v[96:99], v[116:119], 0
    ds_read_b128 v[144:147], v27 offset:24576
    v_mfma_f32_16x16x32_bf16 v[68:71], v[100:103], v[116:119], 0
    ds_read_b128 v[148:151], v27 offset:25600
    v_mfma_f32_16x16x32_bf16 v[40:43], v[96:99], v[120:123], 0
    ds_read_b128 v[152:155], v27 offset:26624
    v_mfma_f32_16x16x32_bf16 v[72:75], v[100:103], v[120:123], 0
    ds_read_b128 v[156:159], v27 offset:27648
    v_mfma_f32_16x16x32_bf16 v[44:47], v[96:99], v[124:127], 0
    ds_read_b128 v[160:163], v27 offset:28672
    v_mfma_f32_16x16x32_bf16 v[76:79], v[100:103], v[124:127], 0
    ds_read_b128 v[164:167], v27 offset:29696
    v_mfma_f32_16x16x32_bf16 v[48:51], v[96:99], v[128:131], 0
    ds_read_b128 v[168:171], v27 offset:30720
    v_mfma_f32_16x16x32_bf16 v[80:83], v[100:103], v[128:131], 0
    ds_read_b128 v[172:175], v27 offset:31744
    v_mfma_f32_16x16x32_bf16 v[52:55], v[96:99], v[132:135], 0
    v_mfma_f32_16x16x32_bf16 v[84:87], v[100:103], v[132:135], 0
    v_mfma_f32_16x16x32_bf16 v[56:59], v[96:99], v[136:139], 0
    v_mfma_f32_16x16x32_bf16 v[88:91], v[100:103], v[136:139], 0
    v_mfma_f32_16x16x32_bf16 v[60:63], v[96:99], v[140:143], 0
    v_mfma_f32_16x16x32_bf16 v[92:95], v[100:103], v[140:143], 0
    s_waitcnt lgkmcnt(0)
    s_barrier
    v_mfma_f32_16x16x32_bf16 v[32:35], v[104:107], v[144:147], v[32:35]
    ds_read_b128 v[96:99], v5 offset:0
    v_mfma_f32_16x16x32_bf16 v[64:67], v[108:111], v[144:147], v[64:67]
    ds_read_b128 v[100:103], v5 offset:1024
    v_mfma_f32_16x16x32_bf16 v[36:39], v[104:107], v[148:151], v[36:39]
    ds_read_b128 v[112:115], v28 offset:8192
    v_mfma_f32_16x16x32_bf16 v[68:71], v[108:111], v[148:151], v[68:71]
    ds_read_b128 v[116:119], v28 offset:9216
    v_mfma_f32_16x16x32_bf16 v[40:43], v[104:107], v[152:155], v[40:43]
    ds_read_b128 v[120:123], v28 offset:10240
    v_mfma_f32_16x16x32_bf16 v[72:75], v[108:111], v[152:155], v[72:75]
    ds_read_b128 v[124:127], v28 offset:11264
    v_mfma_f32_16x16x32_bf16 v[44:47], v[104:107], v[156:159], v[44:47]
    ds_read_b128 v[128:131], v28 offset:12288
    v_mfma_f32_16x16x32_bf16 v[76:79], v[108:111], v[156:159], v[76:79]
    ds_read_b128 v[132:135], v28 offset:13312
    v_mfma_f32_16x16x32_bf16 v[48:51], v[104:107], v[160:163], v[48:51]
    ds_read_b128 v[136:139], v28 offset:14336
    v_mfma_f32_16x16x32_bf16 v[80:83], v[108:111], v[160:163], v[80:83]
    ds_read_b128 v[140:143], v28 offset:15360
    v_mfma_f32_16x16x32_bf16 v[52:55], v[104:107], v[164:167], v[52:55]
    v_mfma_f32_16x16x32_bf16 v[84:87], v[108:111], v[164:167], v[84:87]
    v_mfma_f32_16x16x32_bf16 v[56:59], v[104:107], v[168:171], v[56:59]
    v_mfma_f32_16x16x32_bf16 v[88:91], v[108:111], v[168:171], v[88:91]
    v_mfma_f32_16x16x32_bf16 v[60:63], v[104:107], v[172:175], v[60:63]
    v_mfma_f32_16x16x32_bf16 v[92:95], v[108:111], v[172:175], v[92:95]
    .p2align 4
L_mega_6:
    s_waitcnt lgkmcnt(0)
    v_mfma_f32_16x16x32_bf16 v[32:35], v[96:99], v[112:115], v[32:35]
    ds_read_b128 v[104:107], v5 offset:16384
    v_mfma_f32_16x16x32_bf16 v[64:67], v[100:103], v[112:115], v[64:67]
    ds_read_b128 v[108:111], v5 offset:17408
    v_mfma_f32_16x16x32_bf16 v[36:39], v[96:99], v[116:119], v[36:39]
    ds_read_b128 v[144:147], v28 offset:24576
    v_mfma_f32_16x16x32_bf16 v[68:71], v[100:103], v[116:119], v[68:71]
    ds_read_b128 v[148:151], v28 offset:25600
    v_mfma_f32_16x16x32_bf16 v[40:43], v[96:99], v[120:123], v[40:43]
    ds_read_b128 v[152:155], v28 offset:26624
    v_mfma_f32_16x16x32_bf16 v[72:75], v[100:103], v[120:123], v[72:75]
    ds_read_b128 v[156:159], v28 offset:27648
    v_mfma_f32_16x16x32_bf16 v[44:47], v[96:99], v[124:127], v[44:47]
    ds_read_b128 v[160:163], v28 offset:28672
    v_mfma_f32_16x16x32_bf16 v[76:79], v[100:103], v[124:127], v[76:79]
    ds_read_b128 v[164:167], v28 offset:29696
    v_mfma_f32_16x16x32_bf16 v[48:51], v[96:99], v[128:131], v[48:51]
    ds_read_b128 v[168:171], v28 offset:30720
    v_mfma_f32_16x16x32_bf16 v[80:83], v[100:103], v[128:131], v[80:83]
    ds_read_b128 v[172:175], v28 offset:31744
    v_mfma_f32_16x16x32_bf16 v[52:55], v[96:99], v[132:135], v[52:55]
    v_mfma_f32_16x16x32_bf16 v[84:87], v[100:103], v[132:135], v[84:87]
    v_mfma_f32_16x16x32_bf16 v[56:59], v[96:99], v[136:139], v[56:59]
    v_mfma_f32_16x16x32_bf16 v[88:91], v[100:103], v[136:139], v[88:91]
    v_mfma_f32_16x16x32_bf16 v[60:63], v[96:99], v[140:143], v[60:63]
    v_mfma_f32_16x16x32_bf16 v[92:95], v[100:103], v[140:143], v[92:95]
    s_waitcnt lgkmcnt(0)
    s_barrier
    v_mfma_f32_16x16x32_bf16 v[32:35], v[104:107], v[144:147], v[32:35]
    ds_read_b128 v[96:99], v6 offset:0
    v_mfma_f32_16x16x32_bf16 v[64:67], v[108:111], v[144:147], v[64:67]
    ds_read_b128 v[100:103], v6 offset:1024
    v_mfma_f32_16x16x32_bf16 v[36:39], v[104:107], v[148:151], v[36:39]
    ds_read_b128 v[112:115], v29 offset:8192
    v_mfma_f32_16x16x32_bf16 v[68:71], v[108:111], v[148:151], v[68:71]
    ds_read_b128 v[116:119], v29 offset:9216
    v_mfma_f32_16x16x32_bf16 v[40:43], v[104:107], v[152:155], v[40:43]
    ds_read_b128 v[120:123], v29 offset:10240
    v_mfma_f32_16x16x32_bf16 v[72:75], v[108:111], v[152:155], v[72:75]
    ds_read_b128 v[124:127], v29 offset:11264
    v_mfma_f32_16x16x32_bf16 v[44:47], v[104:107], v[156:159], v[44:47]
    ds_read_b128 v[128:131], v29 offset:12288
    v_mfma_f32_16x16x32_bf16 v[76:79], v[108:111], v[156:159], v[76:79]
    ds_read_b128 v[132:135], v29 offset:13312
    v_mfma_f32_16x16x32_bf16 v[48:51], v[104:107], v[160:163], v[48:51]
    ds_read_b128 v[136:139], v29 offset:14336
    v_mfma_f32_16x16x32_bf16 v[80:83], v[108:111], v[160:163], v[80:83]
    ds_read_b128 v[140:143], v29 offset:15360
    v_mfma_f32_16x16x32_bf16 v[52:55], v[104:107], v[164:167], v[52:55]
    v_mfma_f32_16x16x32_bf16 v[84:87], v[108:111], v[164:167], v[84:87]
    v_mfma_f32_16x16x32_bf16 v[56:59], v[104:107], v[168:171], v[56:59]
    v_mfma_f32_16x16x32_bf16 v[88:91], v[108:111], v[168:171], v[88:91]
    v_mfma_f32_16x16x32_bf16 v[60:63], v[104:107], v[172:175], v[60:63]
    v_mfma_f32_16x16x32_bf16 v[92:95], v[108:111], v[172:175], v[92:95]
    s_waitcnt lgkmcnt(0)
    v_mfma_f32_16x16x32_bf16 v[32:35], v[96:99], v[112:115], v[32:35]
    ds_read_b128 v[104:107], v6 offset:16384
    v_mfma_f32_16x16x32_bf16 v[64:67], v[100:103], v[112:115], v[64:67]
    ds_read_b128 v[108:111], v6 offset:17408
    v_mfma_f32_16x16x32_bf16 v[36:39], v[96:99], v[116:119], v[36:39]
    ds_read_b128 v[144:147], v29 offset:24576
    v_mfma_f32_16x16x32_bf16 v[68:71], v[100:103], v[116:119], v[68:71]
    ds_read_b128 v[148:151], v29 offset:25600
    v_mfma_f32_16x16x32_bf16 v[40:43], v[96:99], v[120:123], v[40:43]
    ds_read_b128 v[152:155], v29 offset:26624
    v_mfma_f32_16x16x32_bf16 v[72:75], v[100:103], v[120:123], v[72:75]
    ds_read_b128 v[156:159], v29 offset:27648
    v_mfma_f32_16x16x32_bf16 v[44:47], v[96:99], v[124:127], v[44:47]
    ds_read_b128 v[160:163], v29 offset:28672
    v_mfma_f32_16x16x32_bf16 v[76:79], v[100:103], v[124:127], v[76:79]
    ds_read_b128 v[164:167], v29 offset:29696
    v_mfma_f32_16x16x32_bf16 v[48:51], v[96:99], v[128:131], v[48:51]
    ds_read_b128 v[168:171], v29 offset:30720
    v_mfma_f32_16x16x32_bf16 v[80:83], v[100:103], v[128:131], v[80:83]
    ds_read_b128 v[172:175], v29 offset:31744
    v_mfma_f32_16x16x32_bf16 v[52:55], v[96:99], v[132:135], v[52:55]
    v_mfma_f32_16x16x32_bf16 v[84:87], v[100:103], v[132:135], v[84:87]
    v_mfma_f32_16x16x32_bf16 v[56:59], v[96:99], v[136:139], v[56:59]
    v_mfma_f32_16x16x32_bf16 v[88:91], v[100:103], v[136:139], v[88:91]
    v_mfma_f32_16x16x32_bf16 v[60:63], v[96:99], v[140:143], v[60:63]
    v_mfma_f32_16x16x32_bf16 v[92:95], v[100:103], v[140:143], v[92:95]
    s_waitcnt lgkmcnt(0)
    s_barrier
    v_mfma_f32_16x16x32_bf16 v[32:35], v[104:107], v[144:147], v[32:35]
    ds_read_b128 v[96:99], v30 offset:0
    v_mfma_f32_16x16x32_bf16 v[64:67], v[108:111], v[144:147], v[64:67]
    ds_read_b128 v[100:103], v30 offset:1024
    v_mfma_f32_16x16x32_bf16 v[36:39], v[104:107], v[148:151], v[36:39]
    ds_read_b128 v[112:115], v31 offset:8192
    v_mfma_f32_16x16x32_bf16 v[68:71], v[108:111], v[148:151], v[68:71]
    ds_read_b128 v[116:119], v31 offset:9216
    v_mfma_f32_16x16x32_bf16 v[40:43], v[104:107], v[152:155], v[40:43]
    ds_read_b128 v[120:123], v31 offset:10240
    v_mfma_f32_16x16x32_bf16 v[72:75], v[108:111], v[152:155], v[72:75]
    ds_read_b128 v[124:127], v31 offset:11264
    v_mfma_f32_16x16x32_bf16 v[44:47], v[104:107], v[156:159], v[44:47]
    ds_read_b128 v[128:131], v31 offset:12288
    v_mfma_f32_16x16x32_bf16 v[76:79], v[108:111], v[156:159], v[76:79]
    ds_read_b128 v[132:135], v31 offset:13312
    v_mfma_f32_16x16x32_bf16 v[48:51], v[104:107], v[160:163], v[48:51]
    ds_read_b128 v[136:139], v31 offset:14336
    v_mfma_f32_16x16x32_bf16 v[80:83], v[108:111], v[160:163], v[80:83]
    ds_read_b128 v[140:143], v31 offset:15360
    v_mfma_f32_16x16x32_bf16 v[52:55], v[104:107], v[164:167], v[52:55]
    v_mfma_f32_16x16x32_bf16 v[84:87], v[108:111], v[164:167], v[84:87]
    v_mfma_f32_16x16x32_bf16 v[56:59], v[104:107], v[168:171], v[56:59]
    v_mfma_f32_16x16x32_bf16 v[88:91], v[108:111], v[168:171], v[88:91]
    v_mfma_f32_16x16x32_bf16 v[60:63], v[104:107], v[172:175], v[60:63]
    v_mfma_f32_16x16x32_bf16 v[92:95], v[108:111], v[172:175], v[92:95]
    s_waitcnt lgkmcnt(0)
    v_mfma_f32_16x16x32_bf16 v[32:35], v[96:99], v[112:115], v[32:35]
    ds_read_b128 v[104:107], v30 offset:16384
    v_mfma_f32_16x16x32_bf16 v[64:67], v[100:103], v[112:115], v[64:67]
    ds_read_b128 v[108:111], v30 offset:17408
    v_mfma_f32_16x16x32_bf16 v[36:39], v[96:99], v[116:119], v[36:39]
    ds_read_b128 v[144:147], v31 offset:24576
    v_mfma_f32_16x16x32_bf16 v[68:71], v[100:103], v[116:119], v[68:71]
    ds_read_b128 v[148:151], v31 offset:25600
    v_mfma_f32_16x16x32_bf16 v[40:43], v[96:99], v[120:123], v[40:43]
    ds_read_b128 v[152:155], v31 offset:26624
    v_mfma_f32_16x16x32_bf16 v[72:75], v[100:103], v[120:123], v[72:75]
    ds_read_b128 v[156:159], v31 offset:27648
    v_mfma_f32_16x16x32_bf16 v[44:47], v[96:99], v[124:127], v[44:47]
    ds_read_b128 v[160:163], v31 offset:28672
    v_mfma_f32_16x16x32_bf16 v[76:79], v[100:103], v[124:127], v[76:79]
    ds_read_b128 v[164:167], v31 offset:29696
    v_mfma_f32_16x16x32_bf16 v[48:51], v[96:99], v[128:131], v[48:51]
    ds_read_b128 v[168:171], v31 offset:30720
    v_mfma_f32_16x16x32_bf16 v[80:83], v[100:103], v[128:131], v[80:83]
    ds_read_b128 v[172:175], v31 offset:31744
    v_mfma_f32_16x16x32_bf16 v[52:55], v[96:99], v[132:135], v[52:55]
    v_mfma_f32_16x16x32_bf16 v[84:87], v[100:103], v[132:135], v[84:87]
    v_mfma_f32_16x16x32_bf16 v[56:59], v[96:99], v[136:139], v[56:59]
    v_mfma_f32_16x16x32_bf16 v[88:91], v[100:103], v[136:139], v[88:91]
    v_mfma_f32_16x16x32_bf16 v[60:63], v[96:99], v[140:143], v[60:63]
    v_mfma_f32_16x16x32_bf16 v[92:95], v[100:103], v[140:143], v[92:95]
    s_waitcnt lgkmcnt(0)
    s_barrier
    v_mfma_f32_16x16x32_bf16 v[32:35], v[104:107], v[144:147], v[32:35]
    ds_read_b128 v[96:99], v4 offset:0
    v_mfma_f32_16x16x32_bf16 v[64:67], v[108:111], v[144:147], v[64:67]
    ds_read_b128 v[100:103], v4 offset:1024
    v_mfma_f32_16x16x32_bf16 v[36:39], v[104:107], v[148:151], v[36:39]
    ds_read_b128 v[112:115], v27 offset:8192
    v_mfma_f32_16x16x32_bf16 v[68:71], v[108:111], v[148:151], v[68:71]
    ds_read_b128 v[116:119], v27 offset:9216
    v_mfma_f32_16x16x32_bf16 v[40:43], v[104:107], v[152:155], v[40:43]
    ds_read_b128 v[120:123], v27 offset:10240
    v_mfma_f32_16x16x32_bf16 v[72:75], v[108:111], v[152:155], v[72:75]
    ds_read_b128 v[124:127], v27 offset:11264
    v_mfma_f32_16x16x32_bf16 v[44:47], v[104:107], v[156:159], v[44:47]
    ds_read_b128 v[128:131], v27 offset:12288
    v_mfma_f32_16x16x32_bf16 v[76:79], v[108:111], v[156:159], v[76:79]
    ds_read_b128 v[132:135], v27 offset:13312
    v_mfma_f32_16x16x32_bf16 v[48:51], v[104:107], v[160:163], v[48:51]
    ds_read_b128 v[136:139], v27 offset:14336
    v_mfma_f32_16x16x32_bf16 v[80:83], v[108:111], v[160:163], v[80:83]
    ds_read_b128 v[140:143], v27 offset:15360
    v_mfma_f32_16x16x32_bf16 v[52:55], v[104:107], v[164:167], v[52:55]
    v_mfma_f32_16x16x32_bf16 v[84:87], v[108:111], v[164:167], v[84:87]
    v_mfma_f32_16x16x32_bf16 v[56:59], v[104:107], v[168:171], v[56:59]
    v_mfma_f32_16x16x32_bf16 v[88:91], v[108:111], v[168:171], v[88:91]
    v_mfma_f32_16x16x32_bf16 v[60:63], v[104:107], v[172:175], v[60:63]
    v_mfma_f32_16x16x32_bf16 v[92:95], v[108:111], v[172:175], v[92:95]
    s_waitcnt lgkmcnt(0)
    v_mfma_f32_16x16x32_bf16 v[32:35], v[96:99], v[112:115], v[32:35]
    ds_read_b128 v[104:107], v4 offset:16384
    v_mfma_f32_16x16x32_bf16 v[64:67], v[100:103], v[112:115], v[64:67]
    ds_read_b128 v[108:111], v4 offset:17408
    v_mfma_f32_16x16x32_bf16 v[36:39], v[96:99], v[116:119], v[36:39]
    ds_read_b128 v[144:147], v27 offset:24576
    v_mfma_f32_16x16x32_bf16 v[68:71], v[100:103], v[116:119], v[68:71]
    ds_read_b128 v[148:151], v27 offset:25600
    v_mfma_f32_16x16x32_bf16 v[40:43], v[96:99], v[120:123], v[40:43]
    ds_read_b128 v[152:155], v27 offset:26624
    v_mfma_f32_16x16x32_bf16 v[72:75], v[100:103], v[120:123], v[72:75]
    ds_read_b128 v[156:159], v27 offset:27648
    v_mfma_f32_16x16x32_bf16 v[44:47], v[96:99], v[124:127], v[44:47]
    ds_read_b128 v[160:163], v27 offset:28672
    v_mfma_f32_16x16x32_bf16 v[76:79], v[100:103], v[124:127], v[76:79]
    ds_read_b128 v[164:167], v27 offset:29696
    v_mfma_f32_16x16x32_bf16 v[48:51], v[96:99], v[128:131], v[48:51]
    ds_read_b128 v[168:171], v27 offset:30720
    v_mfma_f32_16x16x32_bf16 v[80:83], v[100:103], v[128:131], v[80:83]
    ds_read_b128 v[172:175], v27 offset:31744
    v_mfma_f32_16x16x32_bf16 v[52:55], v[96:99], v[132:135], v[52:55]
    v_mfma_f32_16x16x32_bf16 v[84:87], v[100:103], v[132:135], v[84:87]
    v_mfma_f32_16x16x32_bf16 v[56:59], v[96:99], v[136:139], v[56:59]
    v_mfma_f32_16x16x32_bf16 v[88:91], v[100:103], v[136:139], v[88:91]
    v_mfma_f32_16x16x32_bf16 v[60:63], v[96:99], v[140:143], v[60:63]
    v_mfma_f32_16x16x32_bf16 v[92:95], v[100:103], v[140:143], v[92:95]
    s_waitcnt lgkmcnt(0)
    s_barrier
    v_mfma_f32_16x16x32_bf16 v[32:35], v[104:107], v[144:147], v[32:35]
    ds_read_b128 v[96:99], v5 offset:0
    v_mfma_f32_16x16x32_bf16 v[64:67], v[108:111], v[144:147], v[64:67]
    ds_read_b128 v[100:103], v5 offset:1024
    v_mfma_f32_16x16x32_bf16 v[36:39], v[104:107], v[148:151], v[36:39]
    ds_read_b128 v[112:115], v28 offset:8192
    v_mfma_f32_16x16x32_bf16 v[68:71], v[108:111], v[148:151], v[68:71]
    ds_read_b128 v[116:119], v28 offset:9216
    v_mfma_f32_16x16x32_bf16 v[40:43], v[104:107], v[152:155], v[40:43]
    ds_read_b128 v[120:123], v28 offset:10240
    v_mfma_f32_16x16x32_bf16 v[72:75], v[108:111], v[152:155], v[72:75]
    ds_read_b128 v[124:127], v28 offset:11264
    v_mfma_f32_16x16x32_bf16 v[44:47], v[104:107], v[156:159], v[44:47]
    ds_read_b128 v[128:131], v28 offset:12288
    v_mfma_f32_16x16x32_bf16 v[76:79], v[108:111], v[156:159], v[76:79]
    ds_read_b128 v[132:135], v28 offset:13312
    v_mfma_f32_16x16x32_bf16 v[48:51], v[104:107], v[160:163], v[48:51]
    ds_read_b128 v[136:139], v28 offset:14336
    v_mfma_f32_16x16x32_bf16 v[80:83], v[108:111], v[160:163], v[80:83]
    ds_read_b128 v[140:143], v28 offset:15360
    v_mfma_f32_16x16x32_bf16 v[52:55], v[104:107], v[164:167], v[52:55]
    s_sub_u32 s36, s36, 1
    v_mfma_f32_16x16x32_bf16 v[84:87], v[108:111], v[164:167], v[84:87]
    s_cmp_lg_u32 s36, 0
    v_mfma_f32_16x16x32_bf16 v[56:59], v[104:107], v[168:171], v[56:59]
    v_mfma_f32_16x16x32_bf16 v[88:91], v[108:111], v[168:171], v[88:91]
    v_mfma_f32_16x16x32_bf16 v[60:63], v[104:107], v[172:175], v[60:63]
    v_mfma_f32_16x16x32_bf16 v[92:95], v[108:111], v[172:175], v[92:95]
    s_cbranch_scc1 L_mega_6
    s_waitcnt lgkmcnt(0)
    v_mfma_f32_16x16x32_bf16 v[32:35], v[96:99], v[112:115], v[32:35]
    ds_read_b128 v[104:107], v5 offset:16384
    s_waitcnt vmcnt(0)
    v_add_f32 v248, v248, v250
    v_mfma_f32_16x16x32_bf16 v[64:67], v[100:103], v[112:115], v[64:67]
    ds_read_b128 v[108:111], v5 offset:17408
    v_add_f32 v249, v249, v251
    v_add_f32 v252, v252, v254
    v_mfma_f32_16x16x32_bf16 v[36:39], v[96:99], v[116:119], v[36:39]
    ds_read_b128 v[144:147], v28 offset:24576
    v_add_f32 v253, v253, v255
    v_mov_b32 v250, v248
    v_mfma_f32_16x16x32_bf16 v[68:71], v[100:103], v[116:119], v[68:71]
    ds_read_b128 v[148:151], v28 offset:25600
    v_mov_b32 v251, v249
    v_mov_b32 v254, v252
    v_mfma_f32_16x16x32_bf16 v[40:43], v[96:99], v[120:123], v[40:43]
    ds_read_b128 v[152:155], v28 offset:26624
    v_mov_b32 v255, v253
    s_nop 1
    v_mfma_f32_16x16x32_bf16 v[72:75], v[100:103], v[120:123], v[72:75]
    ds_read_b128 v[156:159], v28 offset:27648
    v_permlane32_swap_b32 v248, v250
    v_permlane32_swap_b32 v249, v251
    v_mfma_f32_16x16x32_bf16 v[44:47], v[96:99], v[124:127], v[44:47]
    ds_read_b128 v[160:163], v28 offset:28672
    v_permlane32_swap_b32 v252, v254
    v_permlane32_swap_b32 v253, v255
    v_mfma_f32_16x16x32_bf16 v[76:79], v[100:103], v[124:127], v[76:79]
    ds_read_b128 v[164:167], v28 offset:29696
    s_nop 0
    v_add_f32 v248, v248, v250
    v_mfma_f32_16x16x32_bf16 v[48:51], v[96:99], v[128:131], v[48:51]
    ds_read_b128 v[168:171], v28 offset:30720
    v_add_f32 v249, v249, v251
    v_add_f32 v252, v252, v254
    v_mfma_f32_16x16x32_bf16 v[80:83], v[100:103], v[128:131], v[80:83]
    ds_read_b128 v[172:175], v28 offset:31744
    v_add_f32 v253, v253, v255
    v_mov_b32 v250, v248
    v_mfma_f32_16x16x32_bf16 v[52:55], v[96:99], v[132:135], v[52:55]
    v_mov_b32 v251, v249
    v_mov_b32 v254, v252
    v_mfma_f32_16x16x32_bf16 v[84:87], v[100:103], v[132:135], v[84:87]
    v_mov_b32 v255, v253
    s_nop 1
    v_mfma_f32_16x16x32_bf16 v[56:59], v[96:99], v[136:139], v[56:59]
    v_permlane16_swap_b32 v248, v250
    v_permlane16_swap_b32 v249, v251
    v_mfma_f32_16x16x32_bf16 v[88:91], v[100:103], v[136:139], v[88:91]
    v_permlane16_swap_b32 v252, v254
    v_permlane16_swap_b32 v253, v255
    v_mfma_f32_16x16x32_bf16 v[60:63], v[96:99], v[140:143], v[60:63]
    s_nop 0
    v_add_f32 v248, v248, v250
    v_mfma_f32_16x16x32_bf16 v[92:95], v[100:103], v[140:143], v[92:95]
    v_add_f32 v249, v249, v251
    v_add_f32 v252, v252, v254
    s_waitcnt lgkmcnt(0)
    v_mfma_f32_16x16x32_bf16 v[32:35], v[104:107], v[144:147], v[32:35]
    v_add_f32 v253, v253, v255
    v_mul_f32 v248, 0xbacccccd, v248
    v_mfma_f32_16x16x32_bf16 v[64:67], v[108:111], v[144:147], v[64:67]
    v_mul_f32 v249, 0x3acccccd, v249
    v_cvt_pk_bf16_f32 v250, v248, v248
    v_mfma_f32_16x16x32_bf16 v[36:39], v[104:107], v[148:151], v[36:39]
    v_fma_f32 v249, -v248, v248, v249
    v_and_b32 v251, 0xffff0000, v250
    v_mfma_f32_16x16x32_bf16 v[68:71], v[108:111], v[148:151], v[68:71]
    v_max_f32 v249, 0, v249
    v_sub_f32 v251, v248, v251
    v_mfma_f32_16x16x32_bf16 v[40:43], v[104:107], v[152:155], v[40:43]
    v_add_f32 v249, 0x3727c5ac, v249
    v_cvt_pk_bf16_f32 v251, v251, v251
    v_mfma_f32_16x16x32_bf16 v[72:75], v[108:111], v[152:155], v[72:75]
    v_rsq_f32 v10, v249
    v_mul_f32 v252, 0xbacccccd, v252
    v_mfma_f32_16x16x32_bf16 v[44:47], v[104:107], v[156:159], v[44:47]
    v_mul_f32 v253, 0x3acccccd, v253
    v_cvt_pk_bf16_f32 v254, v252, v252
    v_mfma_f32_16x16x32_bf16 v[76:79], v[108:111], v[156:159], v[76:79]
    v_fma_f32 v253, -v252, v252, v253
    v_and_b32 v255, 0xffff0000, v254
    v_mfma_f32_16x16x32_bf16 v[48:51], v[104:107], v[160:163], v[48:51]
    v_max_f32 v253, 0, v253
    v_sub_f32 v255, v252, v255
    v_mfma_f32_16x16x32_bf16 v[80:83], v[108:111], v[160:163], v[80:83]
    v_add_f32 v253, 0x3727c5ac, v253
    v_cvt_pk_bf16_f32 v255, v255, v255
    v_mfma_f32_16x16x32_bf16 v[52:55], v[104:107], v[164:167], v[52:55]
    v_rsq_f32 v11, v253
    s_nop 0
    v_mfma_f32_16x16x32_bf16 v[84:87], v[108:111], v[164:167], v[84:87]
    ds_write_b32 v12, v10
    ds_write_b32 v12, v11 offset:64
    v_mfma_f32_16x16x32_bf16 v[56:59], v[104:107], v[168:171], v[56:59]
    v_mfma_f32_16x16x32_bf16 v[88:91], v[108:111], v[168:171], v[88:91]
    v_mfma_f32_16x16x32_bf16 v[60:63], v[104:107], v[172:175], v[60:63]
    v_mfma_f32_16x16x32_bf16 v[92:95], v[108:111], v[172:175], v[92:95]
    s_nop 2
L_join_v:
    s_waitcnt lgkmcnt(0)
    ds_read_b128 v[176:179], v13
    ds_read_b128 v[180:183], v13 offset:64
    v_mfma_f32_16x16x16_bf16 v[32:35], v[250:251], v[216:217], v[32:35]
    v_mfma_f32_16x16x16_bf16 v[64:67], v[254:255], v[216:217], v[64:67]
    v_mfma_f32_16x16x16_bf16 v[36:39], v[250:251], v[218:219], v[36:39]
    v_mfma_f32_16x16x16_bf16 v[68:71], v[254:255], v[218:219], v[68:71]
    v_mfma_f32_16x16x16_bf16 v[40:43], v[250:251], v[220:221], v[40:43]
    v_mfma_f32_16x16x16_bf16 v[72:75], v[254:255], v[220:221], v[72:75]
    v_mfma_f32_16x16x16_bf16 v[44:47], v[250:251], v[222:223], v[44:47]
    v_mfma_f32_16x16x16_bf16 v[76:79], v[254:255], v[222:223], v[76:79]
    v_mfma_f32_16x16x16_bf16 v[48:51], v[250:251], v[224:225], v[48:51]
    v_mfma_f32_16x16x16_bf16 v[80:83], v[254:255], v[224:225], v[80:83]
    v_mfma_f32_16x16x16_bf16 v[52:55], v[250:251], v[226:227], v[52:55]
    v_mfma_f32_16x16x16_bf16 v[84:87], v[254:255], v[226:227], v[84:87]
    v_mfma_f32_16x16x16_bf16 v[56:59], v[250:251], v[228:229], v[56:59]
    v_mfma_f32_16x16x16_bf16 v[88:91], v[254:255], v[228:229], v[88:91]
    v_mfma_f32_16x16x16_bf16 v[60:63], v[250:251], v[230:231], v[60:63]
    v_mfma_f32_16x16x16_bf16 v[92:95], v[254:255], v[230:231], v[92:95]
    s_waitcnt lgkmcnt(0)
    v_pk_mul_f32 v[32:33], v[32:33], v[176:177]
    v_pk_mul_f32 v[34:35], v[34:35], v[178:179]
    v_cvt_pk_bf16_f32 v96, v32, v33
    v_cvt_pk_bf16_f32 v97, v34, v35
    v_pk_mul_f32 v[64:65], v[64:65], v[180:181]
    v_pk_mul_f32 v[66:67], v[66:67], v[182:183]
    v_cvt_pk_bf16_f32 v98, v64, v65
    v_cvt_pk_bf16_f32 v99, v66, v67
    buffer_store_dwordx4 v[96:99], v184, s[8:11], s30 offen sc0 sc1
    v_pk_mul_f32 v[36:37], v[36:37], v[176:177]
    v_pk_mul_f32 v[38:39], v[38:39], v[178:179]
    v_cvt_pk_bf16_f32 v100, v36, v37
    v_cvt_pk_bf16_f32 v101, v38, v39
    v_pk_mul_f32 v[68:69], v[68:69], v[180:181]
    v_pk_mul_f32 v[70:71], v[70:71], v[182:183]
    v_cvt_pk_bf16_f32 v102, v68, v69
    v_cvt_pk_bf16_f32 v103, v70, v71
    buffer_store_dwordx4 v[100:103], v185, s[8:11], s30 offen sc0 sc1
    v_pk_mul_f32 v[40:41], v[40:41], v[176:177]
    v_pk_mul_f32 v[42:43], v[42:43], v[178:179]
    v_cvt_pk_bf16_f32 v104, v40, v41
    v_cvt_pk_bf16_f32 v105, v42, v43
    v_pk_mul_f32 v[72:73], v[72:73], v[180:181]
    v_pk_mul_f32 v[74:75], v[74:75], v[182:183]
    v_cvt_pk_bf16_f32 v106, v72, v73
    v_cvt_pk_bf16_f32 v107, v74, v75
    buffer_store_dwordx4 v[104:107], v186, s[8:11], s30 offen sc0 sc1
    v_pk_mul_f32 v[44:45], v[44:45], v[176:177]
    v_pk_mul_f32 v[46:47], v[46:47], v[178:179]
    v_cvt_pk_bf16_f32 v108, v44, v45
    v_cvt_pk_bf16_f32 v109, v46, v47
    v_pk_mul_f32 v[76:77], v[76:77], v[180:181]
    v_pk_mul_f32 v[78:79], v[78:79], v[182:183]
    v_cvt_pk_bf16_f32 v110, v76, v77
    v_cvt_pk_bf16_f32 v111, v78, v79
    buffer_store_dwordx4 v[108:111], v187, s[8:11], s30 offen sc0 sc1
    v_pk_mul_f32 v[48:49], v[48:49], v[176:177]
    v_pk_mul_f32 v[50:51], v[50:51], v[178:179]
    v_cvt_pk_bf16_f32 v112, v48, v49
    v_cvt_pk_bf16_f32 v113, v50, v51
    v_pk_mul_f32 v[80:81], v[80:81], v[180:181]
    v_pk_mul_f32 v[82:83], v[82:83], v[182:183]
    v_cvt_pk_bf16_f32 v114, v80, v81
    v_cvt_pk_bf16_f32 v115, v82, v83
    buffer_store_dwordx4 v[112:115], v188, s[8:11], s30 offen sc0 sc1
    v_pk_mul_f32 v[52:53], v[52:53], v[176:177]
    v_pk_mul_f32 v[54:55], v[54:55], v[178:179]
    v_cvt_pk_bf16_f32 v116, v52, v53
    v_cvt_pk_bf16_f32 v117, v54, v55
    v_pk_mul_f32 v[84:85], v[84:85], v[180:181]
    v_pk_mul_f32 v[86:87], v[86:87], v[182:183]
    v_cvt_pk_bf16_f32 v118, v84, v85
    v_cvt_pk_bf16_f32 v119, v86, v87
    buffer_store_dwordx4 v[116:119], v189, s[8:11], s30 offen sc0 sc1
    v_pk_mul_f32 v[56:57], v[56:57], v[176:177]
    v_pk_mul_f32 v[58:59], v[58:59], v[178:179]
    v_cvt_pk_bf16_f32 v120, v56, v57
    v_cvt_pk_bf16_f32 v121, v58, v59
    v_pk_mul_f32 v[88:89], v[88:89], v[180:181]
    v_pk_mul_f32 v[90:91], v[90:91], v[182:183]
    v_cvt_pk_bf16_f32 v122, v88, v89
    v_cvt_pk_bf16_f32 v123, v90, v91
    buffer_store_dwordx4 v[120:123], v190, s[8:11], s30 offen sc0 sc1
    v_pk_mul_f32 v[60:61], v[60:61], v[176:177]
    v_pk_mul_f32 v[62:63], v[62:63], v[178:179]
    v_cvt_pk_bf16_f32 v124, v60, v61
    v_cvt_pk_bf16_f32 v125, v62, v63
    v_pk_mul_f32 v[92:93], v[92:93], v[180:181]
    v_pk_mul_f32 v[94:95], v[94:95], v[182:183]
    v_cvt_pk_bf16_f32 v126, v92, v93
    v_cvt_pk_bf16_f32 v127, v94, v95
    buffer_store_dwordx4 v[124:127], v191, s[8:11], s30 offen sc0 sc1
    s_sub_u32 s28, s14, 11
    s_lshl_b32 s30, s28, 7
    s_mul_i32 s31, s30, 3277
    s_lshr_b32 s31, s31, 16
    s_add_u32 s30, s30, 127
    s_mul_i32 s30, s30, 3277
    s_lshr_b32 s30, s30, 16
    s_and_b32 s28, s28, 1
    s_lshl_b32 s28, s28, 7
    s_add_u32 s28, s28, 128
    s_lshl_b32 s29, s31, 12
    s_add_u32 s28, s28, s29
    v_lshl_add_u32 v12, v1, 9, s28
    v_lshrrev_b32 v9, 3, v1
    v_add_u32 v9, s31, v9
    v_cmp_ge_u32 s[54:55], s30, v9
L_c_attn:
    v_mov_b32 v26, v3
    v_and_b32 v29, 31, v1
    v_lshrrev_b32 v30, 5, v1
    v_and_b32 v9, 7, v1
    v_lshlrev_b32 v31, 4, v9
    v_bfe_u32 v9, v1, 4, 1
    v_lshl_add_u32 v31, v9, 7, v31
    v_and_b32 v9, 8, v1
    v_add_u32 v31, v31, v9
    v_lshl_add_u32 v27, v30, 8, v31
    v_cmp_gt_u32 s[30:31], 28, v29
    s_mov_b32 s28, 0xfff00000
    s_mov_b32 s29, 0xfff00000
    v_mul_u32_u24 v9, 192, v30
    v_sub_u32 v9, 192, v9
    v_mov_b32 v10, 144
    v_cndmask_b32 v9, v9, v10, s[30:31]
    s_mov_b32 s30, 0x01100000
    s_mov_b32 s31, 0x01100000
    v_mov_b32 v10, 128
    v_cndmask_b32 v9, v9, v10, s[30:31]
    v_mul_u32_u24 v182, 320, v30
    v_lshl_add_u32 v182, v29, 4, v182
    v_add_u32 v182, 5120, v182
    v_cndmask_b32 v182, v182, v9, s[28:29]
    v_mov_b32 v9, 1280
    v_cndmask_b32 v180, v9, 0, s[28:29]
    v_mov_b32 v9, 6400
    v_cndmask_b32 v181, v9, 0, s[28:29]
    s_mov_b32 s48, 0
    s_mov_b32 s49, -1
    s_mov_b32 s50, 0
    s_movk_i32 s52, 10240
    s_add_u32 s53, s21, 0xc00000
    v_mov_b64 v[80:81], 0
    v_mov_b64 v[82:83], 0
    v_mov_b64 v[84:85], 0
    v_mov_b64 v[86:87], 0
    v_mov_b64 v[88:89], 0
    v_mov_b64 v[90:91], 0
    v_mov_b64 v[92:93], 0
    v_mov_b64 v[94:95], 0
    v_mov_b64 v[96:97], 0
    v_mov_b64 v[98:99], 0
    v_mov_b64 v[100:101], 0
    v_mov_b64 v[102:103], 0
    v_mov_b64 v[104:105], 0
    v_mov_b64 v[106:107], 0
    v_mov_b64 v[108:109], 0
    v_mov_b64 v[110:111], 0
    v_mov_b64 v[148:149], 0
    v_mov_b64 v[176:177], 0
    v_mov_b64 v[150:151], 0
    v_mov_b64 v[178:179], 0
    s_waitcnt vmcnt(0)
    s_xor_b32 s28, s12, 3
    s_or_b32 s28, s28, s19
    s_cbranch_scc1 L_c_tkdone
    v_lshlrev_b32 v198, 5, v1
    s_mov_b32 s29, 0x40000
    s_mov_b64 exec, 0xff
L_c_tkl:
    s_mov_b32 s30, 0
    v_readlane_b32 s31, v199, 0
    s_add_u32 s30, s30, s31
    v_readlane_b32 s31, v199, 1
    s_add_u32 s30, s30, s31
    v_readlane_b32 s31, v199, 2
    s_add_u32 s30, s30, s31
    v_readlane_b32 s31, v199, 3
    s_add_u32 s30, s30, s31
    v_readlane_b32 s31, v199, 4
    s_add_u32 s30, s30, s31
    v_readlane_b32 s31, v199, 5
    s_add_u32 s30, s30, s31
    v_readlane_b32 s31, v199, 6
    s_add_u32 s30, s30, s31
    v_readlane_b32 s31, v199, 7
    s_add_u32 s30, s30, s31
    s_cmp_ge_u32 s30, 256
    s_cbranch_scc1 L_c_tkx
    s_sub_u32 s29, s29, 1
    s_cbranch_scc1 L_c_tkx
    buffer_load_dword v199, v198, s[76:79], 0 offen sc1
    s_waitcnt vmcnt(0)
    s_branch L_c_tkl
L_c_tkx:
    v_cmp_ne_u32 vcc, 32, v199
    v_readfirstlane_b32 s30, v2
    s_lshl_b32 s31, s46, 5
    s_add_u32 s30, s30, s31
    s_add_u32 s30, s30, 256
    s_and_b32 s28, s2, 7
    s_lshl_b32 s28, s28, 5
    s_lshr_b32 s29, s2, 3
    s_add_u32 s28, s28, s29
    s_cmp_eq_u64 vcc, 0
    s_cselect_b32 s28, s30, s28
    s_mov_b64 exec, -1
    v_mov_b32 v198, s28
    v_mov_b32 v199, 0x27400
    ds_write_b32 v199, v198
    s_waitcnt lgkmcnt(0)
L_c_tkdone:
    s_barrier
    s_cmp_lg_u32 s12, 0
    s_cbranch_scc1 L_mega_8
    s_mov_b64 exec, s[54:55]
    buffer_atomic_add v15, v12, s[8:11], s53 offen sc1
    s_mov_b64 exec, -1
L_mega_8:
    s_cmp_lg_u32 s19, 0
    s_cbranch_scc1 L_mega_10
    v_mov_b32 v9, 0x27400
    ds_read_b32 v9, v9
    s_waitcnt lgkmcnt(0)
    v_readfirstlane_b32 s28, v9
    s_lshr_b32 s3, s28, 8
    s_bfe_u32 s30, s28, 0x30005
    s_lshl_b32 s15, s30, 2
    s_and_b32 s29, s28, 3
    s_add_u32 s15, s15, s29
    s_bfe_u32 s16, s28, 0x30002
    s_lshl_b32 s13, s30, 1
    s_and_b32 s29, s28, 1
    s_add_u32 s13, s13, s29
    s_bfe_u32 s14, s28, 0x40001
    s_mov_b32 s17, s15
    s_mov_b32 s18, s16
    v_mul_u32_u24 v9, 1280, v7
    v_lshl_add_u32 v9, v8, 3, v9
    s_lshl_b32 s28, s15, 2
    s_add_u32 s28, s28, s12
    s_mul_i32 s28, s28, 20480
    s_mul_i32 s29, s16, 160
    s_add_u32 s28, s28, s29
    buffer_load_dwordx2 v[16:17], v9, s[68:71], s28 offen offset:0
    buffer_load_dwordx2 v[18:19], v9, s[68:71], s28 offen offset:32
    buffer_load_dwordx2 v[20:21], v9, s[68:71], s28 offen offset:64
    buffer_load_dwordx2 v[22:23], v9, s[68:71], s28 offen offset:96
    buffer_load_dwordx2 v[24:25], v9, s[68:71], s28 offen offset:128
L_mega_10:
    s_mul_i32 s28, s17, 20
    s_add_u32 s29, s28, 19
    s_lshr_b32 s28, s28, 7
    s_lshr_b32 s29, s29, 7
    s_and_b32 s30, s28, s29
    s_or_b32 s31, s28, s29
    s_and_b32 s30, s30, 1
    s_xor_b32 s30, s30, 1
    s_lshl_b32 s30, s30, 4
    s_and_b32 s31, s31, 1
    s_lshl_b32 s31, s31, 4
    s_mov_b32 s60, 18
    s_mov_b32 s61, s30
    s_mov_b32 s62, s31
    s_lshl_b32 s28, s17, 3
    s_add_u32 s28, s28, s18
    s_lshl_b32 s28, s28, 9
    s_add_u32 s53, s21, 0xc00000
    s_add_u32 s94, s28, s53
    s_mul_i32 s28, s17, 163840
    s_add_u32 s28, s28, s19
    s_add_u32 s39, s28, 0x1b00000
    s_add_u32 s38, s39, 4096
    s_lshl_b32 s29, s18, 1
    s_lshr_b32 s30, s12, 1
    s_add_u32 s29, s29, s30
    s_mul_i32 s29, s29, 10240
    s_add_u32 s28, s28, s29
    s_add_u32 s28, s28, 0x1600000
    s_and_b32 s30, s12, 1
    s_lshl_b32 s29, s30, 11
    s_add_u32 s29, s29, s28
    s_lshl_b32 s30, s30, 8
    s_add_u32 s30, s30, s28
    s_add_u32 s30, s30, 4096
    s_cmp_lg_u32 s12, 1
    s_cbranch_scc1 L_mega_7
    s_mov_b32 s95, 0x40000
    s_add_u32 s66, s94, 128
    s_add_u32 s67, s94, 256
L_mega_9:
    s_load_dword s63, s[4:5], s94 glc
    s_load_dword s64, s[4:5], s66 glc
    s_load_dword s65, s[4:5], s67 glc
    s_sub_u32 s95, s95, 1
    s_cbranch_scc1 L_mega_9_x
    s_waitcnt lgkmcnt(0)
    s_xor_b32 s63, s63, s60
    s_xor_b32 s64, s64, s61
    s_xor_b32 s65, s65, s62
    s_or_b32 s63, s63, s64
    s_or_b32 s63, s63, s65
    s_cbranch_scc1 L_mega_9
L_mega_9_x:
    s_waitcnt lgkmcnt(0)
L_mega_7:
    s_barrier
    buffer_load_dwordx4 v[152:155], v3, s[8:11], s39 offen sc1
    buffer_load_dwordx2 v[160:161], v27, s[8:11], s38 offen sc1
    buffer_load_dwordx4 v[32:35], v3, s[8:11], s29 offen offset:0 sc1
    buffer_load_dwordx2 v[40:41], v31, s[8:11], s30 offen offset:0 sc1
    buffer_load_dwordx4 v[36:39], v3, s[8:11], s29 offen offset:1024 sc1
    buffer_load_dwordx2 v[42:43], v31, s[8:11], s30 offen offset:512 sc1
    s_waitcnt vmcnt(0)
    v_cndmask_b32 v44, 0, v40, s[48:49]
    v_cndmask_b32 v40, v40, 0, s[48:49]
    v_cndmask_b32 v45, 0, v41, s[48:49]
    v_cndmask_b32 v41, v41, 0, s[48:49]
    v_cndmask_b32 v46, 0, v42, s[48:49]
    v_cndmask_b32 v42, v42, 0, s[48:49]
    v_cndmask_b32 v47, 0, v43, s[48:49]
    v_cndmask_b32 v43, v43, 0, s[48:49]
    v_mfma_f32_32x32x16_bf16 v[48:63], v[152:155], v[32:35], 0
    v_mfma_f32_32x32x16_bf16 v[64:79], v[152:155], v[36:39], 0
    v_mfma_f32_32x32x8_bf16 v[48:63], v[160:161], v[40:41], v[48:63]
    v_mfma_f32_32x32x8_bf16 v[64:79], v[160:161], v[42:43], v[64:79]
    s_nop 10
    v_max3_f32 v10, v48, v49, v50
    v_max3_f32 v10, v10, v51, v52
    v_max3_f32 v10, v10, v53, v54
    v_max3_f32 v10, v10, v55, v56
    v_max3_f32 v10, v10, v57, v58
    v_max3_f32 v10, v10, v59, v60
    v_max3_f32 v10, v10, v61, v62
    v_max_f32 v10, v10, v63
    v_max3_f32 v11, v64, v65, v66
    v_max3_f32 v11, v11, v67, v68
    v_max3_f32 v11, v11, v69, v70
    v_max3_f32 v11, v11, v71, v72
    v_max3_f32 v11, v11, v73, v74
    v_max3_f32 v11, v11, v75, v76
    v_max3_f32 v11, v11, v77, v78
    v_max_f32 v11, v11, v79
L_attn_start:
    v_mov_b32 v12, v10
    v_mov_b32 v13, v11
    s_nop 1
    v_permlane32_swap_b32 v10, v12
    v_permlane32_swap_b32 v11, v13
    s_nop 1
    v_max_f32 v10, v10, v12
    v_max_f32 v11, v11, v13
    v_sub_f32 v10, 0, v10
    v_sub_f32 v12, 0, v11
    v_mov_b32 v11, v10
    v_mov_b32 v13, v12
    v_mov_b64 v[112:113], v[10:11]
    v_mov_b64 v[114:115], v[10:11]
    v_mov_b64 v[116:117], v[10:11]
    v_mov_b64 v[118:119], v[10:11]
    v_mov_b64 v[120:121], v[10:11]
    v_mov_b64 v[122:123], v[10:11]
    v_mov_b64 v[124:125], v[10:11]
    v_mov_b64 v[126:127], v[10:11]
    v_mov_b32 v28, v182
    s_cmp_lg_u32 s50, 0
    v_mfma_f32_32x32x16_bf16 v[48:63], v[152:155], v[32:35], v[112:127]
    v_mfma_f32_32x32x8_bf16 v[48:63], v[160:161], v[40:41], v[48:63]
    v_mov_b64 v[128:129], v[12:13]
    v_mov_b64 v[130:131], v[12:13]
    v_mov_b64 v[132:133], v[12:13]
    v_mov_b64 v[134:135], v[12:13]
    v_mov_b64 v[136:137], v[12:13]
    v_mov_b64 v[138:139], v[12:13]
    v_mov_b64 v[140:141], v[12:13]
    v_mov_b64 v[142:143], v[12:13]
    s_cselect_b32 s51, 2, 0
    s_cselect_b32 s36, 16, 1
    s_cbranch_scc1 L_attn_nock0
    s_barrier
L_attn_nock0:
    ds_read_b128 v[164:167], v28
    ds_read_b128 v[168:171], v28 offset:640
    ds_read_b128 v[156:159], v26 offset:1024
    ds_read_b64 v[162:163], v27 offset:4608
    v_add_u32 v28, v180, v28
    v_exp_f32 v48, v48
    v_exp_f32 v49, v49
    .p2align 6
L_attn_loop:
    v_mfma_f32_32x32x16_bf16 v[64:79], v[152:155], v[36:39], v[128:143]
    v_exp_f32 v50, v50
    v_exp_f32 v51, v51
    v_exp_f32 v52, v52
    v_exp_f32 v53, v53
    v_cvt_pk_bf16_f32 v144, v48, v49
    v_cvt_pk_bf16_f32 v145, v50, v51
    v_mfma_f32_32x32x8_bf16 v[64:79], v[160:161], v[42:43], v[64:79]
    v_exp_f32 v54, v54
    v_exp_f32 v55, v55
    v_exp_f32 v56, v56
    v_exp_f32 v57, v57
    v_cvt_pk_bf16_f32 v146, v52, v53
    v_cvt_pk_bf16_f32 v147, v54, v55
    v_mfma_f32_32x32x16_bf16 v[96:111], v[176:179], v[148:151], v[96:111]
    s_waitcnt lgkmcnt(0)
    ds_read_b128 v[172:175], v28
    ds_read_b128 v[176:179], v28 offset:640
    ds_read_b128 v[152:155], v26 offset:2048
    v_exp_f32 v58, v58
    v_exp_f32 v59, v59
    v_exp_f32 v60, v60
    v_exp_f32 v61, v61
    v_cvt_pk_bf16_f32 v148, v56, v57
    v_cvt_pk_bf16_f32 v149, v58, v59
    v_mfma_f32_32x32x16_bf16 v[80:95], v[164:167], v[144:147], v[80:95]
    v_exp_f32 v62, v62
    v_exp_f32 v63, v63
    v_cvt_pk_bf16_f32 v150, v60, v61
    v_cvt_pk_bf16_f32 v151, v62, v63
    v_exp_f32 v64, v64
    v_exp_f32 v65, v65
    v_add_u32 v28, v180, v28
    v_mfma_f32_32x32x16_bf16 v[48:63], v[156:159], v[32:35], v[112:127]
    v_exp_f32 v66, v66
    v_exp_f32 v67, v67
    v_exp_f32 v68, v68
    v_exp_f32 v69, v69
    v_cvt_pk_bf16_f32 v144, v64, v65
    v_cvt_pk_bf16_f32 v145, v66, v67
    v_mfma_f32_32x32x8_bf16 v[48:63], v[162:163], v[40:41], v[48:63]
    v_exp_f32 v70, v70
    v_exp_f32 v71, v71
    v_exp_f32 v72, v72
    v_exp_f32 v73, v73
    v_cvt_pk_bf16_f32 v146, v68, v69
    v_cvt_pk_bf16_f32 v147, v70, v71
    v_mfma_f32_32x32x16_bf16 v[80:95], v[168:171], v[148:151], v[80:95]
    v_exp_f32 v74, v74
    v_exp_f32 v75, v75
    v_exp_f32 v76, v76
    v_exp_f32 v77, v77
    v_cvt_pk_bf16_f32 v148, v72, v73
    v_cvt_pk_bf16_f32 v149, v74, v75
    v_mfma_f32_32x32x16_bf16 v[96:111], v[164:167], v[144:147], v[96:111]
    v_exp_f32 v78, v78
    v_exp_f32 v79, v79
    v_cvt_pk_bf16_f32 v150, v76, v77
    v_cvt_pk_bf16_f32 v151, v78, v79
    v_exp_f32 v48, v48
    v_exp_f32 v49, v49
    v_mfma_f32_32x32x16_bf16 v[64:79], v[156:159], v[36:39], v[128:143]
    v_exp_f32 v50, v50
    v_exp_f32 v51, v51
    v_exp_f32 v52, v52
    v_exp_f32 v53, v53
    v_cvt_pk_bf16_f32 v144, v48, v49
    v_cvt_pk_bf16_f32 v145, v50, v51
    v_mfma_f32_32x32x8_bf16 v[64:79], v[162:163], v[42:43], v[64:79]
    v_exp_f32 v54, v54
    v_exp_f32 v55, v55
    v_exp_f32 v56, v56
    v_exp_f32 v57, v57
    v_cvt_pk_bf16_f32 v146, v52, v53
    v_cvt_pk_bf16_f32 v147, v54, v55
    v_mfma_f32_32x32x16_bf16 v[96:111], v[168:171], v[148:151], v[96:111]
    s_waitcnt lgkmcnt(0)
    ds_read_b128 v[164:167], v28
    ds_read_b128 v[168:171], v28 offset:640
    ds_read_b128 v[156:159], v26 offset:3072
    v_exp_f32 v58, v58
    v_exp_f32 v59, v59
    v_exp_f32 v60, v60
    v_exp_f32 v61, v61
    v_cvt_pk_bf16_f32 v148, v56, v57
    v_cvt_pk_bf16_f32 v149, v58, v59
    v_mfma_f32_32x32x16_bf16 v[80:95], v[172:175], v[144:147], v[80:95]
    v_exp_f32 v62, v62
    v_exp_f32 v63, v63
    v_cvt_pk_bf16_f32 v150, v60, v61
    v_cvt_pk_bf16_f32 v151, v62, v63
    v_exp_f32 v64, v64
    v_exp_f32 v65, v65
    v_add_u32 v28, v180, v28
    v_mfma_f32_32x32x16_bf16 v[48:63], v[152:155], v[32:35], v[112:127]
    v_exp_f32 v66, v66
    v_exp_f32 v67, v67
    v_exp_f32 v68, v68
    v_exp_f32 v69, v69
    v_cvt_pk_bf16_f32 v144, v64, v65
    v_cvt_pk_bf16_f32 v145, v66, v67
    v_mfma_f32_32x32x8_bf16 v[48:63], v[160:161], v[44:45], v[48:63]
    v_exp_f32 v70, v70
    v_exp_f32 v71, v71
    v_exp_f32 v72, v72
    v_exp_f32 v73, v73
    v_cvt_pk_bf16_f32 v146, v68, v69
    v_cvt_pk_bf16_f32 v147, v70, v71
    v_mfma_f32_32x32x16_bf16 v[80:95], v[176:179], v[148:151], v[80:95]
    v_exp_f32 v74, v74
    v_exp_f32 v75, v75
    v_exp_f32 v76, v76
    v_exp_f32 v77, v77
    v_cvt_pk_bf16_f32 v148, v72, v73
    v_cvt_pk_bf16_f32 v149, v74, v75
    v_mfma_f32_32x32x16_bf16 v[96:111], v[172:175], v[144:147], v[96:111]
    v_exp_f32 v78, v78
    v_exp_f32 v79, v79
    v_cvt_pk_bf16_f32 v150, v76, v77
    v_cvt_pk_bf16_f32 v151, v78, v79
    v_exp_f32 v48, v48
    v_exp_f32 v49, v49
    v_mfma_f32_32x32x16_bf16 v[64:79], v[152:155], v[36:39], v[128:143]
    v_exp_f32 v50, v50
    v_exp_f32 v51, v51
    v_exp_f32 v52, v52
    v_exp_f32 v53, v53
    v_cvt_pk_bf16_f32 v144, v48, v49
    v_cvt_pk_bf16_f32 v145, v50, v51
    v_mfma_f32_32x32x8_bf16 v[64:79], v[160:161], v[46:47], v[64:79]
    v_exp_f32 v54, v54
    v_exp_f32 v55, v55
    v_exp_f32 v56, v56
    v_exp_f32 v57, v57
    v_cvt_pk_bf16_f32 v146, v52, v53
    v_cvt_pk_bf16_f32 v147, v54, v55
    v_mfma_f32_32x32x16_bf16 v[96:111], v[176:179], v[148:151], v[96:111]
    s_waitcnt lgkmcnt(0)
    ds_read_b128 v[172:175], v28
    ds_read_b128 v[176:179], v28 offset:640
    ds_read_b128 v[152:155], v26 offset:10240
    ds_read_b64 v[160:161], v27 offset:14336
    v_exp_f32 v58, v58
    v_exp_f32 v59, v59
    v_exp_f32 v60, v60
    v_exp_f32 v61, v61
    v_cvt_pk_bf16_f32 v148, v56, v57
    v_cvt_pk_bf16_f32 v149, v58, v59
    v_mfma_f32_32x32x16_bf16 v[80:95], v[164:167], v[144:147], v[80:95]
    v_exp_f32 v62, v62
    v_exp_f32 v63, v63
    v_cvt_pk_bf16_f32 v150, v60, v61
    v_cvt_pk_bf16_f32 v151, v62, v63
    v_exp_f32 v64, v64
    v_exp_f32 v65, v65
    v_add_u32 v28, v181, v28
    v_mfma_f32_32x32x16_bf16 v[48:63], v[156:159], v[32:35], v[112:127]
    v_exp_f32 v66, v66
    v_exp_f32 v67, v67
    v_exp_f32 v68, v68
    v_exp_f32 v69, v69
    v_cvt_pk_bf16_f32 v144, v64, v65
    v_cvt_pk_bf16_f32 v145, v66, v67
    v_mfma_f32_32x32x8_bf16 v[48:63], v[162:163], v[44:45], v[48:63]
    v_exp_f32 v70, v70
    v_exp_f32 v71, v71
    v_exp_f32 v72, v72
    v_exp_f32 v73, v73
    v_cvt_pk_bf16_f32 v146, v68, v69
    v_cvt_pk_bf16_f32 v147, v70, v71
    v_mfma_f32_32x32x16_bf16 v[80:95], v[168:171], v[148:151], v[80:95]
    v_exp_f32 v74, v74
    v_exp_f32 v75, v75
    v_exp_f32 v76, v76
    v_exp_f32 v77, v77
    v_cvt_pk_bf16_f32 v148, v72, v73
    v_cvt_pk_bf16_f32 v149, v74, v75
    v_mfma_f32_32x32x16_bf16 v[96:111], v[164:167], v[144:147], v[96:111]
    v_exp_f32 v78, v78
    v_exp_f32 v79, v79
    v_cvt_pk_bf16_f32 v150, v76, v77
    v_cvt_pk_bf16_f32 v151, v78, v79
    v_exp_f32 v48, v48
    v_exp_f32 v49, v49
    v_mfma_f32_32x32x16_bf16 v[64:79], v[156:159], v[36:39], v[128:143]
    v_exp_f32 v50, v50
    v_exp_f32 v51, v51
    v_exp_f32 v52, v52
    v_exp_f32 v53, v53
    v_cvt_pk_bf16_f32 v144, v48, v49
    v_cvt_pk_bf16_f32 v145, v50, v51
    v_mfma_f32_32x32x8_bf16 v[64:79], v[162:163], v[46:47], v[64:79]
    v_exp_f32 v54, v54
    v_exp_f32 v55, v55
    v_exp_f32 v56, v56
    v_exp_f32 v57, v57
    v_cvt_pk_bf16_f32 v146, v52, v53
    v_cvt_pk_bf16_f32 v147, v54, v55
    v_mfma_f32_32x32x16_bf16 v[96:111], v[168:171], v[148:151], v[96:111]
    s_waitcnt lgkmcnt(0)
    ds_read_b128 v[164:167], v28
    ds_read_b128 v[168:171], v28 offset:640
    ds_read_b128 v[156:159], v26 offset:11264
    ds_read_b64 v[162:163], v27 offset:14848
    v_exp_f32 v58, v58
    v_exp_f32 v59, v59
    v_exp_f32 v60, v60
    v_exp_f32 v61, v61
    v_cvt_pk_bf16_f32 v148, v56, v57
    v_cvt_pk_bf16_f32 v149, v58, v59
    v_mfma_f32_32x32x16_bf16 v[80:95], v[172:175], v[144:147], v[80:95]
    v_exp_f32 v62, v62
    v_exp_f32 v63, v63
    v_cvt_pk_bf16_f32 v150, v60, v61
    v_cvt_pk_bf16_f32 v151, v62, v63
    v_exp_f32 v64, v64
    v_exp_f32 v65, v65
    v_add_u32 v28, v180, v28
    v_mfma_f32_32x32x16_bf16 v[48:63], v[152:155], v[32:35], v[112:127]
    s_sub_u32 s36, s36, 1
    v_exp_f32 v66, v66
    v_exp_f32 v67, v67
    v_exp_f32 v68, v68
    v_exp_f32 v69, v69
    v_cvt_pk_bf16_f32 v144, v64, v65
    v_cvt_pk_bf16_f32 v145, v66, v67
    v_mfma_f32_32x32x8_bf16 v[48:63], v[160:161], v[40:41], v[48:63]
    v_exp_f32 v70, v70
    v_exp_f32 v71, v71
    v_exp_f32 v72, v72
    v_exp_f32 v73, v73
    v_cvt_pk_bf16_f32 v146, v68, v69
    v_cvt_pk_bf16_f32 v147, v70, v71
    v_mfma_f32_32x32x16_bf16 v[80:95], v[176:179], v[148:151], v[80:95]
    s_cmp_lg_u32 s36, 0
    v_exp_f32 v74, v74
    v_exp_f32 v75, v75
    v_exp_f32 v76, v76
    v_exp_f32 v77, v77
    v_cvt_pk_bf16_f32 v148, v72, v73
    v_cvt_pk_bf16_f32 v149, v74, v75
    v_add_u32 v26, s52, v26
    v_add_u32 v27, s52, v27
    v_mfma_f32_32x32x16_bf16 v[96:111], v[172:175], v[144:147], v[96:111]
    v_exp_f32 v78, v78
    v_exp_f32 v79, v79
    v_cvt_pk_bf16_f32 v150, v76, v77
    v_cvt_pk_bf16_f32 v151, v78, v79
    v_exp_f32 v48, v48
    v_exp_f32 v49, v49
    s_cbranch_scc1 L_attn_loop
    s_cmp_lt_u32 s51, 2
    s_cbranch_scc1 L_attn_ck
    v_mfma_f32_32x32x16_bf16 v[96:111], v[176:179], v[148:151], v[96:111]
    s_waitcnt lgkmcnt(0)
    s_xor_b32 s28, s12, 2
    s_or_b32 s28, s28, s19
    s_cbranch_scc1 L_attn_nopc
    v_lshlrev_b32 v184, 9, v1
    s_mov_b32 s28, 0xc00180
    s_mov_b32 exec_hi, 0
    buffer_load_dword v185, v184, s[8:11], s28 offen sc1
    s_mov_b64 exec, -1
L_attn_nopc:
    v_subrev_u32 v26, 163840, v26
    v_subrev_u32 v27, 163840, v27
    v_bfe_u32 v9, v29, 3, 1
    v_mul_u32_u24 v9, 20480, v9
    v_and_b32 v12, 7, v29
    v_lshrrev_b32 v13, 4, v29
    v_lshl_add_u32 v12, v13, 3, v12
    v_lshl_add_u32 v14, v12, 4, v9
    v_lshl_add_u32 v14, v30, 8, v14
    v_lshl_add_u32 v9, v12, 3, v9
    v_mul_u32_u24 v13, 40960, v30
    v_add_u32 v9, v9, v13
    s_lshl_b32 s28, s18, 2
    s_add_u32 s28, s28, s12
    s_mul_i32 s28, s28, 81920
    s_add_u32 s28, s28, s19
    s_add_u32 s28, s28, 0x2000000
    s_lshl_b32 s29, s17, 9
    s_add_u32 s29, s29, s28
    s_add_u32 s29, s29, 2048
    v_cndmask_b32 v10, v92, v88, s[48:49]
    v_cndmask_b32 v11, v108, v104, s[48:49]
    v_add_f32 v12, v10, v11
    v_cmp_ngt_f32 vcc, 0x4e800000, v12
    v_rcp_f32 v10, v10
    v_rcp_f32 v11, v11
    s_lshr_b32 s30, s17, 3
    s_and_b32 s31, s17, 16
    s_add_u32 s30, s30, s31
    s_lshl_b32 s30, s30, 10
    s_and_b32 s31, s17, 1
    s_lshl_b32 s31, s31, 9
    s_add_u32 s30, s30, s31
    s_and_b32 s31, s17, 6
    s_lshl_b32 s31, s31, 6
    s_add_u32 s30, s30, s31
    s_add_u32 s30, s30, s28
    s_add_u32 s31, s29, 40960
    s_cmp_lg_u32 s50, 0
    s_cbranch_scc1 L_attn_out
    s_cbranch_vccnz L_attn_slow
L_attn_out:
    v_pk_mul_f32 v[80:81], v[80:81], v[10:11] op_sel:[0,0] op_sel_hi:[1,0]
    v_pk_mul_f32 v[82:83], v[82:83], v[10:11] op_sel:[0,0] op_sel_hi:[1,0]
    v_cvt_pk_bf16_f32 v48, v80, v81
    v_cvt_pk_bf16_f32 v49, v82, v83
    v_pk_mul_f32 v[84:85], v[84:85], v[10:11] op_sel:[0,0] op_sel_hi:[1,0]
    v_pk_mul_f32 v[86:87], v[86:87], v[10:11] op_sel:[0,0] op_sel_hi:[1,0]
    v_cvt_pk_bf16_f32 v50, v84, v85
    v_cvt_pk_bf16_f32 v51, v86, v87
    v_pk_mul_f32 v[88:89], v[88:89], v[10:11] op_sel:[0,0] op_sel_hi:[1,0]
    v_pk_mul_f32 v[90:91], v[90:91], v[10:11] op_sel:[0,0] op_sel_hi:[1,0]
    v_cvt_pk_bf16_f32 v52, v88, v89
    v_cvt_pk_bf16_f32 v53, v90, v91
    buffer_store_dwordx4 v[48:51], v14, s[8:11], s29 offen sc0 sc1
    v_pk_mul_f32 v[96:97], v[96:97], v[10:11] op_sel:[0,1] op_sel_hi:[1,1]
    v_pk_mul_f32 v[98:99], v[98:99], v[10:11] op_sel:[0,1] op_sel_hi:[1,1]
    v_cvt_pk_bf16_f32 v64, v96, v97
    v_cvt_pk_bf16_f32 v65, v98, v99
    v_pk_mul_f32 v[100:101], v[100:101], v[10:11] op_sel:[0,1] op_sel_hi:[1,1]
    v_pk_mul_f32 v[102:103], v[102:103], v[10:11] op_sel:[0,1] op_sel_hi:[1,1]
    v_cvt_pk_bf16_f32 v66, v100, v101
    v_cvt_pk_bf16_f32 v67, v102, v103
    v_pk_mul_f32 v[104:105], v[104:105], v[10:11] op_sel:[0,1] op_sel_hi:[1,1]
    v_pk_mul_f32 v[106:107], v[106:107], v[10:11] op_sel:[0,1] op_sel_hi:[1,1]
    v_cvt_pk_bf16_f32 v68, v104, v105
    v_cvt_pk_bf16_f32 v69, v106, v107
    buffer_store_dwordx4 v[64:67], v14, s[8:11], s31 offen sc0 sc1
    s_nop 0
    v_permlane32_swap_b32 v52, v68
    v_permlane32_swap_b32 v53, v69
    buffer_store_dwordx2 v[52:53], v9, s[8:11], s30 offen sc0 sc1
    s_lshl_b32 s28, s18, 14
    s_and_b32 s29, s17, 1
    s_lshl_b32 s29, s29, 7
    s_add_u32 s28, s28, s29
    v_lshl_add_u32 v12, v1, 9, s28
    s_mov_b64 s[54:55], 0xffffffff
    s_mov_b32 s60, 16
    s_mov_b32 s61, 16
    s_mov_b32 s62, 0
    s_lshl_b32 s28, s15, 3
    s_add_u32 s28, s28, s16
    s_lshl_b32 s28, s28, 9
    s_add_u32 s53, s21, 0xc00004
    s_add_u32 s94, s28, s53
    v_lshlrev_b32 v32, 16, v16
    v_and_b32 v33, 0xffff0000, v16
    v_lshlrev_b32 v34, 16, v17
    v_and_b32 v35, 0xffff0000, v17
    v_lshlrev_b32 v36, 16, v18
    v_and_b32 v37, 0xffff0000, v18
    v_lshlrev_b32 v38, 16, v19
    v_and_b32 v39, 0xffff0000, v19
    v_lshlrev_b32 v40, 16, v20
    v_and_b32 v41, 0xffff0000, v20
    v_lshlrev_b32 v42, 16, v21
    v_and_b32 v43, 0xffff0000, v21
    v_lshlrev_b32 v44, 16, v22
    v_and_b32 v45, 0xffff0000, v22
    v_lshlrev_b32 v46, 16, v23
    v_and_b32 v47, 0xffff0000, v23
    v_lshlrev_b32 v48, 16, v24
    v_and_b32 v49, 0xffff0000, v24
    v_lshlrev_b32 v50, 16, v25
    v_and_b32 v51, 0xffff0000, v25
    s_waitcnt vmcnt(0)
    s_xor_b32 s28, s12, 2
    s_or_b32 s28, s28, s19
    s_cbranch_scc1 L_attn_pcok
    v_lshlrev_b32 v184, 9, v1
    v_mov_b32 v186, 31
    v_mov_b32 v187, 30
    v_cmp_lt_u32 vcc, 11, v1
    s_mov_b32 s28, 0xc00180
    s_mov_b32 s29, 0x40000
    v_cndmask_b32 v186, v186, v187, vcc
    s_mov_b32 exec_hi, 0
L_attn_pchk:
    v_cmp_ne_u32 vcc, v186, v185
    s_sub_u32 s29, s29, 1
    s_cbranch_scc1 L_attn_pcx
    s_cbranch_vccz L_attn_pcx
    s_sleep 8
    buffer_load_dword v185, v184, s[8:11], s28 offen sc1
    s_waitcnt vmcnt(0)
    s_branch L_attn_pchk
L_attn_pcx:
    s_mov_b64 exec, -1
L_attn_pcok:
    s_barrier
    s_cmp_lg_u32 s12, 0
    s_cbranch_scc1 L_mega_12
    s_mov_b64 exec, s[54:55]
    buffer_atomic_add v15, v12, s[8:11], s53 offen sc1
    s_mov_b64 exec, -1
L_mega_12:
    s_mul_i32 s28, s14, 301056
    s_add_u32 s28, s28, 0x305000
    s_cmp_eq_u32 s14, 15
    s_cselect_b32 s30, 0, 21504
    v_lshlrev_b32 v9, 3, v1
    s_add_u32 s29, s28, 0
    buffer_load_dwordx2 v[216:217], v9, s[8:11], s29 offen
    s_add_u32 s29, s28, 21504
    buffer_load_dwordx2 v[218:219], v9, s[8:11], s29 offen
    s_add_u32 s29, s28, 43008
    buffer_load_dwordx2 v[220:221], v9, s[8:11], s29 offen
    s_add_u32 s29, s28, 64512
    buffer_load_dwordx2 v[222:223], v9, s[8:11], s29 offen
    s_mul_i32 s29, s30, 4
    s_add_u32 s29, s29, s28
    buffer_load_dwordx2 v[224:225], v9, s[8:11], s29 offen
    s_mul_i32 s29, s30, 5
    s_add_u32 s29, s29, s28
    buffer_load_dwordx2 v[226:227], v9, s[8:11], s29 offen
    s_mul_i32 s29, s30, 6
    s_add_u32 s29, s29, s28
    buffer_load_dwordx2 v[228:229], v9, s[8:11], s29 offen
    s_mul_i32 s29, s30, 7
    s_add_u32 s29, s29, s28
    buffer_load_dwordx2 v[230:231], v9, s[8:11], s29 offen
    s_mul_i32 s29, s30, 8
    s_add_u32 s29, s29, s28
    buffer_load_dwordx2 v[232:233], v9, s[8:11], s29 offen
    s_mul_i32 s29, s30, 9
    s_add_u32 s29, s29, s28
    buffer_load_dwordx2 v[234:235], v9, s[8:11], s29 offen
    s_mul_i32 s29, s30, 10
    s_add_u32 s29, s29, s28
    buffer_load_dwordx2 v[236:237], v9, s[8:11], s29 offen
    s_mul_i32 s29, s30, 11
    s_add_u32 s29, s29, s28
    buffer_load_dwordx2 v[238:239], v9, s[8:11], s29 offen
    s_add_u32 s29, s28, 258048
    buffer_load_dwordx2 v[240:241], v9, s[8:11], s29 offen
    s_add_u32 s29, s28, 279552
    buffer_load_dwordx2 v[242:243], v9, s[8:11], s29 offen
    s_cmp_lg_u32 s12, 1
    s_cbranch_scc1 L_mega_11
    s_mov_b32 s95, 0x40000
    s_add_u32 s66, s94, 128
    s_add_u32 s67, s94, 256
L_mega_13:
    s_load_dword s63, s[4:5], s94 glc
    s_load_dword s64, s[4:5], s66 glc
    s_load_dword s65, s[4:5], s67 glc
    s_sub_u32 s95, s95, 1
    s_cbranch_scc1 L_mega_13_x
    s_waitcnt lgkmcnt(0)
    s_xor_b32 s63, s63, s60
    s_xor_b32 s64, s64, s61
    s_xor_b32 s65, s65, s62
    s_or_b32 s63, s63, s64
    s_or_b32 s63, s63, s65
    s_cbranch_scc1 L_mega_13
L_mega_13_x:
    s_waitcnt lgkmcnt(0)
L_mega_11:
    s_barrier
    s_lshl_b32 s28, s15, 2
    s_add_u32 s28, s28, s12
    s_mul_i32 s29, s28, 20480
    s_lshl_b32 s30, s16, 11
    s_add_u32 s30, s30, s29
    s_lshl_b32 s31, s16, 9
    s_add_u32 s31, s31, s29
    s_add_u32 s31, s31, 16384
    v_lshrrev_b32 v9, 1, v8
    v_lshlrev_b32 v9, 8, v9
    v_lshl_add_u32 v9, v7, 4, v9
    v_mov_b32 v14, v9
    s_mov_b32 s29, 0x1000000
    s_add_u32 s30, s30, s29
    s_add_u32 s31, s31, s29
    v_lshlrev_b32 v26, 3, v7
    s_lshl_b32 s29, s16, 14
    s_lshl_b32 s28, s28, 7
    s_add_u32 s29, s29, s28
    s_add_u32 s29, s29, 0x1280000
    s_mul_i32 s28, s12, 1024
    v_add_u32 v27, 0x1b000, v3
    v_add_u32 v4, s28, v27
    v_add_u32 v28, 0x0, v3
    v_add_u32 v5, s28, v28
    v_add_u32 v29, 0x9000, v3
    v_add_u32 v6, s28, v29
    v_add_u32 v31, 0x12000, v3
    v_add_u32 v30, s28, v31
    v_lshlrev_b32 v9, 3, v1
    v_sub_u32 v9, v4, v9
    s_mov_b32 s36, 1
    s_barrier
    ds_read2st64_b64 v[52:55], v9 offset0:0 offset1:1
    ds_read_b128 v[68:71], v27 offset:4096
    ds_read_b128 v[72:75], v27 offset:5120
    ds_read_b128 v[76:79], v27 offset:6144
    ds_read_b128 v[80:83], v27 offset:7168
    ds_read_b128 v[84:87], v27 offset:8192
    ds_read2st64_b64 v[56:59], v9 offset0:18 offset1:19
    ds_read_b128 v[88:91], v27 offset:13312
    ds_read_b128 v[92:95], v27 offset:14336
    ds_read_b128 v[96:99], v27 offset:15360
    ds_read_b128 v[100:103], v27 offset:16384
    ds_read_b128 v[104:107], v27 offset:17408
    s_waitcnt lgkmcnt(0)
    v_mfma_f32_16x16x32_bf16 v[32:35], v[68:71], v[52:55], v[32:35]
    ds_read_b128 v[60:63], v4 offset:18432
    ds_read_b128 v[108:111], v27 offset:22528
    v_mfma_f32_16x16x32_bf16 v[36:39], v[72:75], v[52:55], v[36:39]
    ds_read_b128 v[112:115], v27 offset:23552
    ds_read_b128 v[116:119], v27 offset:24576
    v_mfma_f32_16x16x32_bf16 v[40:43], v[76:79], v[52:55], v[40:43]
    ds_read_b128 v[120:123], v27 offset:25600
    ds_read_b128 v[124:127], v27 offset:26624
    v_mfma_f32_16x16x32_bf16 v[44:47], v[80:83], v[52:55], v[44:47]
    ds_read_b128 v[64:67], v4 offset:27648
    ds_read_b128 v[128:131], v27 offset:31744
    v_mfma_f32_16x16x32_bf16 v[48:51], v[84:87], v[52:55], v[48:51]
    ds_read_b128 v[132:135], v27 offset:32768
    ds_read_b128 v[136:139], v27 offset:33792
    v_mfma_f32_16x16x32_bf16 v[32:35], v[88:91], v[56:59], v[32:35]
    ds_read_b128 v[140:143], v27 offset:34816
    ds_read_b128 v[144:147], v27 offset:35840
    v_mfma_f32_16x16x32_bf16 v[36:39], v[92:95], v[56:59], v[36:39]
    v_mfma_f32_16x16x32_bf16 v[40:43], v[96:99], v[56:59], v[40:43]
    v_mfma_f32_16x16x32_bf16 v[44:47], v[100:103], v[56:59], v[44:47]
    v_mfma_f32_16x16x32_bf16 v[48:51], v[104:107], v[56:59], v[48:51]
    s_waitcnt lgkmcnt(0)
    s_barrier
    v_mfma_f32_16x16x32_bf16 v[32:35], v[108:111], v[60:63], v[32:35]
    ds_read_b128 v[52:55], v5 offset:0
    ds_read_b128 v[68:71], v28 offset:4096
    v_mfma_f32_16x16x32_bf16 v[36:39], v[112:115], v[60:63], v[36:39]
    ds_read_b128 v[72:75], v28 offset:5120
    ds_read_b128 v[76:79], v28 offset:6144
    v_mfma_f32_16x16x32_bf16 v[40:43], v[116:119], v[60:63], v[40:43]
    ds_read_b128 v[80:83], v28 offset:7168
    ds_read_b128 v[84:87], v28 offset:8192
    v_mfma_f32_16x16x32_bf16 v[44:47], v[120:123], v[60:63], v[44:47]
    ds_read_b128 v[56:59], v5 offset:9216
    ds_read_b128 v[88:91], v28 offset:13312
    v_mfma_f32_16x16x32_bf16 v[48:51], v[124:127], v[60:63], v[48:51]
    ds_read_b128 v[92:95], v28 offset:14336
    ds_read_b128 v[96:99], v28 offset:15360
    v_mfma_f32_16x16x32_bf16 v[32:35], v[128:131], v[64:67], v[32:35]
    ds_read_b128 v[100:103], v28 offset:16384
    ds_read_b128 v[104:107], v28 offset:17408
    v_mfma_f32_16x16x32_bf16 v[36:39], v[132:135], v[64:67], v[36:39]
    v_mfma_f32_16x16x32_bf16 v[40:43], v[136:139], v[64:67], v[40:43]
    v_mfma_f32_16x16x32_bf16 v[44:47], v[140:143], v[64:67], v[44:47]
    v_mfma_f32_16x16x32_bf16 v[48:51], v[144:147], v[64:67], v[48:51]
    s_waitcnt lgkmcnt(0)
    v_mfma_f32_16x16x32_bf16 v[32:35], v[68:71], v[52:55], v[32:35]
    ds_read_b128 v[60:63], v5 offset:18432
    ds_read_b128 v[108:111], v28 offset:22528
    s_waitcnt vmcnt(0)
    v_mfma_f32_16x16x32_bf16 v[36:39], v[72:75], v[52:55], v[36:39]
    ds_read_b128 v[112:115], v28 offset:23552
    ds_read_b128 v[116:119], v28 offset:24576
    v_add_f32 v10, v216, v217
    v_mfma_f32_16x16x32_bf16 v[40:43], v[76:79], v[52:55], v[40:43]
    ds_read_b128 v[120:123], v28 offset:25600
    ds_read_b128 v[124:127], v28 offset:26624
    v_cvt_pk_bf16_f32 v11, v10, v10
    v_mfma_f32_16x16x32_bf16 v[44:47], v[80:83], v[52:55], v[44:47]
    ds_read_b128 v[64:67], v5 offset:27648
    ds_read_b128 v[128:131], v28 offset:31744
    v_and_b32 v11, 0xffff0000, v11
    v_mfma_f32_16x16x32_bf16 v[48:51], v[84:87], v[52:55], v[48:51]
    ds_read_b128 v[132:135], v28 offset:32768
    ds_read_b128 v[136:139], v28 offset:33792
    v_sub_f32 v11, v10, v11
    v_mfma_f32_16x16x32_bf16 v[32:35], v[88:91], v[56:59], v[32:35]
    ds_read_b128 v[140:143], v28 offset:34816
    ds_read_b128 v[144:147], v28 offset:35840
    v_cvt_pk_bf16_f32 v216, v10, v11
    v_mfma_f32_16x16x32_bf16 v[36:39], v[92:95], v[56:59], v[36:39]
    v_cvt_pk_bf16_f32 v217, v10, v11
    v_mfma_f32_16x16x32_bf16 v[40:43], v[96:99], v[56:59], v[40:43]
    v_add_f32 v10, v218, v219
    v_mfma_f32_16x16x32_bf16 v[44:47], v[100:103], v[56:59], v[44:47]
    v_cvt_pk_bf16_f32 v11, v10, v10
    v_mfma_f32_16x16x32_bf16 v[48:51], v[104:107], v[56:59], v[48:51]
    v_and_b32 v11, 0xffff0000, v11
    s_waitcnt lgkmcnt(0)
    s_barrier
    v_mfma_f32_16x16x32_bf16 v[32:35], v[108:111], v[60:63], v[32:35]
    ds_read_b128 v[52:55], v6 offset:0
    ds_read_b128 v[68:71], v29 offset:4096
    v_sub_f32 v11, v10, v11
    v_mfma_f32_16x16x32_bf16 v[36:39], v[112:115], v[60:63], v[36:39]
    ds_read_b128 v[72:75], v29 offset:5120
    ds_read_b128 v[76:79], v29 offset:6144
    v_cvt_pk_bf16_f32 v218, v10, v11
    v_mfma_f32_16x16x32_bf16 v[40:43], v[116:119], v[60:63], v[40:43]
    ds_read_b128 v[80:83], v29 offset:7168
    ds_read_b128 v[84:87], v29 offset:8192
    v_cvt_pk_bf16_f32 v219, v10, v11
    v_mfma_f32_16x16x32_bf16 v[44:47], v[120:123], v[60:63], v[44:47]
    ds_read_b128 v[56:59], v6 offset:9216
    ds_read_b128 v[88:91], v29 offset:13312
    v_add_f32 v10, v220, v221
    v_mfma_f32_16x16x32_bf16 v[48:51], v[124:127], v[60:63], v[48:51]
    ds_read_b128 v[92:95], v29 offset:14336
    ds_read_b128 v[96:99], v29 offset:15360
    v_cvt_pk_bf16_f32 v11, v10, v10
    v_mfma_f32_16x16x32_bf16 v[32:35], v[128:131], v[64:67], v[32:35]
    ds_read_b128 v[100:103], v29 offset:16384
    ds_read_b128 v[104:107], v29 offset:17408
    v_and_b32 v11, 0xffff0000, v11
    v_mfma_f32_16x16x32_bf16 v[36:39], v[132:135], v[64:67], v[36:39]
    v_sub_f32 v11, v10, v11
    v_mfma_f32_16x16x32_bf16 v[40:43], v[136:139], v[64:67], v[40:43]
    v_cvt_pk_bf16_f32 v220, v10, v11
    v_mfma_f32_16x16x32_bf16 v[44:47], v[140:143], v[64:67], v[44:47]
    v_cvt_pk_bf16_f32 v221, v10, v11
    v_mfma_f32_16x16x32_bf16 v[48:51], v[144:147], v[64:67], v[48:51]
    v_add_f32 v10, v222, v223
    s_waitcnt lgkmcnt(0)
    v_mfma_f32_16x16x32_bf16 v[32:35], v[68:71], v[52:55], v[32:35]
    ds_read_b128 v[60:63], v6 offset:18432
    ds_read_b128 v[108:111], v29 offset:22528
    v_cvt_pk_bf16_f32 v11, v10, v10
    v_mfma_f32_16x16x32_bf16 v[36:39], v[72:75], v[52:55], v[36:39]
    ds_read_b128 v[112:115], v29 offset:23552
    ds_read_b128 v[116:119], v29 offset:24576
    v_and_b32 v11, 0xffff0000, v11
    v_mfma_f32_16x16x32_bf16 v[40:43], v[76:79], v[52:55], v[40:43]
    ds_read_b128 v[120:123], v29 offset:25600
    ds_read_b128 v[124:127], v29 offset:26624
    v_sub_f32 v11, v10, v11
    v_mfma_f32_16x16x32_bf16 v[44:47], v[80:83], v[52:55], v[44:47]
    ds_read_b128 v[64:67], v6 offset:27648
    ds_read_b128 v[128:131], v29 offset:31744
    v_cvt_pk_bf16_f32 v222, v10, v11
    v_mfma_f32_16x16x32_bf16 v[48:51], v[84:87], v[52:55], v[48:51]
    ds_read_b128 v[132:135], v29 offset:32768
    ds_read_b128 v[136:139], v29 offset:33792
    v_cvt_pk_bf16_f32 v223, v10, v11
    v_mfma_f32_16x16x32_bf16 v[32:35], v[88:91], v[56:59], v[32:35]
    ds_read_b128 v[140:143], v29 offset:34816
    ds_read_b128 v[144:147], v29 offset:35840
    v_add_f32 v10, v224, v225
    v_mfma_f32_16x16x32_bf16 v[36:39], v[92:95], v[56:59], v[36:39]
    v_cvt_pk_bf16_f32 v11, v10, v10
    v_mfma_f32_16x16x32_bf16 v[40:43], v[96:99], v[56:59], v[40:43]
    v_and_b32 v11, 0xffff0000, v11
    v_mfma_f32_16x16x32_bf16 v[44:47], v[100:103], v[56:59], v[44:47]
    v_sub_f32 v11, v10, v11
    v_mfma_f32_16x16x32_bf16 v[48:51], v[104:107], v[56:59], v[48:51]
    v_cvt_pk_bf16_f32 v224, v10, v11
    s_waitcnt lgkmcnt(0)
    s_barrier
    v_mfma_f32_16x16x32_bf16 v[32:35], v[108:111], v[60:63], v[32:35]
    ds_read_b128 v[52:55], v30 offset:0
    ds_read_b128 v[68:71], v31 offset:4096
    v_cvt_pk_bf16_f32 v225, v10, v11
    v_mfma_f32_16x16x32_bf16 v[36:39], v[112:115], v[60:63], v[36:39]
    ds_read_b128 v[72:75], v31 offset:5120
    ds_read_b128 v[76:79], v31 offset:6144
    v_add_f32 v10, v226, v227
    v_mfma_f32_16x16x32_bf16 v[40:43], v[116:119], v[60:63], v[40:43]
    ds_read_b128 v[80:83], v31 offset:7168
    ds_read_b128 v[84:87], v31 offset:8192
    v_cvt_pk_bf16_f32 v11, v10, v10
    v_mfma_f32_16x16x32_bf16 v[44:47], v[120:123], v[60:63], v[44:47]
    ds_read_b128 v[56:59], v30 offset:9216
    ds_read_b128 v[88:91], v31 offset:13312
    v_and_b32 v11, 0xffff0000, v11
    v_mfma_f32_16x16x32_bf16 v[48:51], v[124:127], v[60:63], v[48:51]
    ds_read_b128 v[92:95], v31 offset:14336
    ds_read_b128 v[96:99], v31 offset:15360
    v_sub_f32 v11, v10, v11
    v_mfma_f32_16x16x32_bf16 v[32:35], v[128:131], v[64:67], v[32:35]
    ds_read_b128 v[100:103], v31 offset:16384
    ds_read_b128 v[104:107], v31 offset:17408
    v_cvt_pk_bf16_f32 v226, v10, v11
    v_mfma_f32_16x16x32_bf16 v[36:39], v[132:135], v[64:67], v[36:39]
    v_cvt_pk_bf16_f32 v227, v10, v11
    v_mfma_f32_16x16x32_bf16 v[40:43], v[136:139], v[64:67], v[40:43]
    v_add_f32 v10, v228, v229
    v_mfma_f32_16x16x32_bf16 v[44:47], v[140:143], v[64:67], v[44:47]
    v_cvt_pk_bf16_f32 v11, v10, v10
    v_mfma_f32_16x16x32_bf16 v[48:51], v[144:147], v[64:67], v[48:51]
    v_and_b32 v11, 0xffff0000, v11
    s_waitcnt lgkmcnt(0)
    v_mfma_f32_16x16x32_bf16 v[32:35], v[68:71], v[52:55], v[32:35]
    ds_read_b128 v[60:63], v30 offset:18432
    ds_read_b128 v[108:111], v31 offset:22528
    v_sub_f32 v11, v10, v11
    v_mfma_f32_16x16x32_bf16 v[36:39], v[72:75], v[52:55], v[36:39]
    ds_read_b128 v[112:115], v31 offset:23552
    ds_read_b128 v[116:119], v31 offset:24576
    v_cvt_pk_bf16_f32 v228, v10, v11
    v_mfma_f32_16x16x32_bf16 v[40:43], v[76:79], v[52:55], v[40:43]
    ds_read_b128 v[120:123], v31 offset:25600
    ds_read_b128 v[124:127], v31 offset:26624
    v_cvt_pk_bf16_f32 v229, v10, v11
    v_mfma_f32_16x16x32_bf16 v[44:47], v[80:83], v[52:55], v[44:47]
    ds_read_b128 v[64:67], v30 offset:27648
    ds_read_b128 v[128:131], v31 offset:31744
    v_add_f32 v10, v230, v231
    v_mfma_f32_16x16x32_bf16 v[48:51], v[84:87], v[52:55], v[48:51]
    ds_read_b128 v[132:135], v31 offset:32768
    ds_read_b128 v[136:139], v31 offset:33792
    v_cvt_pk_bf16_f32 v11, v10, v10
    v_mfma_f32_16x16x32_bf16 v[32:35], v[88:91], v[56:59], v[32:35]
    ds_read_b128 v[140:143], v31 offset:34816
    ds_read_b128 v[144:147], v31 offset:35840
    v_and_b32 v11, 0xffff0000, v11
    v_mfma_f32_16x16x32_bf16 v[36:39], v[92:95], v[56:59], v[36:39]
    v_sub_f32 v11, v10, v11
    v_mfma_f32_16x16x32_bf16 v[40:43], v[96:99], v[56:59], v[40:43]
    v_cvt_pk_bf16_f32 v230, v10, v11
    v_mfma_f32_16x16x32_bf16 v[44:47], v[100:103], v[56:59], v[44:47]
    v_cvt_pk_bf16_f32 v231, v10, v11
    v_mfma_f32_16x16x32_bf16 v[48:51], v[104:107], v[56:59], v[48:51]
    v_add_f32 v10, v232, v233
    s_waitcnt lgkmcnt(0)
    s_barrier
    v_mfma_f32_16x16x32_bf16 v[32:35], v[108:111], v[60:63], v[32:35]
    ds_read_b128 v[52:55], v4 offset:0
    ds_read_b128 v[68:71], v27 offset:4096
    v_cvt_pk_bf16_f32 v11, v10, v10
    v_mfma_f32_16x16x32_bf16 v[36:39], v[112:115], v[60:63], v[36:39]
    ds_read_b128 v[72:75], v27 offset:5120
    ds_read_b128 v[76:79], v27 offset:6144
    v_and_b32 v11, 0xffff0000, v11
    v_mfma_f32_16x16x32_bf16 v[40:43], v[116:119], v[60:63], v[40:43]
    ds_read_b128 v[80:83], v27 offset:7168
    ds_read_b128 v[84:87], v27 offset:8192
    v_sub_f32 v11, v10, v11
    v_mfma_f32_16x16x32_bf16 v[44:47], v[120:123], v[60:63], v[44:47]
    ds_read_b128 v[56:59], v4 offset:9216
    ds_read_b128 v[88:91], v27 offset:13312
    v_cvt_pk_bf16_f32 v232, v10, v11
    v_mfma_f32_16x16x32_bf16 v[48:51], v[124:127], v[60:63], v[48:51]
    ds_read_b128 v[92:95], v27 offset:14336
    ds_read_b128 v[96:99], v27 offset:15360
    v_cvt_pk_bf16_f32 v233, v10, v11
    v_mfma_f32_16x16x32_bf16 v[32:35], v[128:131], v[64:67], v[32:35]
    ds_read_b128 v[100:103], v27 offset:16384
    ds_read_b128 v[104:107], v27 offset:17408
    v_add_f32 v10, v234, v235
    v_mfma_f32_16x16x32_bf16 v[36:39], v[132:135], v[64:67], v[36:39]
    v_cvt_pk_bf16_f32 v11, v10, v10
    v_mfma_f32_16x16x32_bf16 v[40:43], v[136:139], v[64:67], v[40:43]
    v_and_b32 v11, 0xffff0000, v11
    v_mfma_f32_16x16x32_bf16 v[44:47], v[140:143], v[64:67], v[44:47]
    v_sub_f32 v11, v10, v11
    v_mfma_f32_16x16x32_bf16 v[48:51], v[144:147], v[64:67], v[48:51]
    v_cvt_pk_bf16_f32 v234, v10, v11
    v_lshlrev_b32 v9, 3, v1
    v_sub_u32 v9, v4, v9
    s_waitcnt lgkmcnt(0)
    v_mfma_f32_16x16x32_bf16 v[32:35], v[68:71], v[52:55], v[32:35]
    ds_read2st64_b64 v[60:63], v9 offset0:36 offset1:37
    ds_read_b128 v[108:111], v27 offset:22528
    v_cvt_pk_bf16_f32 v235, v10, v11
    v_add_f32 v10, v236, v237
    v_mfma_f32_16x16x32_bf16 v[36:39], v[72:75], v[52:55], v[36:39]
    ds_read_b128 v[112:115], v27 offset:23552
    ds_read_b128 v[116:119], v27 offset:24576
    v_cvt_pk_bf16_f32 v11, v10, v10
    v_and_b32 v11, 0xffff0000, v11
    v_mfma_f32_16x16x32_bf16 v[40:43], v[76:79], v[52:55], v[40:43]
    ds_read_b128 v[120:123], v27 offset:25600
    ds_read_b128 v[124:127], v27 offset:26624
    v_sub_f32 v11, v10, v11
    v_cvt_pk_bf16_f32 v236, v10, v11
    v_mfma_f32_16x16x32_bf16 v[44:47], v[80:83], v[52:55], v[44:47]
    ds_read2st64_b64 v[64:67], v9 offset0:54 offset1:55
    ds_read_b128 v[128:131], v27 offset:31744
    v_cvt_pk_bf16_f32 v237, v10, v11
    v_add_f32 v10, v238, v239
    v_mfma_f32_16x16x32_bf16 v[48:51], v[84:87], v[52:55], v[48:51]
    ds_read_b128 v[132:135], v27 offset:32768
    ds_read_b128 v[136:139], v27 offset:33792
    v_cvt_pk_bf16_f32 v11, v10, v10
    v_and_b32 v11, 0xffff0000, v11
    v_mfma_f32_16x16x32_bf16 v[32:35], v[88:91], v[56:59], v[32:35]
    ds_read_b128 v[140:143], v27 offset:34816
    ds_read_b128 v[144:147], v27 offset:35840
    v_sub_f32 v11, v10, v11
    v_cvt_pk_bf16_f32 v238, v10, v11
    v_mfma_f32_16x16x32_bf16 v[36:39], v[92:95], v[56:59], v[36:39]
    v_cvt_pk_bf16_f32 v239, v10, v11
    v_add_f32 v10, v240, v241
    v_mfma_f32_16x16x32_bf16 v[40:43], v[96:99], v[56:59], v[40:43]
    v_cvt_pk_bf16_f32 v11, v10, v10
    v_and_b32 v11, 0xffff0000, v11
    v_mfma_f32_16x16x32_bf16 v[44:47], v[100:103], v[56:59], v[44:47]
    v_sub_f32 v11, v10, v11
    v_cvt_pk_bf16_f32 v240, v10, v11
    v_mfma_f32_16x16x32_bf16 v[48:51], v[104:107], v[56:59], v[48:51]
    v_cvt_pk_bf16_f32 v241, v10, v11
    v_add_f32 v10, v242, v243
    s_waitcnt lgkmcnt(0)
    v_mfma_f32_16x16x32_bf16 v[32:35], v[108:111], v[60:63], v[32:35]
    v_cvt_pk_bf16_f32 v11, v10, v10
    v_and_b32 v11, 0xffff0000, v11
    v_mfma_f32_16x16x32_bf16 v[36:39], v[112:115], v[60:63], v[36:39]
    v_sub_f32 v11, v10, v11
    v_cvt_pk_bf16_f32 v242, v10, v11
    v_mfma_f32_16x16x32_bf16 v[40:43], v[116:119], v[60:63], v[40:43]
    v_cvt_pk_bf16_f32 v243, v10, v11
    v_mfma_f32_16x16x32_bf16 v[44:47], v[120:123], v[60:63], v[44:47]
    v_mfma_f32_16x16x32_bf16 v[48:51], v[124:127], v[60:63], v[48:51]
    v_mfma_f32_16x16x32_bf16 v[32:35], v[128:131], v[64:67], v[32:35]
    v_mfma_f32_16x16x32_bf16 v[36:39], v[132:135], v[64:67], v[36:39]
    v_mfma_f32_16x16x32_bf16 v[40:43], v[136:139], v[64:67], v[40:43]
    v_mfma_f32_16x16x32_bf16 v[44:47], v[140:143], v[64:67], v[44:47]
    v_mfma_f32_16x16x32_bf16 v[48:51], v[144:147], v[64:67], v[48:51]
    s_nop 2
    s_nop 4
    v_cvt_pk_bf16_f32 v16, v32, v33
    v_cvt_pk_bf16_f32 v17, v34, v35
    v_cvt_pk_bf16_f32 v18, v36, v37
    v_cvt_pk_bf16_f32 v19, v38, v39
    buffer_store_dwordx4 v[16:19], v3, s[8:11], s30 offen
    v_cvt_pk_bf16_f32 v24, v48, v49
    v_cvt_pk_bf16_f32 v56, v48, v49
    v_cvt_pk_bf16_f32 v58, v48, v49
    v_cvt_pk_bf16_f32 v25, v50, v51
    v_cvt_pk_bf16_f32 v57, v50, v51
    v_cvt_pk_bf16_f32 v59, v50, v51
    v_cvt_pk_bf16_f32 v20, v40, v41
    v_cvt_pk_bf16_f32 v21, v42, v43
    v_cvt_pk_bf16_f32 v22, v44, v45
    v_cvt_pk_bf16_f32 v23, v46, v47
    buffer_store_dwordx4 v[20:23], v3, s[8:11], s30 offen offset:1024
    v_permlane16_swap_b32 v56, v58
    v_permlane16_swap_b32 v57, v59
    s_mov_b32 exec_lo, 0xffff
    s_mov_b32 exec_hi, 0xffff
    buffer_store_dwordx4 v[56:59], v14, s[8:11], s31 offen
    s_mov_b64 exec, -1
    v_pk_add_f32 v[10:11], v[32:33], v[34:35]
    v_pk_mul_f32 v[12:13], v[32:33], v[32:33]
    v_pk_fma_f32 v[12:13], v[34:35], v[34:35], v[12:13]
    v_pk_add_f32 v[10:11], v[10:11], v[36:37]
    v_pk_fma_f32 v[12:13], v[36:37], v[36:37], v[12:13]
    v_pk_add_f32 v[10:11], v[10:11], v[38:39]
    v_pk_fma_f32 v[12:13], v[38:39], v[38:39], v[12:13]
    v_pk_add_f32 v[10:11], v[10:11], v[40:41]
    v_pk_fma_f32 v[12:13], v[40:41], v[40:41], v[12:13]
    v_pk_add_f32 v[10:11], v[10:11], v[42:43]
    v_pk_fma_f32 v[12:13], v[42:43], v[42:43], v[12:13]
    v_pk_add_f32 v[10:11], v[10:11], v[44:45]
    v_pk_fma_f32 v[12:13], v[44:45], v[44:45], v[12:13]
    v_pk_add_f32 v[10:11], v[10:11], v[46:47]
    v_pk_fma_f32 v[12:13], v[46:47], v[46:47], v[12:13]
    v_pk_add_f32 v[10:11], v[10:11], v[48:49]
    v_pk_fma_f32 v[12:13], v[48:49], v[48:49], v[12:13]
    v_pk_add_f32 v[10:11], v[10:11], v[50:51]
    v_pk_fma_f32 v[12:13], v[50:51], v[50:51], v[12:13]
    v_add_f32 v10, v10, v11
    v_add_f32 v11, v12, v13
    v_mov_b32 v12, v10
    v_mov_b32 v13, v11
    s_nop 1
    v_permlane32_swap_b32 v10, v12
    v_permlane32_swap_b32 v11, v13
    s_nop 0
    v_pk_add_f32 v[10:11], v[10:11], v[12:13]
    v_mov_b32 v12, v10
    v_mov_b32 v13, v11
    s_nop 1
    v_permlane16_swap_b32 v10, v12
    v_permlane16_swap_b32 v11, v13
    s_nop 0
    v_pk_add_f32 v[10:11], v[10:11], v[12:13]
    s_mov_b64 exec, 0xffff
    buffer_store_dwordx2 v[10:11], v26, s[8:11], s29 offen
    s_mov_b64 exec, -1
    s_nop 1
    s_lshr_b32 s28, s19, 10
    s_add_u32 s28, s28, 0xc12180
    s_lshr_b32 s29, s15, 1
    s_lshl_b32 s29, s29, 9
    s_add_u32 s53, s28, s29
    s_and_b32 s29, s15, 1
    s_lshl_b32 s29, s29, 3
    s_add_u32 s29, s29, s16
    s_lshl_b32 s29, s29, 2
    s_add_u32 s53, s53, s29
    s_mov_b32 s29, s13
    s_lshl_b32 s29, s29, 9
    s_add_u32 s94, s28, s29
    v_lshlrev_b32 v13, 2, v1
    s_waitcnt vmcnt(0)
    s_barrier
    s_cmp_lg_u32 s12, 0
    s_cbranch_scc1 L_mega_15
    s_mov_b64 exec, 1
    s_cmp_lg_u32 s3, 0
    s_cbranch_scc1 L_mega_16
    buffer_wbl2 sc1
    s_waitcnt vmcnt(0)
    buffer_store_dword v15, off, s[8:11], s53 sc0 sc1
    s_mov_b64 exec, -1
    s_branch L_mega_15
L_mega_16:
    buffer_store_dword v15, off, s[8:11], s53
    s_mov_b64 exec, -1
L_mega_15:
    s_cmp_lg_u32 s12, 1
    s_cbranch_scc1 L_mega_14
    s_mov_b32 s95, 0x40000
    s_mov_b64 exec, 0xffff
L_mega_17:
    buffer_load_dword v14, v13, s[8:11], s94 offen sc1
    s_waitcnt vmcnt(0)
    v_cmp_ne_u32 vcc, 1, v14
    s_sub_u32 s95, s95, 1
    s_cbranch_vccz L_mega_17_x
    s_cbranch_scc0 L_mega_17
L_mega_17_x:
    s_mov_b64 exec, -1
L_mega_14:
    s_barrier
    v_lshlrev_b32 v9, 15, v8
    v_lshl_add_u32 v9, v7, 3, v9
    s_lshl_b32 s28, s13, 2
    s_add_u32 s28, s28, s12
    s_lshl_b32 s28, s28, 8
    s_add_u32 s28, s28, 0x1280000
    s_add_u32 s29, s28, 16384
    buffer_load_dwordx2 v[248:249], v9, s[8:11], s28 offen offset:0 sc1
    buffer_load_dwordx2 v[250:251], v9, s[8:11], s29 offen offset:0 sc1
    buffer_load_dwordx2 v[252:253], v9, s[8:11], s28 offen offset:128 sc1
    buffer_load_dwordx2 v[254:255], v9, s[8:11], s29 offen offset:128 sc1
    s_lshl_b32 s28, s13, 2
    s_add_u32 s28, s28, s12
    s_mul_i32 s28, s28, 110592
    s_add_u32 s28, s28, 0x2300000
    s_mul_i32 s29, s14, 3072
    s_add_u32 s30, s28, s29
    s_add_u32 s31, s30, 55296
    s_lshl_b32 s29, s14, 9
    s_add_u32 s29, s28, s29
    s_add_u32 s29, s29, 47104
    v_and_b32 v9, 1, v8
    v_mul_u32_u24 v9, 55296, v9
    v_lshrrev_b32 v12, 1, v8
    v_lshl_add_u32 v9, v12, 8, v9
    v_lshl_add_u32 v9, v7, 4, v9
    s_mul_i32 s28, s12, 2048
    v_add_u32 v27, 0x0, v3
    v_add_u32 v4, s28, v27
    v_add_u32 v28, 0xb000, v3
    v_add_u32 v5, s28, v28
    v_add_u32 v29, 0x16000, v3
    v_add_u32 v6, s28, v29
    s_mov_b32 s36, 3
    s_barrier
    ds_read_b128 v[144:147], v4 offset:0
    ds_read_b128 v[148:151], v4 offset:1024
    ds_read_b128 v[160:163], v27 offset:8192
    ds_read_b128 v[164:167], v27 offset:9216
    ds_read_b128 v[168:171], v27 offset:10240
    ds_read_b128 v[172:175], v27 offset:11264
    ds_read_b128 v[176:179], v27 offset:12288
    ds_read_b128 v[180:183], v27 offset:13312
    ds_read_b128 v[184:187], v27 offset:14336
    s_waitcnt lgkmcnt(0)
    v_mfma_f32_16x16x32_bf16 v[32:35], v[160:163], v[144:147], 0
    ds_read_b128 v[188:191], v27 offset:15360
    v_mfma_f32_16x16x32_bf16 v[88:91], v[160:163], v[148:151], 0
    ds_read_b128 v[192:195], v27 offset:16384
    v_mfma_f32_16x16x32_bf16 v[36:39], v[164:167], v[144:147], 0
    ds_read_b128 v[196:199], v27 offset:17408
    v_mfma_f32_16x16x32_bf16 v[92:95], v[164:167], v[148:151], 0
    ds_read_b128 v[200:203], v27 offset:18432
    v_mfma_f32_16x16x32_bf16 v[40:43], v[168:171], v[144:147], 0
    ds_read_b128 v[204:207], v27 offset:19456
    v_mfma_f32_16x16x32_bf16 v[96:99], v[168:171], v[148:151], 0
    ds_read_b128 v[208:211], v27 offset:20480
    v_mfma_f32_16x16x32_bf16 v[44:47], v[172:175], v[144:147], 0
    ds_read_b128 v[212:215], v27 offset:21504
    v_mfma_f32_16x16x32_bf16 v[100:103], v[172:175], v[148:151], 0
    v_mfma_f32_16x16x32_bf16 v[48:51], v[176:179], v[144:147], 0
    v_mfma_f32_16x16x32_bf16 v[104:107], v[176:179], v[148:151], 0
    v_mfma_f32_16x16x32_bf16 v[52:55], v[180:183], v[144:147], 0
    v_mfma_f32_16x16x32_bf16 v[108:111], v[180:183], v[148:151], 0
    v_mfma_f32_16x16x32_bf16 v[56:59], v[184:187], v[144:147], 0
    v_mfma_f32_16x16x32_bf16 v[112:115], v[184:187], v[148:151], 0
    s_waitcnt lgkmcnt(0)
    v_mfma_f32_16x16x32_bf16 v[60:63], v[188:191], v[144:147], 0
    ds_read_b128 v[152:155], v4 offset:22528
    v_mfma_f32_16x16x32_bf16 v[116:119], v[188:191], v[148:151], 0
    ds_read_b128 v[156:159], v4 offset:23552
    v_mfma_f32_16x16x32_bf16 v[64:67], v[192:195], v[144:147], 0
    ds_read_b128 v[160:163], v27 offset:30720
    v_mfma_f32_16x16x32_bf16 v[120:123], v[192:195], v[148:151], 0
    ds_read_b128 v[164:167], v27 offset:31744
    v_mfma_f32_16x16x32_bf16 v[68:71], v[196:199], v[144:147], 0
    ds_read_b128 v[168:171], v27 offset:32768
    v_mfma_f32_16x16x32_bf16 v[124:127], v[196:199], v[148:151], 0
    ds_read_b128 v[172:175], v27 offset:33792
    v_mfma_f32_16x16x32_bf16 v[72:75], v[200:203], v[144:147], 0
    ds_read_b128 v[176:179], v27 offset:34816
    v_mfma_f32_16x16x32_bf16 v[128:131], v[200:203], v[148:151], 0
    ds_read_b128 v[180:183], v27 offset:35840
    v_mfma_f32_16x16x32_bf16 v[76:79], v[204:207], v[144:147], 0
    ds_read_b128 v[184:187], v27 offset:36864
    v_mfma_f32_16x16x32_bf16 v[132:135], v[204:207], v[148:151], 0
    v_mfma_f32_16x16x32_bf16 v[80:83], v[208:211], v[144:147], 0
    v_mfma_f32_16x16x32_bf16 v[136:139], v[208:211], v[148:151], 0
    v_mfma_f32_16x16x32_bf16 v[84:87], v[212:215], v[144:147], 0
    v_mfma_f32_16x16x32_bf16 v[140:143], v[212:215], v[148:151], 0
    s_waitcnt lgkmcnt(0)
    v_mfma_f32_16x16x32_bf16 v[32:35], v[160:163], v[152:155], v[32:35]
    ds_read_b128 v[188:191], v27 offset:37888
    v_mfma_f32_16x16x32_bf16 v[88:91], v[160:163], v[156:159], v[88:91]
    ds_read_b128 v[192:195], v27 offset:38912
    v_mfma_f32_16x16x32_bf16 v[36:39], v[164:167], v[152:155], v[36:39]
    ds_read_b128 v[196:199], v27 offset:39936
    v_mfma_f32_16x16x32_bf16 v[92:95], v[164:167], v[156:159], v[92:95]
    ds_read_b128 v[200:203], v27 offset:40960
    v_mfma_f32_16x16x32_bf16 v[40:43], v[168:171], v[152:155], v[40:43]
    ds_read_b128 v[204:207], v27 offset:41984
    v_mfma_f32_16x16x32_bf16 v[96:99], v[168:171], v[156:159], v[96:99]
    ds_read_b128 v[208:211], v27 offset:43008
    v_mfma_f32_16x16x32_bf16 v[44:47], v[172:175], v[152:155], v[44:47]
    ds_read_b128 v[212:215], v27 offset:44032
    v_mfma_f32_16x16x32_bf16 v[100:103], v[172:175], v[156:159], v[100:103]
    v_mfma_f32_16x16x32_bf16 v[48:51], v[176:179], v[152:155], v[48:51]
    v_mfma_f32_16x16x32_bf16 v[104:107], v[176:179], v[156:159], v[104:107]
    v_mfma_f32_16x16x32_bf16 v[52:55], v[180:183], v[152:155], v[52:55]
    v_mfma_f32_16x16x32_bf16 v[108:111], v[180:183], v[156:159], v[108:111]
    v_mfma_f32_16x16x32_bf16 v[56:59], v[184:187], v[152:155], v[56:59]
    v_mfma_f32_16x16x32_bf16 v[112:115], v[184:187], v[156:159], v[112:115]
    s_waitcnt lgkmcnt(0)
    s_barrier
    v_mfma_f32_16x16x32_bf16 v[60:63], v[188:191], v[152:155], v[60:63]
    ds_read_b128 v[144:147], v5 offset:0
    v_mfma_f32_16x16x32_bf16 v[116:119], v[188:191], v[156:159], v[116:119]
    ds_read_b128 v[148:151], v5 offset:1024
    v_mfma_f32_16x16x32_bf16 v[64:67], v[192:195], v[152:155], v[64:67]
    ds_read_b128 v[160:163], v28 offset:8192
    v_mfma_f32_16x16x32_bf16 v[120:123], v[192:195], v[156:159], v[120:123]
    ds_read_b128 v[164:167], v28 offset:9216
    v_mfma_f32_16x16x32_bf16 v[68:71], v[196:199], v[152:155], v[68:71]
    ds_read_b128 v[168:171], v28 offset:10240
    v_mfma_f32_16x16x32_bf16 v[124:127], v[196:199], v[156:159], v[124:127]
    ds_read_b128 v[172:175], v28 offset:11264
    v_mfma_f32_16x16x32_bf16 v[72:75], v[200:203], v[152:155], v[72:75]
    ds_read_b128 v[176:179], v28 offset:12288
    v_mfma_f32_16x16x32_bf16 v[128:131], v[200:203], v[156:159], v[128:131]
    ds_read_b128 v[180:183], v28 offset:13312
    v_mfma_f32_16x16x32_bf16 v[76:79], v[204:207], v[152:155], v[76:79]
    ds_read_b128 v[184:187], v28 offset:14336
    v_mfma_f32_16x16x32_bf16 v[132:135], v[204:207], v[156:159], v[132:135]
    v_mfma_f32_16x16x32_bf16 v[80:83], v[208:211], v[152:155], v[80:83]
    v_mfma_f32_16x16x32_bf16 v[136:139], v[208:211], v[156:159], v[136:139]
    v_mfma_f32_16x16x32_bf16 v[84:87], v[212:215], v[152:155], v[84:87]
    v_mfma_f32_16x16x32_bf16 v[140:143], v[212:215], v[156:159], v[140:143]
    s_branch L_mega_18_mid
    .p2align 4
L_mega_18:
    s_waitcnt lgkmcnt(0)
    v_mfma_f32_16x16x32_bf16 v[32:35], v[160:163], v[144:147], v[32:35]
    ds_read_b128 v[188:191], v27 offset:15360
    v_mfma_f32_16x16x32_bf16 v[88:91], v[160:163], v[148:151], v[88:91]
    ds_read_b128 v[192:195], v27 offset:16384
    v_mfma_f32_16x16x32_bf16 v[36:39], v[164:167], v[144:147], v[36:39]
    ds_read_b128 v[196:199], v27 offset:17408
    v_mfma_f32_16x16x32_bf16 v[92:95], v[164:167], v[148:151], v[92:95]
    ds_read_b128 v[200:203], v27 offset:18432
    v_mfma_f32_16x16x32_bf16 v[40:43], v[168:171], v[144:147], v[40:43]
    ds_read_b128 v[204:207], v27 offset:19456
    v_mfma_f32_16x16x32_bf16 v[96:99], v[168:171], v[148:151], v[96:99]
    ds_read_b128 v[208:211], v27 offset:20480
    v_mfma_f32_16x16x32_bf16 v[44:47], v[172:175], v[144:147], v[44:47]
    ds_read_b128 v[212:215], v27 offset:21504
    v_mfma_f32_16x16x32_bf16 v[100:103], v[172:175], v[148:151], v[100:103]
    v_mfma_f32_16x16x32_bf16 v[48:51], v[176:179], v[144:147], v[48:51]
    v_mfma_f32_16x16x32_bf16 v[104:107], v[176:179], v[148:151], v[104:107]
    v_mfma_f32_16x16x32_bf16 v[52:55], v[180:183], v[144:147], v[52:55]
    v_mfma_f32_16x16x32_bf16 v[108:111], v[180:183], v[148:151], v[108:111]
    v_mfma_f32_16x16x32_bf16 v[56:59], v[184:187], v[144:147], v[56:59]
    v_mfma_f32_16x16x32_bf16 v[112:115], v[184:187], v[148:151], v[112:115]
    s_waitcnt lgkmcnt(0)
    v_mfma_f32_16x16x32_bf16 v[60:63], v[188:191], v[144:147], v[60:63]
    ds_read_b128 v[152:155], v4 offset:22528
    v_mfma_f32_16x16x32_bf16 v[116:119], v[188:191], v[148:151], v[116:119]
    ds_read_b128 v[156:159], v4 offset:23552
    v_mfma_f32_16x16x32_bf16 v[64:67], v[192:195], v[144:147], v[64:67]
    ds_read_b128 v[160:163], v27 offset:30720
    v_mfma_f32_16x16x32_bf16 v[120:123], v[192:195], v[148:151], v[120:123]
    ds_read_b128 v[164:167], v27 offset:31744
    v_mfma_f32_16x16x32_bf16 v[68:71], v[196:199], v[144:147], v[68:71]
    ds_read_b128 v[168:171], v27 offset:32768
    v_mfma_f32_16x16x32_bf16 v[124:127], v[196:199], v[148:151], v[124:127]
    ds_read_b128 v[172:175], v27 offset:33792
    v_mfma_f32_16x16x32_bf16 v[72:75], v[200:203], v[144:147], v[72:75]
    ds_read_b128 v[176:179], v27 offset:34816
    v_mfma_f32_16x16x32_bf16 v[128:131], v[200:203], v[148:151], v[128:131]
    ds_read_b128 v[180:183], v27 offset:35840
    v_mfma_f32_16x16x32_bf16 v[76:79], v[204:207], v[144:147], v[76:79]
    ds_read_b128 v[184:187], v27 offset:36864
    v_mfma_f32_16x16x32_bf16 v[132:135], v[204:207], v[148:151], v[132:135]
    v_mfma_f32_16x16x32_bf16 v[80:83], v[208:211], v[144:147], v[80:83]
    v_mfma_f32_16x16x32_bf16 v[136:139], v[208:211], v[148:151], v[136:139]
    v_mfma_f32_16x16x32_bf16 v[84:87], v[212:215], v[144:147], v[84:87]
    v_mfma_f32_16x16x32_bf16 v[140:143], v[212:215], v[148:151], v[140:143]
    s_waitcnt lgkmcnt(0)
    v_mfma_f32_16x16x32_bf16 v[32:35], v[160:163], v[152:155], v[32:35]
    ds_read_b128 v[188:191], v27 offset:37888
    v_mfma_f32_16x16x32_bf16 v[88:91], v[160:163], v[156:159], v[88:91]
    ds_read_b128 v[192:195], v27 offset:38912
    v_mfma_f32_16x16x32_bf16 v[36:39], v[164:167], v[152:155], v[36:39]
    ds_read_b128 v[196:199], v27 offset:39936
    v_mfma_f32_16x16x32_bf16 v[92:95], v[164:167], v[156:159], v[92:95]
    ds_read_b128 v[200:203], v27 offset:40960
    v_mfma_f32_16x16x32_bf16 v[40:43], v[168:171], v[152:155], v[40:43]
    ds_read_b128 v[204:207], v27 offset:41984
    v_mfma_f32_16x16x32_bf16 v[96:99], v[168:171], v[156:159], v[96:99]
    ds_read_b128 v[208:211], v27 offset:43008
    v_mfma_f32_16x16x32_bf16 v[44:47], v[172:175], v[152:155], v[44:47]
    ds_read_b128 v[212:215], v27 offset:44032
    v_mfma_f32_16x16x32_bf16 v[100:103], v[172:175], v[156:159], v[100:103]
    v_mfma_f32_16x16x32_bf16 v[48:51], v[176:179], v[152:155], v[48:51]
    v_mfma_f32_16x16x32_bf16 v[104:107], v[176:179], v[156:159], v[104:107]
    v_mfma_f32_16x16x32_bf16 v[52:55], v[180:183], v[152:155], v[52:55]
    v_mfma_f32_16x16x32_bf16 v[108:111], v[180:183], v[156:159], v[108:111]
    v_mfma_f32_16x16x32_bf16 v[56:59], v[184:187], v[152:155], v[56:59]
    v_mfma_f32_16x16x32_bf16 v[112:115], v[184:187], v[156:159], v[112:115]
    s_waitcnt lgkmcnt(0)
    s_barrier
    v_mfma_f32_16x16x32_bf16 v[60:63], v[188:191], v[152:155], v[60:63]
    ds_read_b128 v[144:147], v5 offset:0
    v_mfma_f32_16x16x32_bf16 v[116:119], v[188:191], v[156:159], v[116:119]
    ds_read_b128 v[148:151], v5 offset:1024
    v_mfma_f32_16x16x32_bf16 v[64:67], v[192:195], v[152:155], v[64:67]
    ds_read_b128 v[160:163], v28 offset:8192
    v_mfma_f32_16x16x32_bf16 v[120:123], v[192:195], v[156:159], v[120:123]
    ds_read_b128 v[164:167], v28 offset:9216
    v_mfma_f32_16x16x32_bf16 v[68:71], v[196:199], v[152:155], v[68:71]
    ds_read_b128 v[168:171], v28 offset:10240
    v_mfma_f32_16x16x32_bf16 v[124:127], v[196:199], v[156:159], v[124:127]
    ds_read_b128 v[172:175], v28 offset:11264
    v_mfma_f32_16x16x32_bf16 v[72:75], v[200:203], v[152:155], v[72:75]
    ds_read_b128 v[176:179], v28 offset:12288
    v_mfma_f32_16x16x32_bf16 v[128:131], v[200:203], v[156:159], v[128:131]
    ds_read_b128 v[180:183], v28 offset:13312
    v_mfma_f32_16x16x32_bf16 v[76:79], v[204:207], v[152:155], v[76:79]
    ds_read_b128 v[184:187], v28 offset:14336
    v_mfma_f32_16x16x32_bf16 v[132:135], v[204:207], v[156:159], v[132:135]
    v_mfma_f32_16x16x32_bf16 v[80:83], v[208:211], v[152:155], v[80:83]
    v_mfma_f32_16x16x32_bf16 v[136:139], v[208:211], v[156:159], v[136:139]
    v_mfma_f32_16x16x32_bf16 v[84:87], v[212:215], v[152:155], v[84:87]
    v_mfma_f32_16x16x32_bf16 v[140:143], v[212:215], v[156:159], v[140:143]
L_mega_18_mid:
    s_waitcnt lgkmcnt(0)
    v_mfma_f32_16x16x32_bf16 v[32:35], v[160:163], v[144:147], v[32:35]
    ds_read_b128 v[188:191], v28 offset:15360
    v_mfma_f32_16x16x32_bf16 v[88:91], v[160:163], v[148:151], v[88:91]
    ds_read_b128 v[192:195], v28 offset:16384
    v_mfma_f32_16x16x32_bf16 v[36:39], v[164:167], v[144:147], v[36:39]
    ds_read_b128 v[196:199], v28 offset:17408
    v_mfma_f32_16x16x32_bf16 v[92:95], v[164:167], v[148:151], v[92:95]
    ds_read_b128 v[200:203], v28 offset:18432
    v_mfma_f32_16x16x32_bf16 v[40:43], v[168:171], v[144:147], v[40:43]
    ds_read_b128 v[204:207], v28 offset:19456
    v_mfma_f32_16x16x32_bf16 v[96:99], v[168:171], v[148:151], v[96:99]
    ds_read_b128 v[208:211], v28 offset:20480
    v_mfma_f32_16x16x32_bf16 v[44:47], v[172:175], v[144:147], v[44:47]
    ds_read_b128 v[212:215], v28 offset:21504
    v_mfma_f32_16x16x32_bf16 v[100:103], v[172:175], v[148:151], v[100:103]
    v_mfma_f32_16x16x32_bf16 v[48:51], v[176:179], v[144:147], v[48:51]
    v_mfma_f32_16x16x32_bf16 v[104:107], v[176:179], v[148:151], v[104:107]
    v_mfma_f32_16x16x32_bf16 v[52:55], v[180:183], v[144:147], v[52:55]
    v_mfma_f32_16x16x32_bf16 v[108:111], v[180:183], v[148:151], v[108:111]
    v_mfma_f32_16x16x32_bf16 v[56:59], v[184:187], v[144:147], v[56:59]
    v_mfma_f32_16x16x32_bf16 v[112:115], v[184:187], v[148:151], v[112:115]
    s_waitcnt lgkmcnt(0)
    v_mfma_f32_16x16x32_bf16 v[60:63], v[188:191], v[144:147], v[60:63]
    ds_read_b128 v[152:155], v5 offset:22528
    v_mfma_f32_16x16x32_bf16 v[116:119], v[188:191], v[148:151], v[116:119]
    ds_read_b128 v[156:159], v5 offset:23552
    v_mfma_f32_16x16x32_bf16 v[64:67], v[192:195], v[144:147], v[64:67]
    ds_read_b128 v[160:163], v28 offset:30720
    v_mfma_f32_16x16x32_bf16 v[120:123], v[192:195], v[148:151], v[120:123]
    ds_read_b128 v[164:167], v28 offset:31744
    v_mfma_f32_16x16x32_bf16 v[68:71], v[196:199], v[144:147], v[68:71]
    ds_read_b128 v[168:171], v28 offset:32768
    v_mfma_f32_16x16x32_bf16 v[124:127], v[196:199], v[148:151], v[124:127]
    ds_read_b128 v[172:175], v28 offset:33792
    v_mfma_f32_16x16x32_bf16 v[72:75], v[200:203], v[144:147], v[72:75]
    ds_read_b128 v[176:179], v28 offset:34816
    v_mfma_f32_16x16x32_bf16 v[128:131], v[200:203], v[148:151], v[128:131]
    ds_read_b128 v[180:183], v28 offset:35840
    v_mfma_f32_16x16x32_bf16 v[76:79], v[204:207], v[144:147], v[76:79]
    ds_read_b128 v[184:187], v28 offset:36864
    v_mfma_f32_16x16x32_bf16 v[132:135], v[204:207], v[148:151], v[132:135]
    v_mfma_f32_16x16x32_bf16 v[80:83], v[208:211], v[144:147], v[80:83]
    v_mfma_f32_16x16x32_bf16 v[136:139], v[208:211], v[148:151], v[136:139]
    v_mfma_f32_16x16x32_bf16 v[84:87], v[212:215], v[144:147], v[84:87]
    v_mfma_f32_16x16x32_bf16 v[140:143], v[212:215], v[148:151], v[140:143]
    s_waitcnt lgkmcnt(0)
    v_mfma_f32_16x16x32_bf16 v[32:35], v[160:163], v[152:155], v[32:35]
    ds_read_b128 v[188:191], v28 offset:37888
    v_mfma_f32_16x16x32_bf16 v[88:91], v[160:163], v[156:159], v[88:91]
    ds_read_b128 v[192:195], v28 offset:38912
    v_mfma_f32_16x16x32_bf16 v[36:39], v[164:167], v[152:155], v[36:39]
    ds_read_b128 v[196:199], v28 offset:39936
    v_mfma_f32_16x16x32_bf16 v[92:95], v[164:167], v[156:159], v[92:95]
    ds_read_b128 v[200:203], v28 offset:40960
    v_mfma_f32_16x16x32_bf16 v[40:43], v[168:171], v[152:155], v[40:43]
    ds_read_b128 v[204:207], v28 offset:41984
    v_mfma_f32_16x16x32_bf16 v[96:99], v[168:171], v[156:159], v[96:99]
    ds_read_b128 v[208:211], v28 offset:43008
    v_mfma_f32_16x16x32_bf16 v[44:47], v[172:175], v[152:155], v[44:47]
    ds_read_b128 v[212:215], v28 offset:44032
    v_mfma_f32_16x16x32_bf16 v[100:103], v[172:175], v[156:159], v[100:103]
    v_mfma_f32_16x16x32_bf16 v[48:51], v[176:179], v[152:155], v[48:51]
    v_mfma_f32_16x16x32_bf16 v[104:107], v[176:179], v[156:159], v[104:107]
    v_mfma_f32_16x16x32_bf16 v[52:55], v[180:183], v[152:155], v[52:55]
    v_mfma_f32_16x16x32_bf16 v[108:111], v[180:183], v[156:159], v[108:111]
    v_mfma_f32_16x16x32_bf16 v[56:59], v[184:187], v[152:155], v[56:59]
    v_mfma_f32_16x16x32_bf16 v[112:115], v[184:187], v[156:159], v[112:115]
    s_waitcnt lgkmcnt(0)
    s_barrier
    v_mfma_f32_16x16x32_bf16 v[60:63], v[188:191], v[152:155], v[60:63]
    ds_read_b128 v[144:147], v6 offset:0
    v_mfma_f32_16x16x32_bf16 v[116:119], v[188:191], v[156:159], v[116:119]
    ds_read_b128 v[148:151], v6 offset:1024
    v_mfma_f32_16x16x32_bf16 v[64:67], v[192:195], v[152:155], v[64:67]
    ds_read_b128 v[160:163], v29 offset:8192
    v_mfma_f32_16x16x32_bf16 v[120:123], v[192:195], v[156:159], v[120:123]
    ds_read_b128 v[164:167], v29 offset:9216
    v_mfma_f32_16x16x32_bf16 v[68:71], v[196:199], v[152:155], v[68:71]
    ds_read_b128 v[168:171], v29 offset:10240
    v_mfma_f32_16x16x32_bf16 v[124:127], v[196:199], v[156:159], v[124:127]
    ds_read_b128 v[172:175], v29 offset:11264
    v_mfma_f32_16x16x32_bf16 v[72:75], v[200:203], v[152:155], v[72:75]
    ds_read_b128 v[176:179], v29 offset:12288
    v_mfma_f32_16x16x32_bf16 v[128:131], v[200:203], v[156:159], v[128:131]
    ds_read_b128 v[180:183], v29 offset:13312
    v_mfma_f32_16x16x32_bf16 v[76:79], v[204:207], v[152:155], v[76:79]
    ds_read_b128 v[184:187], v29 offset:14336
    v_mfma_f32_16x16x32_bf16 v[132:135], v[204:207], v[156:159], v[132:135]
    v_mfma_f32_16x16x32_bf16 v[80:83], v[208:211], v[152:155], v[80:83]
    v_mfma_f32_16x16x32_bf16 v[136:139], v[208:211], v[156:159], v[136:139]
    v_mfma_f32_16x16x32_bf16 v[84:87], v[212:215], v[152:155], v[84:87]
    v_mfma_f32_16x16x32_bf16 v[140:143], v[212:215], v[156:159], v[140:143]
    s_waitcnt lgkmcnt(0)
    v_mfma_f32_16x16x32_bf16 v[32:35], v[160:163], v[144:147], v[32:35]
    ds_read_b128 v[188:191], v29 offset:15360
    v_mfma_f32_16x16x32_bf16 v[88:91], v[160:163], v[148:151], v[88:91]
    ds_read_b128 v[192:195], v29 offset:16384
    v_mfma_f32_16x16x32_bf16 v[36:39], v[164:167], v[144:147], v[36:39]
    ds_read_b128 v[196:199], v29 offset:17408
    v_mfma_f32_16x16x32_bf16 v[92:95], v[164:167], v[148:151], v[92:95]
    ds_read_b128 v[200:203], v29 offset:18432
    v_mfma_f32_16x16x32_bf16 v[40:43], v[168:171], v[144:147], v[40:43]
    ds_read_b128 v[204:207], v29 offset:19456
    v_mfma_f32_16x16x32_bf16 v[96:99], v[168:171], v[148:151], v[96:99]
    ds_read_b128 v[208:211], v29 offset:20480
    v_mfma_f32_16x16x32_bf16 v[44:47], v[172:175], v[144:147], v[44:47]
    ds_read_b128 v[212:215], v29 offset:21504
    v_mfma_f32_16x16x32_bf16 v[100:103], v[172:175], v[148:151], v[100:103]
    v_mfma_f32_16x16x32_bf16 v[48:51], v[176:179], v[144:147], v[48:51]
    v_mfma_f32_16x16x32_bf16 v[104:107], v[176:179], v[148:151], v[104:107]
    v_mfma_f32_16x16x32_bf16 v[52:55], v[180:183], v[144:147], v[52:55]
    v_mfma_f32_16x16x32_bf16 v[108:111], v[180:183], v[148:151], v[108:111]
    v_mfma_f32_16x16x32_bf16 v[56:59], v[184:187], v[144:147], v[56:59]
    v_mfma_f32_16x16x32_bf16 v[112:115], v[184:187], v[148:151], v[112:115]
    s_waitcnt lgkmcnt(0)
    v_mfma_f32_16x16x32_bf16 v[60:63], v[188:191], v[144:147], v[60:63]
    ds_read_b128 v[152:155], v6 offset:22528
    v_mfma_f32_16x16x32_bf16 v[116:119], v[188:191], v[148:151], v[116:119]
    ds_read_b128 v[156:159], v6 offset:23552
    v_mfma_f32_16x16x32_bf16 v[64:67], v[192:195], v[144:147], v[64:67]
    ds_read_b128 v[160:163], v29 offset:30720
    v_mfma_f32_16x16x32_bf16 v[120:123], v[192:195], v[148:151], v[120:123]
    ds_read_b128 v[164:167], v29 offset:31744
    v_mfma_f32_16x16x32_bf16 v[68:71], v[196:199], v[144:147], v[68:71]
    ds_read_b128 v[168:171], v29 offset:32768
    v_mfma_f32_16x16x32_bf16 v[124:127], v[196:199], v[148:151], v[124:127]
    ds_read_b128 v[172:175], v29 offset:33792
    v_mfma_f32_16x16x32_bf16 v[72:75], v[200:203], v[144:147], v[72:75]
    ds_read_b128 v[176:179], v29 offset:34816
    v_mfma_f32_16x16x32_bf16 v[128:131], v[200:203], v[148:151], v[128:131]
    ds_read_b128 v[180:183], v29 offset:35840
    v_mfma_f32_16x16x32_bf16 v[76:79], v[204:207], v[144:147], v[76:79]
    ds_read_b128 v[184:187], v29 offset:36864
    v_mfma_f32_16x16x32_bf16 v[132:135], v[204:207], v[148:151], v[132:135]
    v_mfma_f32_16x16x32_bf16 v[80:83], v[208:211], v[144:147], v[80:83]
    v_mfma_f32_16x16x32_bf16 v[136:139], v[208:211], v[148:151], v[136:139]
    v_mfma_f32_16x16x32_bf16 v[84:87], v[212:215], v[144:147], v[84:87]
    v_mfma_f32_16x16x32_bf16 v[140:143], v[212:215], v[148:151], v[140:143]
    s_waitcnt lgkmcnt(0)
    v_mfma_f32_16x16x32_bf16 v[32:35], v[160:163], v[152:155], v[32:35]
    ds_read_b128 v[188:191], v29 offset:37888
    v_mfma_f32_16x16x32_bf16 v[88:91], v[160:163], v[156:159], v[88:91]
    ds_read_b128 v[192:195], v29 offset:38912
    v_mfma_f32_16x16x32_bf16 v[36:39], v[164:167], v[152:155], v[36:39]
    ds_read_b128 v[196:199], v29 offset:39936
    v_mfma_f32_16x16x32_bf16 v[92:95], v[164:167], v[156:159], v[92:95]
    ds_read_b128 v[200:203], v29 offset:40960
    v_mfma_f32_16x16x32_bf16 v[40:43], v[168:171], v[152:155], v[40:43]
    ds_read_b128 v[204:207], v29 offset:41984
    v_mfma_f32_16x16x32_bf16 v[96:99], v[168:171], v[156:159], v[96:99]
    ds_read_b128 v[208:211], v29 offset:43008
    v_mfma_f32_16x16x32_bf16 v[44:47], v[172:175], v[152:155], v[44:47]
    ds_read_b128 v[212:215], v29 offset:44032
    v_mfma_f32_16x16x32_bf16 v[100:103], v[172:175], v[156:159], v[100:103]
    v_mfma_f32_16x16x32_bf16 v[48:51], v[176:179], v[152:155], v[48:51]
    v_mfma_f32_16x16x32_bf16 v[104:107], v[176:179], v[156:159], v[104:107]
    v_mfma_f32_16x16x32_bf16 v[52:55], v[180:183], v[152:155], v[52:55]
    v_mfma_f32_16x16x32_bf16 v[108:111], v[180:183], v[156:159], v[108:111]
    v_mfma_f32_16x16x32_bf16 v[56:59], v[184:187], v[152:155], v[56:59]
    v_mfma_f32_16x16x32_bf16 v[112:115], v[184:187], v[156:159], v[112:115]
    s_waitcnt lgkmcnt(0)
    s_barrier
    v_mfma_f32_16x16x32_bf16 v[60:63], v[188:191], v[152:155], v[60:63]
    ds_read_b128 v[144:147], v4 offset:0
    v_mfma_f32_16x16x32_bf16 v[116:119], v[188:191], v[156:159], v[116:119]
    ds_read_b128 v[148:151], v4 offset:1024
    v_mfma_f32_16x16x32_bf16 v[64:67], v[192:195], v[152:155], v[64:67]
    ds_read_b128 v[160:163], v27 offset:8192
    v_mfma_f32_16x16x32_bf16 v[120:123], v[192:195], v[156:159], v[120:123]
    ds_read_b128 v[164:167], v27 offset:9216
    v_mfma_f32_16x16x32_bf16 v[68:71], v[196:199], v[152:155], v[68:71]
    ds_read_b128 v[168:171], v27 offset:10240
    v_mfma_f32_16x16x32_bf16 v[124:127], v[196:199], v[156:159], v[124:127]
    ds_read_b128 v[172:175], v27 offset:11264
    v_mfma_f32_16x16x32_bf16 v[72:75], v[200:203], v[152:155], v[72:75]
    ds_read_b128 v[176:179], v27 offset:12288
    v_mfma_f32_16x16x32_bf16 v[128:131], v[200:203], v[156:159], v[128:131]
    ds_read_b128 v[180:183], v27 offset:13312
    v_mfma_f32_16x16x32_bf16 v[76:79], v[204:207], v[152:155], v[76:79]
    ds_read_b128 v[184:187], v27 offset:14336
    v_mfma_f32_16x16x32_bf16 v[132:135], v[204:207], v[156:159], v[132:135]
    s_sub_u32 s36, s36, 1
    v_mfma_f32_16x16x32_bf16 v[80:83], v[208:211], v[152:155], v[80:83]
    s_cmp_lg_u32 s36, 0
    v_mfma_f32_16x16x32_bf16 v[136:139], v[208:211], v[156:159], v[136:139]
    v_mfma_f32_16x16x32_bf16 v[84:87], v[212:215], v[152:155], v[84:87]
    v_mfma_f32_16x16x32_bf16 v[140:143], v[212:215], v[156:159], v[140:143]
    s_cbranch_scc1 L_mega_18
    s_waitcnt lgkmcnt(0)
    v_mfma_f32_16x16x32_bf16 v[32:35], v[160:163], v[144:147], v[32:35]
    ds_read_b128 v[188:191], v27 offset:15360
    s_waitcnt vmcnt(0)
    v_mfma_f32_16x16x32_bf16 v[88:91], v[160:163], v[148:151], v[88:91]
    ds_read_b128 v[192:195], v27 offset:16384
    v_add_f32 v248, v248, v250
    v_mfma_f32_16x16x32_bf16 v[36:39], v[164:167], v[144:147], v[36:39]
    ds_read_b128 v[196:199], v27 offset:17408
    v_add_f32 v249, v249, v251
    v_mfma_f32_16x16x32_bf16 v[92:95], v[164:167], v[148:151], v[92:95]
    ds_read_b128 v[200:203], v27 offset:18432
    v_add_f32 v252, v252, v254
    v_mfma_f32_16x16x32_bf16 v[40:43], v[168:171], v[144:147], v[40:43]
    ds_read_b128 v[204:207], v27 offset:19456
    v_add_f32 v253, v253, v255
    v_mfma_f32_16x16x32_bf16 v[96:99], v[168:171], v[148:151], v[96:99]
    ds_read_b128 v[208:211], v27 offset:20480
    v_mov_b32 v250, v248
    v_mfma_f32_16x16x32_bf16 v[44:47], v[172:175], v[144:147], v[44:47]
    ds_read_b128 v[212:215], v27 offset:21504
    v_mov_b32 v251, v249
    v_mfma_f32_16x16x32_bf16 v[100:103], v[172:175], v[148:151], v[100:103]
    v_mov_b32 v254, v252
    v_mfma_f32_16x16x32_bf16 v[48:51], v[176:179], v[144:147], v[48:51]
    v_mov_b32 v255, v253
    v_mfma_f32_16x16x32_bf16 v[104:107], v[176:179], v[148:151], v[104:107]
    s_nop 1
    v_mfma_f32_16x16x32_bf16 v[52:55], v[180:183], v[144:147], v[52:55]
    v_permlane32_swap_b32 v248, v250
    v_mfma_f32_16x16x32_bf16 v[108:111], v[180:183], v[148:151], v[108:111]
    v_permlane32_swap_b32 v249, v251
    v_mfma_f32_16x16x32_bf16 v[56:59], v[184:187], v[144:147], v[56:59]
    v_permlane32_swap_b32 v252, v254
    v_mfma_f32_16x16x32_bf16 v[112:115], v[184:187], v[148:151], v[112:115]
    v_permlane32_swap_b32 v253, v255
    s_waitcnt lgkmcnt(0)
    v_mfma_f32_16x16x32_bf16 v[60:63], v[188:191], v[144:147], v[60:63]
    ds_read_b128 v[152:155], v4 offset:22528
    s_nop 0
    v_mfma_f32_16x16x32_bf16 v[116:119], v[188:191], v[148:151], v[116:119]
    ds_read_b128 v[156:159], v4 offset:23552
    v_add_f32 v248, v248, v250
    v_mfma_f32_16x16x32_bf16 v[64:67], v[192:195], v[144:147], v[64:67]
    ds_read_b128 v[160:163], v27 offset:30720
    v_add_f32 v249, v249, v251
    v_mfma_f32_16x16x32_bf16 v[120:123], v[192:195], v[148:151], v[120:123]
    ds_read_b128 v[164:167], v27 offset:31744
    v_add_f32 v252, v252, v254
    v_mfma_f32_16x16x32_bf16 v[68:71], v[196:199], v[144:147], v[68:71]
    ds_read_b128 v[168:171], v27 offset:32768
    v_add_f32 v253, v253, v255
    v_mfma_f32_16x16x32_bf16 v[124:127], v[196:199], v[148:151], v[124:127]
    ds_read_b128 v[172:175], v27 offset:33792
    v_mov_b32 v250, v248
    v_mfma_f32_16x16x32_bf16 v[72:75], v[200:203], v[144:147], v[72:75]
    ds_read_b128 v[176:179], v27 offset:34816
    v_mov_b32 v251, v249
    v_mfma_f32_16x16x32_bf16 v[128:131], v[200:203], v[148:151], v[128:131]
    ds_read_b128 v[180:183], v27 offset:35840
    v_mov_b32 v254, v252
    v_mfma_f32_16x16x32_bf16 v[76:79], v[204:207], v[144:147], v[76:79]
    ds_read_b128 v[184:187], v27 offset:36864
    v_mov_b32 v255, v253
    v_mfma_f32_16x16x32_bf16 v[132:135], v[204:207], v[148:151], v[132:135]
    s_nop 1
    v_mfma_f32_16x16x32_bf16 v[80:83], v[208:211], v[144:147], v[80:83]
    v_permlane16_swap_b32 v248, v250
    v_mfma_f32_16x16x32_bf16 v[136:139], v[208:211], v[148:151], v[136:139]
    v_permlane16_swap_b32 v249, v251
    v_mfma_f32_16x16x32_bf16 v[84:87], v[212:215], v[144:147], v[84:87]
    v_permlane16_swap_b32 v252, v254
    v_mfma_f32_16x16x32_bf16 v[140:143], v[212:215], v[148:151], v[140:143]
    v_permlane16_swap_b32 v253, v255
    s_waitcnt lgkmcnt(0)
    v_mfma_f32_16x16x32_bf16 v[32:35], v[160:163], v[152:155], v[32:35]
    ds_read_b128 v[188:191], v27 offset:37888
    s_nop 0
    v_mfma_f32_16x16x32_bf16 v[88:91], v[160:163], v[156:159], v[88:91]
    ds_read_b128 v[192:195], v27 offset:38912
    v_add_f32 v248, v248, v250
    v_mfma_f32_16x16x32_bf16 v[36:39], v[164:167], v[152:155], v[36:39]
    ds_read_b128 v[196:199], v27 offset:39936
    v_add_f32 v249, v249, v251
    v_mfma_f32_16x16x32_bf16 v[92:95], v[164:167], v[156:159], v[92:95]
    ds_read_b128 v[200:203], v27 offset:40960
    v_add_f32 v252, v252, v254
    v_mfma_f32_16x16x32_bf16 v[40:43], v[168:171], v[152:155], v[40:43]
    ds_read_b128 v[204:207], v27 offset:41984
    v_add_f32 v253, v253, v255
    v_mfma_f32_16x16x32_bf16 v[96:99], v[168:171], v[156:159], v[96:99]
    ds_read_b128 v[208:211], v27 offset:43008
    v_mul_f32 v248, 0xbacccccd, v248
    v_mfma_f32_16x16x32_bf16 v[44:47], v[172:175], v[152:155], v[44:47]
    ds_read_b128 v[212:215], v27 offset:44032
    v_mul_f32 v249, 0x3acccccd, v249
    v_mfma_f32_16x16x32_bf16 v[100:103], v[172:175], v[156:159], v[100:103]
    v_cvt_pk_bf16_f32 v250, v248, v248
    v_mfma_f32_16x16x32_bf16 v[48:51], v[176:179], v[152:155], v[48:51]
    v_fma_f32 v249, -v248, v248, v249
    v_mfma_f32_16x16x32_bf16 v[104:107], v[176:179], v[156:159], v[104:107]
    v_and_b32 v251, 0xffff0000, v250
    v_mfma_f32_16x16x32_bf16 v[52:55], v[180:183], v[152:155], v[52:55]
    v_max_f32 v249, 0, v249
    v_mfma_f32_16x16x32_bf16 v[108:111], v[180:183], v[156:159], v[108:111]
    v_sub_f32 v251, v248, v251
    v_mfma_f32_16x16x32_bf16 v[56:59], v[184:187], v[152:155], v[56:59]
    v_add_f32 v249, 0x3727c5ac, v249
    v_mfma_f32_16x16x32_bf16 v[112:115], v[184:187], v[156:159], v[112:115]
    v_cvt_pk_bf16_f32 v251, v251, v251
    s_waitcnt lgkmcnt(0)
    v_mfma_f32_16x16x32_bf16 v[60:63], v[188:191], v[152:155], v[60:63]
    v_rsq_f32 v10, v249
    v_mfma_f32_16x16x32_bf16 v[116:119], v[188:191], v[156:159], v[116:119]
    v_mul_f32 v252, 0xbacccccd, v252
    v_mfma_f32_16x16x32_bf16 v[64:67], v[192:195], v[152:155], v[64:67]
    v_mul_f32 v253, 0x3acccccd, v253
    v_mfma_f32_16x16x32_bf16 v[120:123], v[192:195], v[156:159], v[120:123]
    v_cvt_pk_bf16_f32 v254, v252, v252
    v_mfma_f32_16x16x32_bf16 v[68:71], v[196:199], v[152:155], v[68:71]
    v_fma_f32 v253, -v252, v252, v253
    v_mfma_f32_16x16x32_bf16 v[124:127], v[196:199], v[156:159], v[124:127]
    v_and_b32 v255, 0xffff0000, v254
    v_mfma_f32_16x16x32_bf16 v[72:75], v[200:203], v[152:155], v[72:75]
    v_max_f32 v253, 0, v253
    v_mfma_f32_16x16x32_bf16 v[128:131], v[200:203], v[156:159], v[128:131]
    v_sub_f32 v255, v252, v255
    v_mfma_f32_16x16x32_bf16 v[76:79], v[204:207], v[152:155], v[76:79]
    v_add_f32 v253, 0x3727c5ac, v253
    v_mfma_f32_16x16x32_bf16 v[132:135], v[204:207], v[156:159], v[132:135]
    v_cvt_pk_bf16_f32 v255, v255, v255
    v_mfma_f32_16x16x32_bf16 v[80:83], v[208:211], v[152:155], v[80:83]
    v_rsq_f32 v11, v253
    v_mfma_f32_16x16x32_bf16 v[136:139], v[208:211], v[156:159], v[136:139]
    s_nop 0
    v_mfma_f32_16x16x32_bf16 v[84:87], v[212:215], v[152:155], v[84:87]
    v_mul_f32 v10, v10, v10
    v_mfma_f32_16x16x32_bf16 v[140:143], v[212:215], v[156:159], v[140:143]
    v_mul_f32 v11, v11, v11
    s_nop 2
    v_mfma_f32_16x16x16_bf16 v[32:35], v[216:217], v[250:251], v[32:35]
    v_mfma_f32_16x16x16_bf16 v[88:91], v[216:217], v[254:255], v[88:91]
    v_mfma_f32_16x16x16_bf16 v[36:39], v[218:219], v[250:251], v[36:39]
    v_mfma_f32_16x16x16_bf16 v[92:95], v[218:219], v[254:255], v[92:95]
    v_mfma_f32_16x16x16_bf16 v[40:43], v[220:221], v[250:251], v[40:43]
    v_mfma_f32_16x16x16_bf16 v[96:99], v[220:221], v[254:255], v[96:99]
    v_mfma_f32_16x16x16_bf16 v[44:47], v[222:223], v[250:251], v[44:47]
    v_mfma_f32_16x16x16_bf16 v[100:103], v[222:223], v[254:255], v[100:103]
    v_mfma_f32_16x16x16_bf16 v[80:83], v[240:241], v[250:251], v[80:83]
    v_mfma_f32_16x16x16_bf16 v[136:139], v[240:241], v[254:255], v[136:139]
    v_mfma_f32_16x16x16_bf16 v[84:87], v[242:243], v[250:251], v[84:87]
    v_mfma_f32_16x16x16_bf16 v[140:143], v[242:243], v[254:255], v[140:143]
    v_max_f32 v32, 0, v32
    v_max_f32 v33, 0, v33
    v_max_f32 v34, 0, v34
    v_max_f32 v35, 0, v35
    v_pk_mul_f32 v[32:33], v[32:33], v[36:37]
    v_pk_mul_f32 v[34:35], v[34:35], v[38:39]
    v_pk_mul_f32 v[32:33], v[32:33], v[10:11] op_sel:[0,0] op_sel_hi:[1,0]
    v_pk_mul_f32 v[34:35], v[34:35], v[10:11] op_sel:[0,0] op_sel_hi:[1,0]
    v_cvt_pk_bf16_f32 v148, v32, v33
    v_cvt_pk_bf16_f32 v149, v34, v35
    v_mfma_f32_16x16x16_bf16 v[48:51], v[224:225], v[250:251], v[48:51]
    v_mfma_f32_16x16x16_bf16 v[104:107], v[224:225], v[254:255], v[104:107]
    v_mfma_f32_16x16x16_bf16 v[52:55], v[226:227], v[250:251], v[52:55]
    v_mfma_f32_16x16x16_bf16 v[108:111], v[226:227], v[254:255], v[108:111]
    v_max_f32 v40, 0, v40
    v_max_f32 v41, 0, v41
    v_max_f32 v42, 0, v42
    v_max_f32 v43, 0, v43
    v_pk_mul_f32 v[40:41], v[40:41], v[44:45]
    v_pk_mul_f32 v[42:43], v[42:43], v[46:47]
    v_pk_mul_f32 v[40:41], v[40:41], v[10:11] op_sel:[0,0] op_sel_hi:[1,0]
    v_pk_mul_f32 v[42:43], v[42:43], v[10:11] op_sel:[0,0] op_sel_hi:[1,0]
    v_cvt_pk_bf16_f32 v150, v40, v41
    v_cvt_pk_bf16_f32 v151, v42, v43
    v_mfma_f32_16x16x16_bf16 v[56:59], v[228:229], v[250:251], v[56:59]
    v_mfma_f32_16x16x16_bf16 v[112:115], v[228:229], v[254:255], v[112:115]
    v_mfma_f32_16x16x16_bf16 v[60:63], v[230:231], v[250:251], v[60:63]
    v_mfma_f32_16x16x16_bf16 v[116:119], v[230:231], v[254:255], v[116:119]
    buffer_store_dwordx4 v[148:151], v3, s[8:11], s30 offen offset:0
    v_max_f32 v88, 0, v88
    v_max_f32 v89, 0, v89
    v_max_f32 v90, 0, v90
    v_max_f32 v91, 0, v91
    v_pk_mul_f32 v[88:89], v[88:89], v[92:93]
    v_pk_mul_f32 v[90:91], v[90:91], v[94:95]
    v_pk_mul_f32 v[88:89], v[88:89], v[10:11] op_sel:[0,1] op_sel_hi:[1,1]
    v_pk_mul_f32 v[90:91], v[90:91], v[10:11] op_sel:[0,1] op_sel_hi:[1,1]
    v_cvt_pk_bf16_f32 v152, v88, v89
    v_cvt_pk_bf16_f32 v153, v90, v91
    v_mfma_f32_16x16x16_bf16 v[64:67], v[232:233], v[250:251], v[64:67]
    v_mfma_f32_16x16x16_bf16 v[120:123], v[232:233], v[254:255], v[120:123]
    v_mfma_f32_16x16x16_bf16 v[68:71], v[234:235], v[250:251], v[68:71]
    v_mfma_f32_16x16x16_bf16 v[124:127], v[234:235], v[254:255], v[124:127]
    v_max_f32 v96, 0, v96
    v_max_f32 v97, 0, v97
    v_max_f32 v98, 0, v98
    v_max_f32 v99, 0, v99
    v_pk_mul_f32 v[96:97], v[96:97], v[100:101]
    v_pk_mul_f32 v[98:99], v[98:99], v[102:103]
    v_pk_mul_f32 v[96:97], v[96:97], v[10:11] op_sel:[0,1] op_sel_hi:[1,1]
    v_pk_mul_f32 v[98:99], v[98:99], v[10:11] op_sel:[0,1] op_sel_hi:[1,1]
    v_cvt_pk_bf16_f32 v154, v96, v97
    v_cvt_pk_bf16_f32 v155, v98, v99
    v_mfma_f32_16x16x16_bf16 v[72:75], v[236:237], v[250:251], v[72:75]
    v_mfma_f32_16x16x16_bf16 v[128:131], v[236:237], v[254:255], v[128:131]
    v_mfma_f32_16x16x16_bf16 v[76:79], v[238:239], v[250:251], v[76:79]
    v_mfma_f32_16x16x16_bf16 v[132:135], v[238:239], v[254:255], v[132:135]
    buffer_store_dwordx4 v[152:155], v3, s[8:11], s31 offen offset:0
    v_max_f32 v80, 0, v80
    v_max_f32 v81, 0, v81
    v_max_f32 v82, 0, v82
    v_max_f32 v83, 0, v83
    v_pk_mul_f32 v[80:81], v[80:81], v[84:85]
    v_pk_mul_f32 v[82:83], v[82:83], v[86:87]
    v_pk_mul_f32 v[80:81], v[80:81], v[10:11] op_sel:[0,0] op_sel_hi:[1,0]
    v_pk_mul_f32 v[82:83], v[82:83], v[10:11] op_sel:[0,0] op_sel_hi:[1,0]
    v_cvt_pk_bf16_f32 v144, v80, v81
    v_cvt_pk_bf16_f32 v145, v82, v83
    v_max_f32 v136, 0, v136
    v_max_f32 v137, 0, v137
    v_max_f32 v138, 0, v138
    v_max_f32 v139, 0, v139
    v_pk_mul_f32 v[136:137], v[136:137], v[140:141]
    v_pk_mul_f32 v[138:139], v[138:139], v[142:143]
    v_pk_mul_f32 v[136:137], v[136:137], v[10:11] op_sel:[0,1] op_sel_hi:[1,1]
    v_pk_mul_f32 v[138:139], v[138:139], v[10:11] op_sel:[0,1] op_sel_hi:[1,1]
    v_cvt_pk_bf16_f32 v146, v136, v137
    v_cvt_pk_bf16_f32 v147, v138, v139
    s_nop 1
    v_permlane16_swap_b32 v144, v146
    v_permlane16_swap_b32 v145, v147
    buffer_store_dwordx4 v[144:147], v9, s[8:11], s29 offen
    s_cmp_eq_u32 s14, 15
    s_cbranch_scc1 L_c_gu_skip
    v_max_f32 v48, 0, v48
    v_max_f32 v49, 0, v49
    v_max_f32 v50, 0, v50
    v_max_f32 v51, 0, v51
    v_pk_mul_f32 v[48:49], v[48:49], v[52:53]
    v_pk_mul_f32 v[50:51], v[50:51], v[54:55]
    v_pk_mul_f32 v[48:49], v[48:49], v[10:11] op_sel:[0,0] op_sel_hi:[1,0]
    v_pk_mul_f32 v[50:51], v[50:51], v[10:11] op_sel:[0,0] op_sel_hi:[1,0]
    v_cvt_pk_bf16_f32 v156, v48, v49
    v_cvt_pk_bf16_f32 v157, v50, v51
    v_max_f32 v56, 0, v56
    v_max_f32 v57, 0, v57
    v_max_f32 v58, 0, v58
    v_max_f32 v59, 0, v59
    v_pk_mul_f32 v[56:57], v[56:57], v[60:61]
    v_pk_mul_f32 v[58:59], v[58:59], v[62:63]
    v_pk_mul_f32 v[56:57], v[56:57], v[10:11] op_sel:[0,0] op_sel_hi:[1,0]
    v_pk_mul_f32 v[58:59], v[58:59], v[10:11] op_sel:[0,0] op_sel_hi:[1,0]
    v_cvt_pk_bf16_f32 v158, v56, v57
    v_cvt_pk_bf16_f32 v159, v58, v59
    buffer_store_dwordx4 v[156:159], v3, s[8:11], s30 offen offset:1024
    v_max_f32 v104, 0, v104
    v_max_f32 v105, 0, v105
    v_max_f32 v106, 0, v106
    v_max_f32 v107, 0, v107
    v_pk_mul_f32 v[104:105], v[104:105], v[108:109]
    v_pk_mul_f32 v[106:107], v[106:107], v[110:111]
    v_pk_mul_f32 v[104:105], v[104:105], v[10:11] op_sel:[0,1] op_sel_hi:[1,1]
    v_pk_mul_f32 v[106:107], v[106:107], v[10:11] op_sel:[0,1] op_sel_hi:[1,1]
    v_cvt_pk_bf16_f32 v160, v104, v105
    v_cvt_pk_bf16_f32 v161, v106, v107
    v_max_f32 v112, 0, v112
    v_max_f32 v113, 0, v113
    v_max_f32 v114, 0, v114
    v_max_f32 v115, 0, v115
    v_pk_mul_f32 v[112:113], v[112:113], v[116:117]
    v_pk_mul_f32 v[114:115], v[114:115], v[118:119]
    v_pk_mul_f32 v[112:113], v[112:113], v[10:11] op_sel:[0,1] op_sel_hi:[1,1]
    v_pk_mul_f32 v[114:115], v[114:115], v[10:11] op_sel:[0,1] op_sel_hi:[1,1]
    v_cvt_pk_bf16_f32 v162, v112, v113
    v_cvt_pk_bf16_f32 v163, v114, v115
    buffer_store_dwordx4 v[160:163], v3, s[8:11], s31 offen offset:1024
    v_max_f32 v64, 0, v64
    v_max_f32 v65, 0, v65
    v_max_f32 v66, 0, v66
    v_max_f32 v67, 0, v67
    v_pk_mul_f32 v[64:65], v[64:65], v[68:69]
    v_pk_mul_f32 v[66:67], v[66:67], v[70:71]
    v_pk_mul_f32 v[64:65], v[64:65], v[10:11] op_sel:[0,0] op_sel_hi:[1,0]
    v_pk_mul_f32 v[66:67], v[66:67], v[10:11] op_sel:[0,0] op_sel_hi:[1,0]
    v_cvt_pk_bf16_f32 v164, v64, v65
    v_cvt_pk_bf16_f32 v165, v66, v67
    v_max_f32 v72, 0, v72
    v_max_f32 v73, 0, v73
    v_max_f32 v74, 0, v74
    v_max_f32 v75, 0, v75
    v_pk_mul_f32 v[72:73], v[72:73], v[76:77]
    v_pk_mul_f32 v[74:75], v[74:75], v[78:79]
    v_pk_mul_f32 v[72:73], v[72:73], v[10:11] op_sel:[0,0] op_sel_hi:[1,0]
    v_pk_mul_f32 v[74:75], v[74:75], v[10:11] op_sel:[0,0] op_sel_hi:[1,0]
    v_cvt_pk_bf16_f32 v166, v72, v73
    v_cvt_pk_bf16_f32 v167, v74, v75
    buffer_store_dwordx4 v[164:167], v3, s[8:11], s30 offen offset:2048
    v_max_f32 v120, 0, v120
    v_max_f32 v121, 0, v121
    v_max_f32 v122, 0, v122
    v_max_f32 v123, 0, v123
    v_pk_mul_f32 v[120:121], v[120:121], v[124:125]
    v_pk_mul_f32 v[122:123], v[122:123], v[126:127]
    v_pk_mul_f32 v[120:121], v[120:121], v[10:11] op_sel:[0,1] op_sel_hi:[1,1]
    v_pk_mul_f32 v[122:123], v[122:123], v[10:11] op_sel:[0,1] op_sel_hi:[1,1]
    v_cvt_pk_bf16_f32 v168, v120, v121
    v_cvt_pk_bf16_f32 v169, v122, v123
    v_max_f32 v128, 0, v128
    v_max_f32 v129, 0, v129
    v_max_f32 v130, 0, v130
    v_max_f32 v131, 0, v131
    v_pk_mul_f32 v[128:129], v[128:129], v[132:133]
    v_pk_mul_f32 v[130:131], v[130:131], v[134:135]
    v_pk_mul_f32 v[128:129], v[128:129], v[10:11] op_sel:[0,1] op_sel_hi:[1,1]
    v_pk_mul_f32 v[130:131], v[130:131], v[10:11] op_sel:[0,1] op_sel_hi:[1,1]
    v_cvt_pk_bf16_f32 v170, v128, v129
    v_cvt_pk_bf16_f32 v171, v130, v131
    buffer_store_dwordx4 v[168:171], v3, s[8:11], s31 offen offset:2048
L_c_gu_skip:
    v_lshlrev_b32 v32, 16, v16
    v_and_b32 v33, 0xffff0000, v16
    v_lshlrev_b32 v34, 16, v17
    v_and_b32 v35, 0xffff0000, v17
    v_lshlrev_b32 v36, 16, v18
    v_and_b32 v37, 0xffff0000, v18
    v_lshlrev_b32 v38, 16, v19
    v_and_b32 v39, 0xffff0000, v19
    v_lshlrev_b32 v40, 16, v20
    v_and_b32 v41, 0xffff0000, v20
    v_lshlrev_b32 v42, 16, v21
    v_and_b32 v43, 0xffff0000, v21
    v_lshlrev_b32 v44, 16, v22
    v_and_b32 v45, 0xffff0000, v22
    v_lshlrev_b32 v46, 16, v23
    v_and_b32 v47, 0xffff0000, v23
    v_lshlrev_b32 v48, 16, v24
    v_and_b32 v49, 0xffff0000, v24
    v_lshlrev_b32 v50, 16, v25
    v_and_b32 v51, 0xffff0000, v25
    s_lshr_b32 s28, s19, 10
    s_add_u32 s28, s28, 0xc14180
    s_mov_b32 s29, s13
    s_lshl_b32 s29, s29, 9
    s_add_u32 s53, s28, s29
    s_mov_b32 s29, s14
    s_lshl_b32 s29, s29, 2
    s_add_u32 s53, s53, s29
    s_lshr_b32 s29, s15, 1
    s_lshl_b32 s29, s29, 9
    s_add_u32 s94, s28, s29
    v_lshlrev_b32 v13, 2, v1
    s_waitcnt vmcnt(0)
    s_barrier
    s_cmp_lg_u32 s12, 0
    s_cbranch_scc1 L_mega_20
    s_mov_b64 exec, 1
    s_cmp_lg_u32 s3, 0
    s_cbranch_scc1 L_mega_21
    buffer_wbl2 sc1
    s_waitcnt vmcnt(0)
    buffer_store_dword v15, off, s[8:11], s53 sc0 sc1
    s_mov_b64 exec, -1
    s_branch L_mega_20
L_mega_21:
    buffer_store_dword v15, off, s[8:11], s53
    s_mov_b64 exec, -1
L_mega_20:
    s_cmp_lg_u32 s12, 1
    s_cbranch_scc1 L_mega_19
    s_mov_b32 s95, 0x40000
    s_mov_b64 exec, 0xffff
L_mega_22:
    buffer_load_dword v14, v13, s[8:11], s94 offen sc1
    s_waitcnt vmcnt(0)
    v_cmp_ne_u32 vcc, 1, v14
    s_sub_u32 s95, s95, 1
    s_cbranch_vccz L_mega_22_x
    s_cbranch_scc0 L_mega_22
L_mega_22_x:
    s_mov_b64 exec, -1
L_mega_19:
    s_barrier
    s_mul_i32 s28, s12, 1024
    v_add_u32 v27, 0x16000, v3
    v_add_u32 v4, s28, v27
    v_add_u32 v28, 0xc000, v3
    v_add_u32 v5, s28, v28
    v_add_u32 v29, 0x1f000, v3
    v_add_u32 v6, s28, v29
    v_add_u32 v31, 0x0, v3
    v_add_u32 v30, s28, v31
    s_mov_b32 s36, 4
    s_barrier
    ds_read_b128 v[60:63], v4 offset:18432
    ds_read_b128 v[108:111], v27 offset:22528
    ds_read_b128 v[112:115], v27 offset:23552
    ds_read_b128 v[116:119], v27 offset:24576
    ds_read_b128 v[120:123], v27 offset:25600
    ds_read_b128 v[124:127], v27 offset:26624
    ds_read_b128 v[64:67], v4 offset:27648
    ds_read_b128 v[128:131], v27 offset:31744
    ds_read_b128 v[132:135], v27 offset:32768
    ds_read_b128 v[136:139], v27 offset:33792
    ds_read_b128 v[140:143], v27 offset:34816
    ds_read_b128 v[144:147], v27 offset:35840
    s_cmp_lg_u32 s19, 0
    s_cbranch_scc1 L_mega_23
    s_mul_i32 s28, s14, 172032
    s_add_u32 s28, s28, 0x6000
    s_cmp_eq_u32 s14, 10
    s_cselect_b32 s30, 0, 21504
    v_lshlrev_b32 v9, 3, v1
    s_add_u32 s29, s28, 0
    buffer_load_dwordx2 v[216:217], v9, s[8:11], s29 offen
    s_add_u32 s29, s28, 21504
    buffer_load_dwordx2 v[218:219], v9, s[8:11], s29 offen
    s_add_u32 s29, s28, 43008
    buffer_load_dwordx2 v[220:221], v9, s[8:11], s29 offen
    s_add_u32 s29, s28, 64512
    buffer_load_dwordx2 v[222:223], v9, s[8:11], s29 offen
    s_mul_i32 s29, s30, 4
    s_add_u32 s29, s29, s28
    buffer_load_dwordx2 v[224:225], v9, s[8:11], s29 offen
    s_mul_i32 s29, s30, 5
    s_add_u32 s29, s29, s28
    buffer_load_dwordx2 v[226:227], v9, s[8:11], s29 offen
    s_add_u32 s29, s28, 129024
    buffer_load_dwordx2 v[228:229], v9, s[8:11], s29 offen
    s_mul_i32 s29, s30, 7
    s_add_u32 s29, s29, s28
    buffer_load_dwordx2 v[230:231], v9, s[8:11], s29 offen
    s_lshl_b32 s28, s15, 2
    s_add_u32 s28, s28, s12
    s_mul_i32 s29, s28, 20480
    s_lshl_b32 s30, s16, 11
    s_add_u32 s30, s30, s29
    s_lshl_b32 s31, s16, 9
    s_add_u32 s31, s31, s29
    s_add_u32 s31, s31, 16384
    v_lshrrev_b32 v9, 1, v8
    v_lshlrev_b32 v9, 8, v9
    v_lshl_add_u32 v9, v7, 4, v9
    v_mov_b32 v14, v9
    s_mov_b32 s29, 0x1000000
    s_add_u32 s30, s30, s29
    s_add_u32 s31, s31, s29
    v_lshlrev_b32 v26, 3, v7
    s_lshl_b32 s29, s16, 14
    s_lshl_b32 s28, s28, 7
    s_add_u32 s29, s29, s28
    s_add_u32 s29, s29, 0x1280000
L_mega_23:
    s_branch L_mega_24_mid
    .p2align 4
L_mega_24:
    s_waitcnt lgkmcnt(0)
    v_mfma_f32_16x16x32_bf16 v[32:35], v[68:71], v[52:55], v[32:35]
    ds_read_b128 v[60:63], v5 offset:18432
    ds_read_b128 v[108:111], v28 offset:22528
    v_mfma_f32_16x16x32_bf16 v[36:39], v[72:75], v[52:55], v[36:39]
    ds_read_b128 v[112:115], v28 offset:23552
    ds_read_b128 v[116:119], v28 offset:24576
    v_mfma_f32_16x16x32_bf16 v[40:43], v[76:79], v[52:55], v[40:43]
    ds_read_b128 v[120:123], v28 offset:25600
    ds_read_b128 v[124:127], v28 offset:26624
    v_mfma_f32_16x16x32_bf16 v[44:47], v[80:83], v[52:55], v[44:47]
    ds_read_b128 v[64:67], v5 offset:27648
    ds_read_b128 v[128:131], v28 offset:31744
    v_mfma_f32_16x16x32_bf16 v[48:51], v[84:87], v[52:55], v[48:51]
    ds_read_b128 v[132:135], v28 offset:32768
    ds_read_b128 v[136:139], v28 offset:33792
    v_mfma_f32_16x16x32_bf16 v[32:35], v[88:91], v[56:59], v[32:35]
    ds_read_b128 v[140:143], v28 offset:34816
    ds_read_b128 v[144:147], v28 offset:35840
    v_mfma_f32_16x16x32_bf16 v[36:39], v[92:95], v[56:59], v[36:39]
    v_mfma_f32_16x16x32_bf16 v[40:43], v[96:99], v[56:59], v[40:43]
    v_mfma_f32_16x16x32_bf16 v[44:47], v[100:103], v[56:59], v[44:47]
    v_mfma_f32_16x16x32_bf16 v[48:51], v[104:107], v[56:59], v[48:51]
    s_waitcnt lgkmcnt(0)
    s_barrier
    v_mfma_f32_16x16x32_bf16 v[32:35], v[108:111], v[60:63], v[32:35]
    ds_read_b128 v[52:55], v6 offset:0
    ds_read_b128 v[68:71], v29 offset:4096
    v_mfma_f32_16x16x32_bf16 v[36:39], v[112:115], v[60:63], v[36:39]
    ds_read_b128 v[72:75], v29 offset:5120
    ds_read_b128 v[76:79], v29 offset:6144
    v_mfma_f32_16x16x32_bf16 v[40:43], v[116:119], v[60:63], v[40:43]
    ds_read_b128 v[80:83], v29 offset:7168
    ds_read_b128 v[84:87], v29 offset:8192
    v_mfma_f32_16x16x32_bf16 v[44:47], v[120:123], v[60:63], v[44:47]
    ds_read_b128 v[56:59], v6 offset:9216
    ds_read_b128 v[88:91], v29 offset:13312
    v_mfma_f32_16x16x32_bf16 v[48:51], v[124:127], v[60:63], v[48:51]
    ds_read_b128 v[92:95], v29 offset:14336
    ds_read_b128 v[96:99], v29 offset:15360
    v_mfma_f32_16x16x32_bf16 v[32:35], v[128:131], v[64:67], v[32:35]
    ds_read_b128 v[100:103], v29 offset:16384
    ds_read_b128 v[104:107], v29 offset:17408
    v_mfma_f32_16x16x32_bf16 v[36:39], v[132:135], v[64:67], v[36:39]
    v_mfma_f32_16x16x32_bf16 v[40:43], v[136:139], v[64:67], v[40:43]
    v_mfma_f32_16x16x32_bf16 v[44:47], v[140:143], v[64:67], v[44:47]
    v_mfma_f32_16x16x32_bf16 v[48:51], v[144:147], v[64:67], v[48:51]
    s_waitcnt lgkmcnt(0)
    v_mfma_f32_16x16x32_bf16 v[32:35], v[68:71], v[52:55], v[32:35]
    ds_read_b128 v[60:63], v6 offset:18432
    ds_read_b128 v[108:111], v29 offset:22528
    v_mfma_f32_16x16x32_bf16 v[36:39], v[72:75], v[52:55], v[36:39]
    ds_read_b128 v[112:115], v29 offset:23552
    ds_read_b128 v[116:119], v29 offset:24576
    v_mfma_f32_16x16x32_bf16 v[40:43], v[76:79], v[52:55], v[40:43]
    ds_read_b128 v[120:123], v29 offset:25600
    ds_read_b128 v[124:127], v29 offset:26624
    v_mfma_f32_16x16x32_bf16 v[44:47], v[80:83], v[52:55], v[44:47]
    ds_read_b128 v[64:67], v6 offset:27648
    ds_read_b128 v[128:131], v29 offset:31744
    v_mfma_f32_16x16x32_bf16 v[48:51], v[84:87], v[52:55], v[48:51]
    ds_read_b128 v[132:135], v29 offset:32768
    ds_read_b128 v[136:139], v29 offset:33792
    v_mfma_f32_16x16x32_bf16 v[32:35], v[88:91], v[56:59], v[32:35]
    ds_read_b128 v[140:143], v29 offset:34816
    ds_read_b128 v[144:147], v29 offset:35840
    v_mfma_f32_16x16x32_bf16 v[36:39], v[92:95], v[56:59], v[36:39]
    v_mfma_f32_16x16x32_bf16 v[40:43], v[96:99], v[56:59], v[40:43]
    v_mfma_f32_16x16x32_bf16 v[44:47], v[100:103], v[56:59], v[44:47]
    v_mfma_f32_16x16x32_bf16 v[48:51], v[104:107], v[56:59], v[48:51]
    s_waitcnt lgkmcnt(0)
    s_barrier
    v_mfma_f32_16x16x32_bf16 v[32:35], v[108:111], v[60:63], v[32:35]
    ds_read_b128 v[52:55], v30 offset:0
    ds_read_b128 v[68:71], v31 offset:4096
    v_mfma_f32_16x16x32_bf16 v[36:39], v[112:115], v[60:63], v[36:39]
    ds_read_b128 v[72:75], v31 offset:5120
    ds_read_b128 v[76:79], v31 offset:6144
    v_mfma_f32_16x16x32_bf16 v[40:43], v[116:119], v[60:63], v[40:43]
    ds_read_b128 v[80:83], v31 offset:7168
    ds_read_b128 v[84:87], v31 offset:8192
    v_mfma_f32_16x16x32_bf16 v[44:47], v[120:123], v[60:63], v[44:47]
    ds_read_b128 v[56:59], v30 offset:9216
    ds_read_b128 v[88:91], v31 offset:13312
    v_mfma_f32_16x16x32_bf16 v[48:51], v[124:127], v[60:63], v[48:51]
    ds_read_b128 v[92:95], v31 offset:14336
    ds_read_b128 v[96:99], v31 offset:15360
    v_mfma_f32_16x16x32_bf16 v[32:35], v[128:131], v[64:67], v[32:35]
    ds_read_b128 v[100:103], v31 offset:16384
    ds_read_b128 v[104:107], v31 offset:17408
    v_mfma_f32_16x16x32_bf16 v[36:39], v[132:135], v[64:67], v[36:39]
    v_mfma_f32_16x16x32_bf16 v[40:43], v[136:139], v[64:67], v[40:43]
    v_mfma_f32_16x16x32_bf16 v[44:47], v[140:143], v[64:67], v[44:47]
    v_mfma_f32_16x16x32_bf16 v[48:51], v[144:147], v[64:67], v[48:51]
    s_waitcnt lgkmcnt(0)
    v_mfma_f32_16x16x32_bf16 v[32:35], v[68:71], v[52:55], v[32:35]
    ds_read_b128 v[60:63], v30 offset:18432
    ds_read_b128 v[108:111], v31 offset:22528
    v_mfma_f32_16x16x32_bf16 v[36:39], v[72:75], v[52:55], v[36:39]
    ds_read_b128 v[112:115], v31 offset:23552
    ds_read_b128 v[116:119], v31 offset:24576
    v_mfma_f32_16x16x32_bf16 v[40:43], v[76:79], v[52:55], v[40:43]
    ds_read_b128 v[120:123], v31 offset:25600
    ds_read_b128 v[124:127], v31 offset:26624
    v_mfma_f32_16x16x32_bf16 v[44:47], v[80:83], v[52:55], v[44:47]
    ds_read_b128 v[64:67], v30 offset:27648
    ds_read_b128 v[128:131], v31 offset:31744
    v_mfma_f32_16x16x32_bf16 v[48:51], v[84:87], v[52:55], v[48:51]
    ds_read_b128 v[132:135], v31 offset:32768
    ds_read_b128 v[136:139], v31 offset:33792
    v_mfma_f32_16x16x32_bf16 v[32:35], v[88:91], v[56:59], v[32:35]
    ds_read_b128 v[140:143], v31 offset:34816
    ds_read_b128 v[144:147], v31 offset:35840
    v_mfma_f32_16x16x32_bf16 v[36:39], v[92:95], v[56:59], v[36:39]
    v_mfma_f32_16x16x32_bf16 v[40:43], v[96:99], v[56:59], v[40:43]
    v_mfma_f32_16x16x32_bf16 v[44:47], v[100:103], v[56:59], v[44:47]
    v_mfma_f32_16x16x32_bf16 v[48:51], v[104:107], v[56:59], v[48:51]
    s_waitcnt lgkmcnt(0)
    s_barrier
    v_mfma_f32_16x16x32_bf16 v[32:35], v[108:111], v[60:63], v[32:35]
    ds_read_b128 v[52:55], v4 offset:0
    ds_read_b128 v[68:71], v27 offset:4096
    v_mfma_f32_16x16x32_bf16 v[36:39], v[112:115], v[60:63], v[36:39]
    ds_read_b128 v[72:75], v27 offset:5120
    ds_read_b128 v[76:79], v27 offset:6144
    v_mfma_f32_16x16x32_bf16 v[40:43], v[116:119], v[60:63], v[40:43]
    ds_read_b128 v[80:83], v27 offset:7168
    ds_read_b128 v[84:87], v27 offset:8192
    v_mfma_f32_16x16x32_bf16 v[44:47], v[120:123], v[60:63], v[44:47]
    ds_read_b128 v[56:59], v4 offset:9216
    ds_read_b128 v[88:91], v27 offset:13312
    v_mfma_f32_16x16x32_bf16 v[48:51], v[124:127], v[60:63], v[48:51]
    ds_read_b128 v[92:95], v27 offset:14336
    ds_read_b128 v[96:99], v27 offset:15360
    v_mfma_f32_16x16x32_bf16 v[32:35], v[128:131], v[64:67], v[32:35]
    ds_read_b128 v[100:103], v27 offset:16384
    ds_read_b128 v[104:107], v27 offset:17408
    v_mfma_f32_16x16x32_bf16 v[36:39], v[132:135], v[64:67], v[36:39]
    v_mfma_f32_16x16x32_bf16 v[40:43], v[136:139], v[64:67], v[40:43]
    v_mfma_f32_16x16x32_bf16 v[44:47], v[140:143], v[64:67], v[44:47]
    v_mfma_f32_16x16x32_bf16 v[48:51], v[144:147], v[64:67], v[48:51]
    s_waitcnt lgkmcnt(0)
    v_mfma_f32_16x16x32_bf16 v[32:35], v[68:71], v[52:55], v[32:35]
    ds_read_b128 v[60:63], v4 offset:18432
    ds_read_b128 v[108:111], v27 offset:22528
    v_mfma_f32_16x16x32_bf16 v[36:39], v[72:75], v[52:55], v[36:39]
    ds_read_b128 v[112:115], v27 offset:23552
    ds_read_b128 v[116:119], v27 offset:24576
    v_mfma_f32_16x16x32_bf16 v[40:43], v[76:79], v[52:55], v[40:43]
    ds_read_b128 v[120:123], v27 offset:25600
    ds_read_b128 v[124:127], v27 offset:26624
    v_mfma_f32_16x16x32_bf16 v[44:47], v[80:83], v[52:55], v[44:47]
    ds_read_b128 v[64:67], v4 offset:27648
    ds_read_b128 v[128:131], v27 offset:31744
    v_mfma_f32_16x16x32_bf16 v[48:51], v[84:87], v[52:55], v[48:51]
    ds_read_b128 v[132:135], v27 offset:32768
    ds_read_b128 v[136:139], v27 offset:33792
    v_mfma_f32_16x16x32_bf16 v[32:35], v[88:91], v[56:59], v[32:35]
    ds_read_b128 v[140:143], v27 offset:34816
    ds_read_b128 v[144:147], v27 offset:35840
    v_mfma_f32_16x16x32_bf16 v[36:39], v[92:95], v[56:59], v[36:39]
    v_mfma_f32_16x16x32_bf16 v[40:43], v[96:99], v[56:59], v[40:43]
    v_mfma_f32_16x16x32_bf16 v[44:47], v[100:103], v[56:59], v[44:47]
    v_mfma_f32_16x16x32_bf16 v[48:51], v[104:107], v[56:59], v[48:51]
L_mega_24_mid:
    s_waitcnt lgkmcnt(0)
    s_barrier
    v_mfma_f32_16x16x32_bf16 v[32:35], v[108:111], v[60:63], v[32:35]
    ds_read_b128 v[52:55], v5 offset:0
    ds_read_b128 v[68:71], v28 offset:4096
    v_mfma_f32_16x16x32_bf16 v[36:39], v[112:115], v[60:63], v[36:39]
    ds_read_b128 v[72:75], v28 offset:5120
    ds_read_b128 v[76:79], v28 offset:6144
    v_mfma_f32_16x16x32_bf16 v[40:43], v[116:119], v[60:63], v[40:43]
    ds_read_b128 v[80:83], v28 offset:7168
    ds_read_b128 v[84:87], v28 offset:8192
    v_mfma_f32_16x16x32_bf16 v[44:47], v[120:123], v[60:63], v[44:47]
    ds_read_b128 v[56:59], v5 offset:9216
    ds_read_b128 v[88:91], v28 offset:13312
    v_mfma_f32_16x16x32_bf16 v[48:51], v[124:127], v[60:63], v[48:51]
    ds_read_b128 v[92:95], v28 offset:14336
    ds_read_b128 v[96:99], v28 offset:15360
    v_mfma_f32_16x16x32_bf16 v[32:35], v[128:131], v[64:67], v[32:35]
    ds_read_b128 v[100:103], v28 offset:16384
    ds_read_b128 v[104:107], v28 offset:17408
    v_mfma_f32_16x16x32_bf16 v[36:39], v[132:135], v[64:67], v[36:39]
    s_sub_u32 s36, s36, 1
    v_mfma_f32_16x16x32_bf16 v[40:43], v[136:139], v[64:67], v[40:43]
    s_cmp_lg_u32 s36, 0
    v_mfma_f32_16x16x32_bf16 v[44:47], v[140:143], v[64:67], v[44:47]
    v_mfma_f32_16x16x32_bf16 v[48:51], v[144:147], v[64:67], v[48:51]
    s_cbranch_scc1 L_mega_24
    s_waitcnt lgkmcnt(0)
    v_mfma_f32_16x16x32_bf16 v[32:35], v[68:71], v[52:55], v[32:35]
    ds_read_b128 v[60:63], v5 offset:18432
    ds_read_b128 v[108:111], v28 offset:22528
    v_mfma_f32_16x16x32_bf16 v[36:39], v[72:75], v[52:55], v[36:39]
    ds_read_b128 v[112:115], v28 offset:23552
    ds_read_b128 v[116:119], v28 offset:24576
    v_mfma_f32_16x16x32_bf16 v[40:43], v[76:79], v[52:55], v[40:43]
    ds_read_b128 v[120:123], v28 offset:25600
    ds_read_b128 v[124:127], v28 offset:26624
    v_mfma_f32_16x16x32_bf16 v[44:47], v[80:83], v[52:55], v[44:47]
    ds_read_b128 v[64:67], v5 offset:27648
    ds_read_b128 v[128:131], v28 offset:31744
    v_mfma_f32_16x16x32_bf16 v[48:51], v[84:87], v[52:55], v[48:51]
    ds_read_b128 v[132:135], v28 offset:32768
    ds_read_b128 v[136:139], v28 offset:33792
    v_mfma_f32_16x16x32_bf16 v[32:35], v[88:91], v[56:59], v[32:35]
    ds_read_b128 v[140:143], v28 offset:34816
    ds_read_b128 v[144:147], v28 offset:35840
    v_mfma_f32_16x16x32_bf16 v[36:39], v[92:95], v[56:59], v[36:39]
    v_mfma_f32_16x16x32_bf16 v[40:43], v[96:99], v[56:59], v[40:43]
    v_mfma_f32_16x16x32_bf16 v[44:47], v[100:103], v[56:59], v[44:47]
    v_mfma_f32_16x16x32_bf16 v[48:51], v[104:107], v[56:59], v[48:51]
    s_waitcnt lgkmcnt(0)
    v_mfma_f32_16x16x32_bf16 v[32:35], v[108:111], v[60:63], v[32:35]
    v_mfma_f32_16x16x32_bf16 v[36:39], v[112:115], v[60:63], v[36:39]
    v_mfma_f32_16x16x32_bf16 v[40:43], v[116:119], v[60:63], v[40:43]
    v_mfma_f32_16x16x32_bf16 v[44:47], v[120:123], v[60:63], v[44:47]
    v_mfma_f32_16x16x32_bf16 v[48:51], v[124:127], v[60:63], v[48:51]
    v_mfma_f32_16x16x32_bf16 v[32:35], v[128:131], v[64:67], v[32:35]
    v_mfma_f32_16x16x32_bf16 v[36:39], v[132:135], v[64:67], v[36:39]
    v_mfma_f32_16x16x32_bf16 v[40:43], v[136:139], v[64:67], v[40:43]
    v_mfma_f32_16x16x32_bf16 v[44:47], v[140:143], v[64:67], v[44:47]
    v_mfma_f32_16x16x32_bf16 v[48:51], v[144:147], v[64:67], v[48:51]
    s_nop 2
    s_cmp_lg_u32 s19, 0
    s_cbranch_scc1 L_c_final
    s_nop 2
    v_cvt_pk_bf16_f32 v16, v32, v33
    v_cvt_pk_bf16_f32 v17, v34, v35
    v_cvt_pk_bf16_f32 v18, v36, v37
    v_cvt_pk_bf16_f32 v19, v38, v39
    buffer_store_dwordx4 v[16:19], v3, s[8:11], s30 offen
    v_cvt_pk_bf16_f32 v24, v48, v49
    v_cvt_pk_bf16_f32 v56, v48, v49
    v_cvt_pk_bf16_f32 v58, v48, v49
    v_cvt_pk_bf16_f32 v25, v50, v51
    v_cvt_pk_bf16_f32 v57, v50, v51
    v_cvt_pk_bf16_f32 v59, v50, v51
    v_cvt_pk_bf16_f32 v20, v40, v41
    v_cvt_pk_bf16_f32 v21, v42, v43
    v_cvt_pk_bf16_f32 v22, v44, v45
    v_cvt_pk_bf16_f32 v23, v46, v47
    buffer_store_dwordx4 v[20:23], v3, s[8:11], s30 offen offset:1024
    v_permlane16_swap_b32 v56, v58
    v_permlane16_swap_b32 v57, v59
    s_mov_b32 exec_lo, 0xffff
    s_mov_b32 exec_hi, 0xffff
    buffer_store_dwordx4 v[56:59], v14, s[8:11], s31 offen
    s_mov_b64 exec, -1
    v_pk_add_f32 v[10:11], v[32:33], v[34:35]
    v_pk_mul_f32 v[12:13], v[32:33], v[32:33]
    v_pk_fma_f32 v[12:13], v[34:35], v[34:35], v[12:13]
    v_pk_add_f32 v[10:11], v[10:11], v[36:37]
    v_pk_fma_f32 v[12:13], v[36:37], v[36:37], v[12:13]
    v_pk_add_f32 v[10:11], v[10:11], v[38:39]
    v_pk_fma_f32 v[12:13], v[38:39], v[38:39], v[12:13]
    v_pk_add_f32 v[10:11], v[10:11], v[40:41]
    v_pk_fma_f32 v[12:13], v[40:41], v[40:41], v[12:13]
    v_pk_add_f32 v[10:11], v[10:11], v[42:43]
    v_pk_fma_f32 v[12:13], v[42:43], v[42:43], v[12:13]
    v_pk_add_f32 v[10:11], v[10:11], v[44:45]
    v_pk_fma_f32 v[12:13], v[44:45], v[44:45], v[12:13]
    v_pk_add_f32 v[10:11], v[10:11], v[46:47]
    v_pk_fma_f32 v[12:13], v[46:47], v[46:47], v[12:13]
    v_pk_add_f32 v[10:11], v[10:11], v[48:49]
    v_pk_fma_f32 v[12:13], v[48:49], v[48:49], v[12:13]
    v_pk_add_f32 v[10:11], v[10:11], v[50:51]
    v_pk_fma_f32 v[12:13], v[50:51], v[50:51], v[12:13]
    v_add_f32 v10, v10, v11
    v_add_f32 v11, v12, v13
    v_mov_b32 v12, v10
    v_mov_b32 v13, v11
    s_nop 1
    v_permlane32_swap_b32 v10, v12
    v_permlane32_swap_b32 v11, v13
    s_nop 0
    v_pk_add_f32 v[10:11], v[10:11], v[12:13]
    v_mov_b32 v12, v10
    v_mov_b32 v13, v11
    s_nop 1
    v_permlane16_swap_b32 v10, v12
    v_permlane16_swap_b32 v11, v13
    s_nop 0
    v_pk_add_f32 v[10:11], v[10:11], v[12:13]
    s_mov_b64 exec, 0xffff
    buffer_store_dwordx2 v[10:11], v26, s[8:11], s29 offen
    s_mov_b64 exec, -1
    s_nop 1
    s_waitcnt vmcnt(4)
    v_add_f32 v10, v216, v217
    v_cvt_pk_bf16_f32 v11, v10, v10
    v_and_b32 v11, 0xffff0000, v11
    v_sub_f32 v11, v10, v11
    v_cvt_pk_bf16_f32 v216, v10, v11
    v_cvt_pk_bf16_f32 v217, v10, v11
    v_add_f32 v10, v218, v219
    v_cvt_pk_bf16_f32 v11, v10, v10
    v_and_b32 v11, 0xffff0000, v11
    v_sub_f32 v11, v10, v11
    v_cvt_pk_bf16_f32 v218, v10, v11
    v_cvt_pk_bf16_f32 v219, v10, v11
    v_add_f32 v10, v220, v221
    v_cvt_pk_bf16_f32 v11, v10, v10
    v_and_b32 v11, 0xffff0000, v11
    v_sub_f32 v11, v10, v11
    v_cvt_pk_bf16_f32 v220, v10, v11
    v_cvt_pk_bf16_f32 v221, v10, v11
    v_add_f32 v10, v222, v223
    v_cvt_pk_bf16_f32 v11, v10, v10
    v_and_b32 v11, 0xffff0000, v11
    v_sub_f32 v11, v10, v11
    v_cvt_pk_bf16_f32 v222, v10, v11
    v_cvt_pk_bf16_f32 v223, v10, v11
    v_add_f32 v10, v224, v225
    v_cvt_pk_bf16_f32 v11, v10, v10
    v_and_b32 v11, 0xffff0000, v11
    v_sub_f32 v11, v10, v11
    v_cvt_pk_bf16_f32 v224, v10, v11
    v_cvt_pk_bf16_f32 v225, v10, v11
    v_add_f32 v10, v226, v227
    v_cvt_pk_bf16_f32 v11, v10, v10
    v_and_b32 v11, 0xffff0000, v11
    v_sub_f32 v11, v10, v11
    v_cvt_pk_bf16_f32 v226, v10, v11
    v_cvt_pk_bf16_f32 v227, v10, v11
    v_add_f32 v10, v228, v229
    v_cvt_pk_bf16_f32 v11, v10, v10
    v_and_b32 v11, 0xffff0000, v11
    v_sub_f32 v11, v10, v11
    v_cvt_pk_bf16_f32 v228, v10, v11
    v_cvt_pk_bf16_f32 v229, v10, v11
    v_add_f32 v10, v230, v231
    v_cvt_pk_bf16_f32 v11, v10, v10
    v_and_b32 v11, 0xffff0000, v11
    v_sub_f32 v11, v10, v11
    v_cvt_pk_bf16_f32 v230, v10, v11
    v_cvt_pk_bf16_f32 v231, v10, v11
    s_lshr_b32 s28, s19, 10
    s_add_u32 s28, s28, 0xc16180
    s_lshr_b32 s29, s15, 1
    s_lshl_b32 s29, s29, 9
    s_add_u32 s53, s28, s29
    s_and_b32 s29, s15, 1
    s_lshl_b32 s29, s29, 3
    s_add_u32 s29, s29, s16
    s_lshl_b32 s29, s29, 2
    s_add_u32 s53, s53, s29
    s_mov_b32 s29, s13
    s_lshl_b32 s29, s29, 9
    s_add_u32 s94, s28, s29
    v_lshlrev_b32 v13, 2, v1
    s_waitcnt vmcnt(0)
    s_barrier
    s_cmp_lg_u32 s12, 0
    s_cbranch_scc1 L_mega_26
    s_mov_b64 exec, 1
    s_cmp_lg_u32 s3, 0
    s_cbranch_scc1 L_mega_27
    buffer_wbl2 sc1
    s_waitcnt vmcnt(0)
    buffer_store_dword v15, off, s[8:11], s53 sc0 sc1
    s_mov_b64 exec, -1
    s_branch L_mega_26
L_mega_27:
    buffer_store_dword v15, off, s[8:11], s53
    s_mov_b64 exec, -1
L_mega_26:
    s_cmp_lg_u32 s12, 1
    s_cbranch_scc1 L_mega_25
    s_mov_b32 s95, 0x40000
    s_mov_b64 exec, 0xffff
L_mega_28:
    buffer_load_dword v14, v13, s[8:11], s94 offen sc1
    s_waitcnt vmcnt(0)
    v_cmp_ne_u32 vcc, 1, v14
    s_sub_u32 s95, s95, 1
    s_cbranch_vccz L_mega_28_x
    s_cbranch_scc0 L_mega_28
L_mega_28_x:
    s_mov_b64 exec, -1
L_mega_25:
    s_mov_b32 s19, 0x2000000
    s_mov_b32 s21, 20
    s_add_u32 s22, s22, 320
    s_branch L_c_layer
L_c_final:
    v_mul_u32_u24 v9, 1280, v7
    v_and_b32 v10, 1, v8
    v_lshl_add_u32 v9, v10, 5, v9
    v_lshrrev_b32 v10, 1, v8
    v_lshl_add_u32 v9, v10, 4, v9
    s_lshl_b32 s28, s15, 2
    s_add_u32 s28, s28, s12
    s_mul_i32 s28, s28, 20480
    s_mul_i32 s29, s16, 160
    s_add_u32 s28, s28, s29
    v_cvt_pk_bf16_f32 v56, v32, v33
    v_cvt_pk_bf16_f32 v57, v34, v35
    v_cvt_pk_bf16_f32 v58, v36, v37
    v_cvt_pk_bf16_f32 v59, v38, v39
    v_cvt_pk_bf16_f32 v60, v40, v41
    v_cvt_pk_bf16_f32 v61, v42, v43
    v_cvt_pk_bf16_f32 v62, v44, v45
    v_cvt_pk_bf16_f32 v63, v46, v47
    v_cvt_pk_bf16_f32 v64, v48, v49
    v_cvt_pk_bf16_f32 v65, v50, v51
    v_mov_b32 v66, v64
    v_mov_b32 v67, v65
    v_permlane16_swap_b32 v56, v58
    v_permlane16_swap_b32 v57, v59
    buffer_store_dwordx4 v[56:59], v9, s[24:27], s28 offen offset:0
    v_permlane16_swap_b32 v60, v62
    v_permlane16_swap_b32 v61, v63
    buffer_store_dwordx4 v[60:63], v9, s[24:27], s28 offen offset:64
    v_permlane16_swap_b32 v64, v66
    v_permlane16_swap_b32 v65, v67
    s_mov_b32 exec_lo, 0xffff
    s_mov_b32 exec_hi, 0xffff
    buffer_store_dwordx4 v[64:67], v9, s[24:27], s28 offen offset:128
L_mega_end:
    s_endpgm
L_attn_ck:
    s_cmp_eq_u32 s51, 0
    s_cselect_b32 s36, 3, 12
    s_add_u32 s51, s51, 1
    s_barrier
    s_branch L_attn_loop
L_l_attn:
    s_barrier
    s_cmp_lg_u32 s19, 0
    s_cbranch_scc1 L_l_havec
    v_mov_b32 v9, 0x27400
    ds_read_b32 v9, v9
    s_waitcnt lgkmcnt(0)
    v_readfirstlane_b32 s28, v9
    s_lshr_b32 s3, s28, 8
    s_bfe_u32 s30, s28, 0x30005
    s_lshl_b32 s15, s30, 2
    s_and_b32 s29, s28, 3
    s_add_u32 s15, s15, s29
    s_bfe_u32 s16, s28, 0x30002
    s_lshl_b32 s13, s30, 1
    s_and_b32 s29, s28, 1
    s_add_u32 s13, s13, s29
    s_bfe_u32 s14, s28, 0x40001
    s_mov_b32 s17, s15
    s_mov_b32 s18, s16
L_l_havec:
    s_mul_i32 s28, s17, 163840
    s_add_u32 s28, s28, s19
    s_lshl_b32 s29, s12, 10
    s_mov_b32 m0, s29
    s_add_u32 s31, s28, s29
    s_add_u32 s31, s31, 0x1b00000
    s_mov_b32 s28, 0x100
    s_mov_b32 s29, 0x10000
    v_mov_b32 v8, 0x3f803f80
    v_cndmask_b32 v8, 0, v8, s[28:29]
    v_mov_b32 v9, v8
    v_mov_b32 v10, v8
    v_mov_b32 v11, v8
    ds_write_b128 v3, v[8:11]
    s_waitcnt lgkmcnt(0)
    s_cmp_eq_u32 s12, 0
    s_mov_b32 s36, 5
    s_barrier
    s_cbranch_scc1 L_l_skip0
L_mega_29:
    buffer_load_dwordx4 v3, s[8:11], s31 offen sc1 lds
L_l_skip0:
    s_add_u32 m0, m0, 4096
    s_add_u32 s31, s31, 4096
    s_sub_u32 s36, s36, 1
    s_cmp_lg_u32 s36, 0
    s_cbranch_scc1 L_mega_29
    s_waitcnt vmcnt(3)
    s_mov_b32 s36, 6
L_mega_30:
    buffer_load_dwordx4 v3, s[8:11], s31 offen sc1 lds
    s_add_u32 m0, m0, 4096
    s_add_u32 s31, s31, 4096
    s_sub_u32 s36, s36, 1
    s_cmp_lg_u32 s36, 0
    s_cbranch_scc1 L_mega_30
    s_waitcnt vmcnt(6)
    s_barrier
    s_setprio 3
    s_mov_b32 s36, 11
L_mega_31:
    buffer_load_dwordx4 v3, s[8:11], s31 offen sc1 lds
    s_add_u32 m0, m0, 4096
    s_add_u32 s31, s31, 4096
    s_sub_u32 s36, s36, 1
    s_cmp_lg_u32 s36, 0
    s_cbranch_scc1 L_mega_31
    s_waitcnt vmcnt(9)
    s_barrier
    s_mov_b32 s36, 18
L_mega_32:
    buffer_load_dwordx4 v3, s[8:11], s31 offen sc1 lds
    s_add_u32 m0, m0, 4096
    s_add_u32 s31, s31, 4096
    s_sub_u32 s36, s36, 1
    s_cmp_lg_u32 s36, 0
    s_cbranch_scc1 L_mega_32
    s_lshl_b32 s28, s12, 8
    s_add_u32 s28, s28, s2
    s_cmp_lg_u32 s19, 0
    s_cselect_b32 s28, 1000, s28
    s_cmp_ge_u32 s28, 972
    s_cbranch_scc1 L_attn_noprep
    s_mov_b32 s83, 0x00020000
    s_and_b32 s37, s28, 31
    s_cmp_lt_u32 s28, 732
    s_cbranch_scc1 L_prep_notq
    s_sub_u32 s28, s28, 732
    s_and_b32 s56, s28, 7
    s_lshr_b32 s28, s28, 3
    s_lshl_b32 s28, s28, 6
    v_add_u32 v5, s28, v1
    v_lshlrev_b32 v64, 1, v5
    s_mov_b32 s80, s32
    s_mov_b32 s81, s33
    s_mov_b32 s82, 2457600
    s_movk_i32 s76, 3840
    v_mul_u32_u24 v6, 3277, v5
    v_lshrrev_b32 v6, 16, v6
    v_mul_u32_u24 v7, 20, v6
    v_sub_u32 v7, v5, v7
    v_mul_u32_u24 v8, 43, v6
    v_lshrrev_b32 v8, 8, v8
    v_mul_u32_u24 v9, 6, v8
    v_sub_u32 v9, v6, v9
    v_and_b32 v10, 6, v9
    v_bfe_u32 v11, v7, 2, 1
    v_add_u32 v10, v10, v11
    v_and_b32 v11, 1, v9
    v_lshlrev_b32 v12, 3, v11
    v_bfe_u32 v11, v7, 3, 1
    v_lshl_add_u32 v12, v11, 2, v12
    v_lshrrev_b32 v14, 2, v9
    v_add_u32 v14, 6, v14
    v_and_b32 v17, 3, v9
    v_lshlrev_b32 v17, 2, v17
    v_cmp_le_u32 s[30:31], 16, v7
    s_nop 1
    v_cndmask_b32 v10, v10, v14, s[30:31]
    v_cndmask_b32 v12, v12, v17, s[30:31]
    v_and_b32 v13, 3, v7
    v_add_u32 v12, v12, v13
    v_lshl_add_u32 v10, v8, 3, v10
    v_lshrrev_b32 v14, 4, v5
    v_add_u32 v14, 8, v14
    v_and_b32 v17, 15, v5
    s_movk_i32 s30, 1280
    v_cmp_le_u32 s[30:31], s30, v5
    s_nop 1
    v_cndmask_b32 v10, v10, v14, s[30:31]
    v_cndmask_b32 v12, v12, v17, s[30:31]
    v_mov_b32 v9, v12
    s_movk_i32 s31, 21504
    s_mov_b32 s35, 0x1000
    s_movk_i32 s38, 80
    s_mov_b32 s39, 1
    s_branch L_prep_go
L_prep_notq:
    s_cmp_ge_u32 s28, 432
    s_cbranch_scc1 L_prep_small
    s_and_b32 s56, s28, 7
    s_lshr_b32 s31, s28, 3
    s_cmp_ge_u32 s31, 27
    s_cselect_b32 s80, s90, s88
    s_cselect_b32 s81, s91, s89
    s_cselect_b32 s29, 21504, 0
    s_cselect_b32 s30, 27, 0
    s_sub_u32 s30, s31, s30
    s_mov_b32 s82, 2211840
    s_movk_i32 s76, 3456
    s_lshl_b32 s30, s30, 6
    v_add_u32 v9, s30, v1
    v_lshlrev_b32 v64, 1, v9
    v_lshrrev_b32 v10, 4, v9
    v_mov_b32 v11, 111
    v_cmp_eq_u32 vcc, 107, v10
    s_add_u32 s35, s29, 0x300000
    s_mov_b32 s31, 43008
    v_cndmask_b32 v10, v10, v11, vcc
    s_movk_i32 s38, 80
    s_mov_b32 s39, 1
    s_branch L_prep_go
L_prep_small:
    s_movk_i32 s76, 1280
    s_mov_b32 s39, 0
    s_mov_b32 s29, 819200
    s_movk_i32 s30, 432
    s_movk_i32 s38, 80
    s_movk_i32 s31, 20480
    s_mov_b32 s35, 0x800000
    s_cmp_ge_u32 s28, 512
    s_cselect_b32 s80, s92, s86
    s_cselect_b32 s81, s93, s87
    s_cselect_b32 s82, 2211840, s29
    s_cselect_b32 s29, 512, s30
    s_cselect_b32 s38, 216, s38
    s_cselect_b32 s31, 55296, s31
    s_cselect_b32 s35, 0x900000, s35
    s_sub_u32 s28, s28, s29
    s_mul_i32 s56, s28, 205
    s_lshr_b32 s56, s56, 11
    s_mul_i32 s29, s56, 10
    s_sub_u32 s28, s28, s29
    s_lshl_b32 s28, s28, 6
    v_add_u32 v9, s28, v1
    v_lshlrev_b32 v64, 1, v9
    v_lshrrev_b32 v10, 4, v9
L_prep_go:
    v_mul_u32_u24 v10, s31, v10
    v_add_u32 v10, s35, v10
    v_and_b32 v9, 15, v9
    v_lshl_add_u32 v65, v9, 4, v10
    v_lshl_add_u32 v66, v9, 3, v10
    s_mul_i32 s57, s56, 10
    s_mov_b32 s79, s57
    s_mov_b32 s35, 0
L_prep_rows:
    s_cmp_lg_u32 s39, 0
    s_cbranch_scc1 L_prep_rx
    s_cmp_eq_u32 s38, 80
    s_cbranch_scc1 L_prep_rwo
    s_add_u32 s58, s79, 0
    s_min_u32 s58, s58, 215
    s_and_b32 s59, s58, 3
    s_lshl_b32 s59, s59, 2
    s_lshr_b32 s60, s58, 2
    s_mul_i32 s61, s60, 86
    s_lshr_b32 s61, s61, 8
    s_mul_i32 s62, s61, 3
    s_sub_u32 s62, s60, s62
    s_mul_i32 s61, s61, 112
    s_lshl_b32 s62, s62, 5
    s_add_u32 s61, s61, s62
    s_add_u32 s61, s61, s59
    s_lshr_b32 s63, s58, 1
    s_mul_i32 s63, s63, 112
    s_sub_u32 s63, s63, 10208
    s_min_u32 s63, s63, 1712
    s_and_b32 s64, s58, 1
    s_lshl_b32 s64, s64, 3
    s_add_u32 s63, s63, s64
    s_cmp_ge_u32 s60, 46
    s_cselect_b32 s61, s63, s61
    s_cselect_b32 s62, 4, 16
    s_add_u32 s62, s61, s62
    s_mul_i32 s66, s61, s76
    s_mul_i32 s67, s62, s76
    s_add_u32 s58, s79, 1
    s_min_u32 s58, s58, 215
    s_and_b32 s59, s58, 3
    s_lshl_b32 s59, s59, 2
    s_lshr_b32 s60, s58, 2
    s_mul_i32 s61, s60, 86
    s_lshr_b32 s61, s61, 8
    s_mul_i32 s62, s61, 3
    s_sub_u32 s62, s60, s62
    s_mul_i32 s61, s61, 112
    s_lshl_b32 s62, s62, 5
    s_add_u32 s61, s61, s62
    s_add_u32 s61, s61, s59
    s_lshr_b32 s63, s58, 1
    s_mul_i32 s63, s63, 112
    s_sub_u32 s63, s63, 10208
    s_min_u32 s63, s63, 1712
    s_and_b32 s64, s58, 1
    s_lshl_b32 s64, s64, 3
    s_add_u32 s63, s63, s64
    s_cmp_ge_u32 s60, 46
    s_cselect_b32 s61, s63, s61
    s_cselect_b32 s62, 4, 16
    s_add_u32 s62, s61, s62
    s_mul_i32 s68, s61, s76
    s_mul_i32 s69, s62, s76
    s_add_u32 s58, s79, 2
    s_min_u32 s58, s58, 215
    s_and_b32 s59, s58, 3
    s_lshl_b32 s59, s59, 2
    s_lshr_b32 s60, s58, 2
    s_mul_i32 s61, s60, 86
    s_lshr_b32 s61, s61, 8
    s_mul_i32 s62, s61, 3
    s_sub_u32 s62, s60, s62
    s_mul_i32 s61, s61, 112
    s_lshl_b32 s62, s62, 5
    s_add_u32 s61, s61, s62
    s_add_u32 s61, s61, s59
    s_lshr_b32 s63, s58, 1
    s_mul_i32 s63, s63, 112
    s_sub_u32 s63, s63, 10208
    s_min_u32 s63, s63, 1712
    s_and_b32 s64, s58, 1
    s_lshl_b32 s64, s64, 3
    s_add_u32 s63, s63, s64
    s_cmp_ge_u32 s60, 46
    s_cselect_b32 s61, s63, s61
    s_cselect_b32 s62, 4, 16
    s_add_u32 s62, s61, s62
    s_mul_i32 s70, s61, s76
    s_mul_i32 s71, s62, s76
    s_add_u32 s58, s79, 3
    s_min_u32 s58, s58, 215
    s_and_b32 s59, s58, 3
    s_lshl_b32 s59, s59, 2
    s_lshr_b32 s60, s58, 2
    s_mul_i32 s61, s60, 86
    s_lshr_b32 s61, s61, 8
    s_mul_i32 s62, s61, 3
    s_sub_u32 s62, s60, s62
    s_mul_i32 s61, s61, 112
    s_lshl_b32 s62, s62, 5
    s_add_u32 s61, s61, s62
    s_add_u32 s61, s61, s59
    s_lshr_b32 s63, s58, 1
    s_mul_i32 s63, s63, 112
    s_sub_u32 s63, s63, 10208
    s_min_u32 s63, s63, 1712
    s_and_b32 s64, s58, 1
    s_lshl_b32 s64, s64, 3
    s_add_u32 s63, s63, s64
    s_cmp_ge_u32 s60, 46
    s_cselect_b32 s61, s63, s61
    s_cselect_b32 s62, 4, 16
    s_add_u32 s62, s61, s62
    s_mul_i32 s72, s61, s76
    s_mul_i32 s73, s62, s76
    s_add_u32 s58, s79, 4
    s_min_u32 s58, s58, 215
    s_and_b32 s59, s58, 3
    s_lshl_b32 s59, s59, 2
    s_lshr_b32 s60, s58, 2
    s_mul_i32 s61, s60, 86
    s_lshr_b32 s61, s61, 8
    s_mul_i32 s62, s61, 3
    s_sub_u32 s62, s60, s62
    s_mul_i32 s61, s61, 112
    s_lshl_b32 s62, s62, 5
    s_add_u32 s61, s61, s62
    s_add_u32 s61, s61, s59
    s_lshr_b32 s63, s58, 1
    s_mul_i32 s63, s63, 112
    s_sub_u32 s63, s63, 10208
    s_min_u32 s63, s63, 1712
    s_and_b32 s64, s58, 1
    s_lshl_b32 s64, s64, 3
    s_add_u32 s63, s63, s64
    s_cmp_ge_u32 s60, 46
    s_cselect_b32 s61, s63, s61
    s_cselect_b32 s62, 4, 16
    s_add_u32 s62, s61, s62
    s_mul_i32 s74, s61, s76
    s_mul_i32 s75, s62, s76
    s_branch L_prep_ld
L_prep_rwo:
    s_add_u32 s58, s79, 0
    s_and_b32 s59, s58, 3
    s_lshl_b32 s59, s59, 2
    s_lshr_b32 s60, s58, 2
    s_sub_u32 s60, s58, 8
    s_lshr_b32 s61, s60, 1
    s_mul_i32 s61, s61, 20
    s_and_b32 s62, s58, 1
    s_lshl_b32 s62, s62, 2
    s_add_u32 s61, s61, s62
    s_and_b32 s63, s58, 15
    s_mul_i32 s63, s63, 40
    s_add_u32 s63, s63, 16
    s_cmp_ge_u32 s60, 64
    s_cselect_b32 s61, s63, s61
    s_cselect_b32 s62, 20, 8
    s_add_u32 s62, s61, s62
    s_mul_i32 s66, s61, s76
    s_mul_i32 s67, s62, s76
    s_add_u32 s58, s79, 1
    s_and_b32 s59, s58, 3
    s_lshl_b32 s59, s59, 2
    s_lshr_b32 s60, s58, 2
    s_sub_u32 s60, s58, 8
    s_lshr_b32 s61, s60, 1
    s_mul_i32 s61, s61, 20
    s_and_b32 s62, s58, 1
    s_lshl_b32 s62, s62, 2
    s_add_u32 s61, s61, s62
    s_and_b32 s63, s58, 15
    s_mul_i32 s63, s63, 40
    s_add_u32 s63, s63, 16
    s_cmp_ge_u32 s60, 64
    s_cselect_b32 s61, s63, s61
    s_cselect_b32 s62, 20, 8
    s_add_u32 s62, s61, s62
    s_mul_i32 s68, s61, s76
    s_mul_i32 s69, s62, s76
    s_add_u32 s58, s79, 2
    s_and_b32 s59, s58, 3
    s_lshl_b32 s59, s59, 2
    s_lshr_b32 s60, s58, 2
    s_sub_u32 s60, s58, 8
    s_lshr_b32 s61, s60, 1
    s_mul_i32 s61, s61, 20
    s_and_b32 s62, s58, 1
    s_lshl_b32 s62, s62, 2
    s_add_u32 s61, s61, s62
    s_and_b32 s63, s58, 15
    s_mul_i32 s63, s63, 40
    s_add_u32 s63, s63, 16
    s_cmp_ge_u32 s60, 64
    s_cselect_b32 s61, s63, s61
    s_cselect_b32 s62, 20, 8
    s_add_u32 s62, s61, s62
    s_mul_i32 s70, s61, s76
    s_mul_i32 s71, s62, s76
    s_add_u32 s58, s79, 3
    s_and_b32 s59, s58, 3
    s_lshl_b32 s59, s59, 2
    s_lshr_b32 s60, s58, 2
    s_sub_u32 s60, s58, 8
    s_lshr_b32 s61, s60, 1
    s_mul_i32 s61, s61, 20
    s_and_b32 s62, s58, 1
    s_lshl_b32 s62, s62, 2
    s_add_u32 s61, s61, s62
    s_and_b32 s63, s58, 15
    s_mul_i32 s63, s63, 40
    s_add_u32 s63, s63, 16
    s_cmp_ge_u32 s60, 64
    s_cselect_b32 s61, s63, s61
    s_cselect_b32 s62, 20, 8
    s_add_u32 s62, s61, s62
    s_mul_i32 s72, s61, s76
    s_mul_i32 s73, s62, s76
    s_add_u32 s58, s79, 4
    s_and_b32 s59, s58, 3
    s_lshl_b32 s59, s59, 2
    s_lshr_b32 s60, s58, 2
    s_sub_u32 s60, s58, 8
    s_lshr_b32 s61, s60, 1
    s_mul_i32 s61, s61, 20
    s_and_b32 s62, s58, 1
    s_lshl_b32 s62, s62, 2
    s_add_u32 s61, s61, s62
    s_and_b32 s63, s58, 15
    s_mul_i32 s63, s63, 40
    s_add_u32 s63, s63, 16
    s_cmp_ge_u32 s60, 64
    s_cselect_b32 s61, s63, s61
    s_cselect_b32 s62, 20, 8
    s_add_u32 s62, s61, s62
    s_mul_i32 s74, s61, s76
    s_mul_i32 s75, s62, s76
    s_branch L_prep_ld
L_prep_rx:
    s_add_u32 s58, s79, 0
    s_and_b32 s59, s58, 3
    s_lshl_b32 s59, s59, 2
    s_lshr_b32 s60, s58, 2
    s_lshr_b32 s61, s60, 1
    s_and_b32 s62, s60, 1
    s_mul_i32 s61, s61, 80
    s_lshl_b32 s62, s62, 5
    s_add_u32 s61, s61, s62
    s_add_u32 s61, s61, s59
    s_lshr_b32 s63, s58, 1
    s_mul_i32 s63, s63, 80
    s_sub_u32 s63, s63, 2496
    s_and_b32 s64, s58, 1
    s_lshl_b32 s64, s64, 3
    s_add_u32 s63, s63, s64
    s_cmp_ge_u32 s60, 16
    s_cselect_b32 s61, s63, s61
    s_cselect_b32 s62, 4, 16
    s_add_u32 s62, s61, s62
    s_mul_i32 s66, s61, s76
    s_mul_i32 s67, s62, s76
    s_add_u32 s58, s79, 1
    s_and_b32 s59, s58, 3
    s_lshl_b32 s59, s59, 2
    s_lshr_b32 s60, s58, 2
    s_lshr_b32 s61, s60, 1
    s_and_b32 s62, s60, 1
    s_mul_i32 s61, s61, 80
    s_lshl_b32 s62, s62, 5
    s_add_u32 s61, s61, s62
    s_add_u32 s61, s61, s59
    s_lshr_b32 s63, s58, 1
    s_mul_i32 s63, s63, 80
    s_sub_u32 s63, s63, 2496
    s_and_b32 s64, s58, 1
    s_lshl_b32 s64, s64, 3
    s_add_u32 s63, s63, s64
    s_cmp_ge_u32 s60, 16
    s_cselect_b32 s61, s63, s61
    s_cselect_b32 s62, 4, 16
    s_add_u32 s62, s61, s62
    s_mul_i32 s68, s61, s76
    s_mul_i32 s69, s62, s76
    s_add_u32 s58, s79, 2
    s_and_b32 s59, s58, 3
    s_lshl_b32 s59, s59, 2
    s_lshr_b32 s60, s58, 2
    s_lshr_b32 s61, s60, 1
    s_and_b32 s62, s60, 1
    s_mul_i32 s61, s61, 80
    s_lshl_b32 s62, s62, 5
    s_add_u32 s61, s61, s62
    s_add_u32 s61, s61, s59
    s_lshr_b32 s63, s58, 1
    s_mul_i32 s63, s63, 80
    s_sub_u32 s63, s63, 2496
    s_and_b32 s64, s58, 1
    s_lshl_b32 s64, s64, 3
    s_add_u32 s63, s63, s64
    s_cmp_ge_u32 s60, 16
    s_cselect_b32 s61, s63, s61
    s_cselect_b32 s62, 4, 16
    s_add_u32 s62, s61, s62
    s_mul_i32 s70, s61, s76
    s_mul_i32 s71, s62, s76
    s_add_u32 s58, s79, 3
    s_and_b32 s59, s58, 3
    s_lshl_b32 s59, s59, 2
    s_lshr_b32 s60, s58, 2
    s_lshr_b32 s61, s60, 1
    s_and_b32 s62, s60, 1
    s_mul_i32 s61, s61, 80
    s_lshl_b32 s62, s62, 5
    s_add_u32 s61, s61, s62
    s_add_u32 s61, s61, s59
    s_lshr_b32 s63, s58, 1
    s_mul_i32 s63, s63, 80
    s_sub_u32 s63, s63, 2496
    s_and_b32 s64, s58, 1
    s_lshl_b32 s64, s64, 3
    s_add_u32 s63, s63, s64
    s_cmp_ge_u32 s60, 16
    s_cselect_b32 s61, s63, s61
    s_cselect_b32 s62, 4, 16
    s_add_u32 s62, s61, s62
    s_mul_i32 s72, s61, s76
    s_mul_i32 s73, s62, s76
    s_add_u32 s58, s79, 4
    s_and_b32 s59, s58, 3
    s_lshl_b32 s59, s59, 2
    s_lshr_b32 s60, s58, 2
    s_lshr_b32 s61, s60, 1
    s_and_b32 s62, s60, 1
    s_mul_i32 s61, s61, 80
    s_lshl_b32 s62, s62, 5
    s_add_u32 s61, s61, s62
    s_add_u32 s61, s61, s59
    s_lshr_b32 s63, s58, 1
    s_mul_i32 s63, s63, 80
    s_sub_u32 s63, s63, 2496
    s_and_b32 s64, s58, 1
    s_lshl_b32 s64, s64, 3
    s_add_u32 s63, s63, s64
    s_cmp_ge_u32 s60, 16
    s_cselect_b32 s61, s63, s61
    s_cselect_b32 s62, 4, 16
    s_add_u32 s62, s61, s62
    s_mul_i32 s74, s61, s76
    s_mul_i32 s75, s62, s76
L_prep_ld:
    s_cmp_lg_u32 s35, 0
    s_cbranch_scc1 L_prep_ld2
    buffer_load_ushort v80, v64, s[80:83], s66 offen
    s_add_u32 s66, s66, s76
    buffer_load_ushort v81, v64, s[80:83], s66 offen
    s_add_u32 s66, s66, s76
    buffer_load_ushort v82, v64, s[80:83], s66 offen
    s_add_u32 s66, s66, s76
    buffer_load_ushort v83, v64, s[80:83], s66 offen
    buffer_load_ushort v84, v64, s[80:83], s67 offen
    s_add_u32 s67, s67, s76
    buffer_load_ushort v85, v64, s[80:83], s67 offen
    s_add_u32 s67, s67, s76
    buffer_load_ushort v86, v64, s[80:83], s67 offen
    s_add_u32 s67, s67, s76
    buffer_load_ushort v87, v64, s[80:83], s67 offen
    buffer_load_ushort v88, v64, s[80:83], s68 offen
    s_add_u32 s68, s68, s76
    buffer_load_ushort v89, v64, s[80:83], s68 offen
    s_add_u32 s68, s68, s76
    buffer_load_ushort v90, v64, s[80:83], s68 offen
    s_add_u32 s68, s68, s76
    buffer_load_ushort v91, v64, s[80:83], s68 offen
    buffer_load_ushort v92, v64, s[80:83], s69 offen
    s_add_u32 s69, s69, s76
    buffer_load_ushort v93, v64, s[80:83], s69 offen
    s_add_u32 s69, s69, s76
    buffer_load_ushort v94, v64, s[80:83], s69 offen
    s_add_u32 s69, s69, s76
    buffer_load_ushort v95, v64, s[80:83], s69 offen
    buffer_load_ushort v96, v64, s[80:83], s70 offen
    s_add_u32 s70, s70, s76
    buffer_load_ushort v97, v64, s[80:83], s70 offen
    s_add_u32 s70, s70, s76
    buffer_load_ushort v98, v64, s[80:83], s70 offen
    s_add_u32 s70, s70, s76
    buffer_load_ushort v99, v64, s[80:83], s70 offen
    buffer_load_ushort v100, v64, s[80:83], s71 offen
    s_add_u32 s71, s71, s76
    buffer_load_ushort v101, v64, s[80:83], s71 offen
    s_add_u32 s71, s71, s76
    buffer_load_ushort v102, v64, s[80:83], s71 offen
    s_add_u32 s71, s71, s76
    buffer_load_ushort v103, v64, s[80:83], s71 offen
    buffer_load_ushort v104, v64, s[80:83], s72 offen
    s_add_u32 s72, s72, s76
    buffer_load_ushort v105, v64, s[80:83], s72 offen
    s_add_u32 s72, s72, s76
    buffer_load_ushort v106, v64, s[80:83], s72 offen
    s_add_u32 s72, s72, s76
    buffer_load_ushort v107, v64, s[80:83], s72 offen
    buffer_load_ushort v108, v64, s[80:83], s73 offen
    s_add_u32 s73, s73, s76
    buffer_load_ushort v109, v64, s[80:83], s73 offen
    s_add_u32 s73, s73, s76
    buffer_load_ushort v110, v64, s[80:83], s73 offen
    s_add_u32 s73, s73, s76
    buffer_load_ushort v111, v64, s[80:83], s73 offen
    buffer_load_ushort v112, v64, s[80:83], s74 offen
    s_add_u32 s74, s74, s76
    buffer_load_ushort v113, v64, s[80:83], s74 offen
    s_add_u32 s74, s74, s76
    buffer_load_ushort v114, v64, s[80:83], s74 offen
    s_add_u32 s74, s74, s76
    buffer_load_ushort v115, v64, s[80:83], s74 offen
    buffer_load_ushort v116, v64, s[80:83], s75 offen
    s_add_u32 s75, s75, s76
    buffer_load_ushort v117, v64, s[80:83], s75 offen
    s_add_u32 s75, s75, s76
    buffer_load_ushort v118, v64, s[80:83], s75 offen
    s_add_u32 s75, s75, s76
    buffer_load_ushort v119, v64, s[80:83], s75 offen
    s_mov_b32 s35, 1
    s_add_u32 s79, s79, 5
    s_branch L_prep_rows
L_prep_ld2:
    s_waitcnt vmcnt(40)
    buffer_load_ushort v120, v64, s[80:83], s66 offen
    s_add_u32 s66, s66, s76
    buffer_load_ushort v121, v64, s[80:83], s66 offen
    s_add_u32 s66, s66, s76
    buffer_load_ushort v122, v64, s[80:83], s66 offen
    s_add_u32 s66, s66, s76
    buffer_load_ushort v123, v64, s[80:83], s66 offen
    buffer_load_ushort v124, v64, s[80:83], s67 offen
    s_add_u32 s67, s67, s76
    buffer_load_ushort v125, v64, s[80:83], s67 offen
    s_add_u32 s67, s67, s76
    buffer_load_ushort v126, v64, s[80:83], s67 offen
    s_add_u32 s67, s67, s76
    buffer_load_ushort v127, v64, s[80:83], s67 offen
    buffer_load_ushort v128, v64, s[80:83], s68 offen
    s_add_u32 s68, s68, s76
    buffer_load_ushort v129, v64, s[80:83], s68 offen
    s_add_u32 s68, s68, s76
    buffer_load_ushort v130, v64, s[80:83], s68 offen
    s_add_u32 s68, s68, s76
    buffer_load_ushort v131, v64, s[80:83], s68 offen
    buffer_load_ushort v132, v64, s[80:83], s69 offen
    s_add_u32 s69, s69, s76
    buffer_load_ushort v133, v64, s[80:83], s69 offen
    s_add_u32 s69, s69, s76
    buffer_load_ushort v134, v64, s[80:83], s69 offen
    s_add_u32 s69, s69, s76
    buffer_load_ushort v135, v64, s[80:83], s69 offen
    buffer_load_ushort v136, v64, s[80:83], s70 offen
    s_add_u32 s70, s70, s76
    buffer_load_ushort v137, v64, s[80:83], s70 offen
    s_add_u32 s70, s70, s76
    buffer_load_ushort v138, v64, s[80:83], s70 offen
    s_add_u32 s70, s70, s76
    buffer_load_ushort v139, v64, s[80:83], s70 offen
    buffer_load_ushort v140, v64, s[80:83], s71 offen
    s_add_u32 s71, s71, s76
    buffer_load_ushort v141, v64, s[80:83], s71 offen
    s_add_u32 s71, s71, s76
    buffer_load_ushort v142, v64, s[80:83], s71 offen
    s_add_u32 s71, s71, s76
    buffer_load_ushort v143, v64, s[80:83], s71 offen
    buffer_load_ushort v144, v64, s[80:83], s72 offen
    s_add_u32 s72, s72, s76
    buffer_load_ushort v145, v64, s[80:83], s72 offen
    s_add_u32 s72, s72, s76
    buffer_load_ushort v146, v64, s[80:83], s72 offen
    s_add_u32 s72, s72, s76
    buffer_load_ushort v147, v64, s[80:83], s72 offen
    buffer_load_ushort v148, v64, s[80:83], s73 offen
    s_add_u32 s73, s73, s76
    buffer_load_ushort v149, v64, s[80:83], s73 offen
    s_add_u32 s73, s73, s76
    buffer_load_ushort v150, v64, s[80:83], s73 offen
    s_add_u32 s73, s73, s76
    buffer_load_ushort v151, v64, s[80:83], s73 offen
    buffer_load_ushort v152, v64, s[80:83], s74 offen
    s_add_u32 s74, s74, s76
    buffer_load_ushort v153, v64, s[80:83], s74 offen
    s_add_u32 s74, s74, s76
    buffer_load_ushort v154, v64, s[80:83], s74 offen
    s_add_u32 s74, s74, s76
    buffer_load_ushort v155, v64, s[80:83], s74 offen
    buffer_load_ushort v156, v64, s[80:83], s75 offen
    s_add_u32 s75, s75, s76
    buffer_load_ushort v157, v64, s[80:83], s75 offen
    s_add_u32 s75, s75, s76
    buffer_load_ushort v158, v64, s[80:83], s75 offen
    s_add_u32 s75, s75, s76
    buffer_load_ushort v159, v64, s[80:83], s75 offen
    s_barrier
    s_waitcnt vmcnt(0)
    s_lshl_b32 s58, s57, 8
    v_lshl_or_b32 v72, v81, 16, v80
    v_lshl_or_b32 v73, v83, 16, v82
    v_lshl_or_b32 v74, v85, 16, v84
    v_lshl_or_b32 v75, v87, 16, v86
    buffer_store_dwordx4 v[72:75], v65, s[8:11], s58 offen offset:0 sc0 sc1
    s_add_u32 s59, s57, 1
    s_cmp_ge_u32 s59, s38
    s_cbranch_scc1 L_mega_33
    v_lshl_or_b32 v76, v89, 16, v88
    v_lshl_or_b32 v77, v91, 16, v90
    v_lshl_or_b32 v78, v93, 16, v92
    v_lshl_or_b32 v79, v95, 16, v94
    buffer_store_dwordx4 v[76:79], v65, s[8:11], s58 offen offset:256 sc0 sc1
    s_add_u32 s59, s57, 2
    s_cmp_ge_u32 s59, s38
    s_cbranch_scc1 L_mega_33
    v_lshl_or_b32 v72, v97, 16, v96
    v_lshl_or_b32 v73, v99, 16, v98
    v_lshl_or_b32 v74, v101, 16, v100
    v_lshl_or_b32 v75, v103, 16, v102
    buffer_store_dwordx4 v[72:75], v65, s[8:11], s58 offen offset:512 sc0 sc1
    s_add_u32 s59, s57, 3
    s_cmp_ge_u32 s59, s38
    s_cbranch_scc1 L_mega_33
    v_lshl_or_b32 v76, v105, 16, v104
    v_lshl_or_b32 v77, v107, 16, v106
    v_lshl_or_b32 v78, v109, 16, v108
    v_lshl_or_b32 v79, v111, 16, v110
    buffer_store_dwordx4 v[76:79], v65, s[8:11], s58 offen offset:768 sc0 sc1
    s_add_u32 s59, s57, 4
    s_cmp_ge_u32 s59, s38
    s_cbranch_scc1 L_mega_33
    v_lshl_or_b32 v72, v113, 16, v112
    v_lshl_or_b32 v73, v115, 16, v114
    v_lshl_or_b32 v74, v117, 16, v116
    v_lshl_or_b32 v75, v119, 16, v118
    buffer_store_dwordx4 v[72:75], v65, s[8:11], s58 offen offset:1024 sc0 sc1
    s_add_u32 s59, s57, 5
    s_cmp_ge_u32 s59, s38
    s_cbranch_scc1 L_mega_33
    v_lshl_or_b32 v76, v121, 16, v120
    v_lshl_or_b32 v77, v123, 16, v122
    v_lshl_or_b32 v78, v125, 16, v124
    v_lshl_or_b32 v79, v127, 16, v126
    buffer_store_dwordx4 v[76:79], v65, s[8:11], s58 offen offset:1280 sc0 sc1
    s_add_u32 s59, s57, 6
    s_cmp_ge_u32 s59, s38
    s_cbranch_scc1 L_mega_33
    v_lshl_or_b32 v72, v129, 16, v128
    v_lshl_or_b32 v73, v131, 16, v130
    v_lshl_or_b32 v74, v133, 16, v132
    v_lshl_or_b32 v75, v135, 16, v134
    buffer_store_dwordx4 v[72:75], v65, s[8:11], s58 offen offset:1536 sc0 sc1
    s_add_u32 s59, s57, 7
    s_cmp_ge_u32 s59, s38
    s_cbranch_scc1 L_mega_33
    v_lshl_or_b32 v76, v137, 16, v136
    v_lshl_or_b32 v77, v139, 16, v138
    v_lshl_or_b32 v78, v141, 16, v140
    v_lshl_or_b32 v79, v143, 16, v142
    buffer_store_dwordx4 v[76:79], v65, s[8:11], s58 offen offset:1792 sc0 sc1
    s_add_u32 s59, s57, 8
    s_cmp_ge_u32 s59, s38
    s_cbranch_scc1 L_mega_33
    v_lshl_or_b32 v72, v145, 16, v144
    v_lshl_or_b32 v73, v147, 16, v146
    v_lshl_or_b32 v74, v149, 16, v148
    v_lshl_or_b32 v75, v151, 16, v150
    buffer_store_dwordx4 v[72:75], v65, s[8:11], s58 offen offset:2048 sc0 sc1
    s_add_u32 s59, s57, 9
    s_cmp_ge_u32 s59, s38
    s_cbranch_scc1 L_mega_33
    v_lshl_or_b32 v76, v153, 16, v152
    v_lshl_or_b32 v77, v155, 16, v154
    v_lshl_or_b32 v78, v157, 16, v156
    v_lshl_or_b32 v79, v159, 16, v158
    buffer_store_dwordx4 v[76:79], v65, s[8:11], s58 offen offset:2304 sc0 sc1
L_mega_33:
    s_cmp_eq_u32 s39, 0
    s_cbranch_scc1 L_mega_34
    v_lshlrev_b32 v80, 16, v80
    v_lshlrev_b32 v81, 16, v81
    v_lshlrev_b32 v82, 16, v82
    v_lshlrev_b32 v83, 16, v83
    v_pk_add_f32 v[80:81], v[80:81], v[82:83]
    v_lshlrev_b32 v84, 16, v84
    v_lshlrev_b32 v85, 16, v85
    v_pk_add_f32 v[80:81], v[80:81], v[84:85]
    v_lshlrev_b32 v86, 16, v86
    v_lshlrev_b32 v87, 16, v87
    v_pk_add_f32 v[80:81], v[80:81], v[86:87]
    v_lshlrev_b32 v88, 16, v88
    v_lshlrev_b32 v89, 16, v89
    v_pk_add_f32 v[80:81], v[80:81], v[88:89]
    v_lshlrev_b32 v90, 16, v90
    v_lshlrev_b32 v91, 16, v91
    v_pk_add_f32 v[80:81], v[80:81], v[90:91]
    v_lshlrev_b32 v92, 16, v92
    v_lshlrev_b32 v93, 16, v93
    v_pk_add_f32 v[80:81], v[80:81], v[92:93]
    v_lshlrev_b32 v94, 16, v94
    v_lshlrev_b32 v95, 16, v95
    v_pk_add_f32 v[80:81], v[80:81], v[94:95]
    v_lshlrev_b32 v96, 16, v96
    v_lshlrev_b32 v97, 16, v97
    v_pk_add_f32 v[80:81], v[80:81], v[96:97]
    v_lshlrev_b32 v98, 16, v98
    v_lshlrev_b32 v99, 16, v99
    v_pk_add_f32 v[80:81], v[80:81], v[98:99]
    v_lshlrev_b32 v100, 16, v100
    v_lshlrev_b32 v101, 16, v101
    v_pk_add_f32 v[80:81], v[80:81], v[100:101]
    v_lshlrev_b32 v102, 16, v102
    v_lshlrev_b32 v103, 16, v103
    v_pk_add_f32 v[80:81], v[80:81], v[102:103]
    v_lshlrev_b32 v104, 16, v104
    v_lshlrev_b32 v105, 16, v105
    v_pk_add_f32 v[80:81], v[80:81], v[104:105]
    v_lshlrev_b32 v106, 16, v106
    v_lshlrev_b32 v107, 16, v107
    v_pk_add_f32 v[80:81], v[80:81], v[106:107]
    v_lshlrev_b32 v108, 16, v108
    v_lshlrev_b32 v109, 16, v109
    v_pk_add_f32 v[80:81], v[80:81], v[108:109]
    v_lshlrev_b32 v110, 16, v110
    v_lshlrev_b32 v111, 16, v111
    v_pk_add_f32 v[80:81], v[80:81], v[110:111]
    v_lshlrev_b32 v112, 16, v112
    v_lshlrev_b32 v113, 16, v113
    v_pk_add_f32 v[80:81], v[80:81], v[112:113]
    v_lshlrev_b32 v114, 16, v114
    v_lshlrev_b32 v115, 16, v115
    v_pk_add_f32 v[80:81], v[80:81], v[114:115]
    v_lshlrev_b32 v116, 16, v116
    v_lshlrev_b32 v117, 16, v117
    v_pk_add_f32 v[80:81], v[80:81], v[116:117]
    v_lshlrev_b32 v118, 16, v118
    v_lshlrev_b32 v119, 16, v119
    v_pk_add_f32 v[80:81], v[80:81], v[118:119]
    v_lshlrev_b32 v120, 16, v120
    v_lshlrev_b32 v121, 16, v121
    v_pk_add_f32 v[80:81], v[80:81], v[120:121]
    v_lshlrev_b32 v122, 16, v122
    v_lshlrev_b32 v123, 16, v123
    v_pk_add_f32 v[80:81], v[80:81], v[122:123]
    v_lshlrev_b32 v124, 16, v124
    v_lshlrev_b32 v125, 16, v125
    v_pk_add_f32 v[80:81], v[80:81], v[124:125]
    v_lshlrev_b32 v126, 16, v126
    v_lshlrev_b32 v127, 16, v127
    v_pk_add_f32 v[80:81], v[80:81], v[126:127]
    v_lshlrev_b32 v128, 16, v128
    v_lshlrev_b32 v129, 16, v129
    v_pk_add_f32 v[80:81], v[80:81], v[128:129]
    v_lshlrev_b32 v130, 16, v130
    v_lshlrev_b32 v131, 16, v131
    v_pk_add_f32 v[80:81], v[80:81], v[130:131]
    v_lshlrev_b32 v132, 16, v132
    v_lshlrev_b32 v133, 16, v133
    v_pk_add_f32 v[80:81], v[80:81], v[132:133]
    v_lshlrev_b32 v134, 16, v134
    v_lshlrev_b32 v135, 16, v135
    v_pk_add_f32 v[80:81], v[80:81], v[134:135]
    v_lshlrev_b32 v136, 16, v136
    v_lshlrev_b32 v137, 16, v137
    v_pk_add_f32 v[80:81], v[80:81], v[136:137]
    v_lshlrev_b32 v138, 16, v138
    v_lshlrev_b32 v139, 16, v139
    v_pk_add_f32 v[80:81], v[80:81], v[138:139]
    v_lshlrev_b32 v140, 16, v140
    v_lshlrev_b32 v141, 16, v141
    v_pk_add_f32 v[80:81], v[80:81], v[140:141]
    v_lshlrev_b32 v142, 16, v142
    v_lshlrev_b32 v143, 16, v143
    v_pk_add_f32 v[80:81], v[80:81], v[142:143]
    v_lshlrev_b32 v144, 16, v144
    v_lshlrev_b32 v145, 16, v145
    v_pk_add_f32 v[80:81], v[80:81], v[144:145]
    v_lshlrev_b32 v146, 16, v146
    v_lshlrev_b32 v147, 16, v147
    v_pk_add_f32 v[80:81], v[80:81], v[146:147]
    v_lshlrev_b32 v148, 16, v148
    v_lshlrev_b32 v149, 16, v149
    v_pk_add_f32 v[80:81], v[80:81], v[148:149]
    v_lshlrev_b32 v150, 16, v150
    v_lshlrev_b32 v151, 16, v151
    v_pk_add_f32 v[80:81], v[80:81], v[150:151]
    v_lshlrev_b32 v152, 16, v152
    v_lshlrev_b32 v153, 16, v153
    v_pk_add_f32 v[80:81], v[80:81], v[152:153]
    v_lshlrev_b32 v154, 16, v154
    v_lshlrev_b32 v155, 16, v155
    v_pk_add_f32 v[80:81], v[80:81], v[154:155]
    v_lshlrev_b32 v156, 16, v156
    v_lshlrev_b32 v157, 16, v157
    v_pk_add_f32 v[80:81], v[80:81], v[156:157]
    v_lshlrev_b32 v158, 16, v158
    v_lshlrev_b32 v159, 16, v159
    v_pk_add_f32 v[80:81], v[80:81], v[158:159]
    v_add_f32 v80, v80, v81
    s_lshr_b32 s58, s56, 1
    s_lshl_b32 s58, s58, 7
    s_and_b32 s59, s56, 1
    s_lshl_b32 s59, s59, 2
    s_add_u32 s58, s58, s59
    s_add_u32 s58, s58, 20480
    buffer_store_dword v80, v66, s[8:11], s58 offen sc0 sc1
L_mega_34:
    s_lshl_b32 s37, s37, 9
    s_add_u32 s37, s37, 0xc00180
    s_waitcnt vmcnt(0)
    s_mov_b64 exec, 1
    buffer_atomic_add v15, off, s[8:11], s37 sc1
    s_mov_b64 exec, -1
    s_branch L_attn_Bgo
L_attn_noprep:
    s_waitcnt vmcnt(0)
    s_barrier
L_attn_Bgo:
    s_cmp_lg_u32 s19, 0
    s_cbranch_scc1 L_attn_prepok
    s_lshl_b32 s28, s13, 2
    s_add_u32 s28, s28, s12
    s_mul_i32 s28, s28, 110592
    s_add_u32 s28, s28, 0x2300000
    s_mul_i32 s29, s14, 3072
    s_add_u32 s30, s28, s29
    s_lshl_b32 s29, s14, 9
    s_add_u32 s29, s28, s29
    s_add_u32 s29, s29, 47104
    s_cmp_eq_u32 s14, 15
    s_cselect_b32 s31, 0, 1024
    v_add_u32 v24, s31, v3
    v_add_u32 v25, s31, v24
    buffer_load_dwordx4 v[20:23], v3, s[8:11], s30 offen sc1
    buffer_load_dwordx4 v[20:23], v24, s[8:11], s30 offen sc1
    buffer_load_dwordx4 v[20:23], v25, s[8:11], s30 offen sc1
    s_mov_b32 exec_hi, 0
    buffer_load_dwordx4 v[20:23], v3, s[8:11], s29 offen sc1
    s_mov_b64 exec, -1
    s_add_u32 s30, s30, 55296
    s_add_u32 s29, s29, 55296
    buffer_load_dwordx4 v[20:23], v3, s[8:11], s30 offen sc1
    buffer_load_dwordx4 v[20:23], v24, s[8:11], s30 offen sc1
    buffer_load_dwordx4 v[20:23], v25, s[8:11], s30 offen sc1
    s_mov_b32 exec_hi, 0
    buffer_load_dwordx4 v[20:23], v3, s[8:11], s29 offen sc1
    s_mov_b64 exec, -1
L_attn_prepok:
    s_lshl_b32 s28, s15, 2
    s_add_u32 s28, s28, s12
    s_mul_i32 s29, s28, 20480
    s_add_u32 s29, s29, 0x1000000
    s_lshl_b32 s30, s16, 11
    s_add_u32 s30, s30, s29
    s_lshl_b32 s31, s16, 9
    s_add_u32 s31, s31, s29
    s_add_u32 s31, s31, 16384
    buffer_load_dwordx4 v[20:23], v3, s[8:11], s30 offen sc1
    buffer_load_dwordx4 v[20:23], v3, s[8:11], s30 offen offset:1024 sc1
    s_mov_b32 exec_hi, 0
    buffer_load_dwordx4 v[20:23], v3, s[8:11], s31 offen sc1
    s_lshl_b32 s29, s16, 14
    s_lshl_b32 s28, s28, 7
    s_add_u32 s29, s29, s28
    s_add_u32 s29, s29, 0x1280000
    s_mov_b64 exec, 1
    buffer_load_dwordx4 v[20:23], v3, s[8:11], s29 offen sc1
    s_mov_b64 exec, -1
    s_mul_i32 s28, s16, 102400
    s_lshr_b32 s29, s12, 0
    s_lshl_b32 s29, s29, 10
    s_add_u32 s28, s28, s29
    s_add_u32 s28, s28, 0x800000
    s_add_u32 s29, s28, 0
    v_add_u32 v52, s29, v3
    s_add_u32 s29, s28, 19456
    v_add_u32 v53, s29, v3
    s_add_u32 s29, s28, 38912
    v_add_u32 v54, s29, v3
    s_add_u32 s29, s28, 58368
    v_add_u32 v55, s29, v3
    s_add_u32 s29, s28, 81920
    v_add_u32 v56, s29, v3
    s_mul_i32 s28, s15, 81920
    s_mov_b32 s29, s12
    s_lshl_b32 s29, s29, 10
    s_add_u32 s28, s28, s29
    s_add_u32 s28, s28, 0x2000000
    s_add_u32 s28, s28, s19
    v_add_u32 v48, s28, v3
    s_add_u32 s28, s28, 19456
    v_add_u32 v49, s28, v3
    s_add_u32 s28, s28, 19456
    v_add_u32 v50, s28, v3
    s_add_u32 s28, s28, 19456
    v_add_u32 v51, s28, v3
    s_setprio 0
    s_barrier
    s_branch L_l_after_attn
L_attn_slow:
    s_mov_b32 s50, 1
    v_mov_b32 v10, 0xff800000
    v_mov_b32 v11, 0xff800000
    s_mov_b32 s36, 0
    buffer_load_dwordx4 v[152:155], v3, s[8:11], s39 offen sc1
    buffer_load_dwordx2 v[160:161], v27, s[8:11], s38 offen sc1
    ds_read_b64 v[162:163], v27 offset:4608
    s_waitcnt vmcnt(0)
    s_branch L_attn_slow_in
L_attn_slow_loop:
    ds_read_b64 v[160:161], v27 offset:4096
    ds_read_b64 v[162:163], v27 offset:4608
    ds_read_b128 v[152:155], v26 offset:0
L_attn_slow_in:
    s_waitcnt lgkmcnt(0)
    v_mfma_f32_32x32x16_bf16 v[48:63], v[152:155], v[32:35], 0
    v_mfma_f32_32x32x8_bf16 v[48:63], v[160:161], v[40:41], v[48:63]
    v_mfma_f32_32x32x16_bf16 v[64:79], v[152:155], v[36:39], 0
    v_mfma_f32_32x32x8_bf16 v[64:79], v[160:161], v[42:43], v[64:79]
    s_nop 15
    v_max3_f32 v10, v10, v48, v49
    v_max3_f32 v10, v10, v50, v51
    v_max3_f32 v10, v10, v52, v53
    v_max3_f32 v10, v10, v54, v55
    v_max3_f32 v10, v10, v56, v57
    v_max3_f32 v10, v10, v58, v59
    v_max3_f32 v10, v10, v60, v61
    v_max3_f32 v10, v10, v62, v63
    v_max3_f32 v11, v11, v64, v65
    v_max3_f32 v11, v11, v66, v67
    v_max3_f32 v11, v11, v68, v69
    v_max3_f32 v11, v11, v70, v71
    v_max3_f32 v11, v11, v72, v73
    v_max3_f32 v11, v11, v74, v75
    v_max3_f32 v11, v11, v76, v77
    v_max3_f32 v11, v11, v78, v79
    ds_read_b128 v[156:159], v26 offset:1024
    s_waitcnt lgkmcnt(0)
    v_mfma_f32_32x32x16_bf16 v[48:63], v[156:159], v[32:35], 0
    v_mfma_f32_32x32x8_bf16 v[48:63], v[162:163], v[40:41], v[48:63]
    v_mfma_f32_32x32x16_bf16 v[64:79], v[156:159], v[36:39], 0
    v_mfma_f32_32x32x8_bf16 v[64:79], v[162:163], v[42:43], v[64:79]
    s_nop 15
    v_max3_f32 v10, v10, v48, v49
    v_max3_f32 v10, v10, v50, v51
    v_max3_f32 v10, v10, v52, v53
    v_max3_f32 v10, v10, v54, v55
    v_max3_f32 v10, v10, v56, v57
    v_max3_f32 v10, v10, v58, v59
    v_max3_f32 v10, v10, v60, v61
    v_max3_f32 v10, v10, v62, v63
    v_max3_f32 v11, v11, v64, v65
    v_max3_f32 v11, v11, v66, v67
    v_max3_f32 v11, v11, v68, v69
    v_max3_f32 v11, v11, v70, v71
    v_max3_f32 v11, v11, v72, v73
    v_max3_f32 v11, v11, v74, v75
    v_max3_f32 v11, v11, v76, v77
    v_max3_f32 v11, v11, v78, v79
    ds_read_b128 v[152:155], v26 offset:2048
    s_waitcnt lgkmcnt(0)
    v_mfma_f32_32x32x16_bf16 v[48:63], v[152:155], v[32:35], 0
    v_mfma_f32_32x32x8_bf16 v[48:63], v[160:161], v[44:45], v[48:63]
    v_mfma_f32_32x32x16_bf16 v[64:79], v[152:155], v[36:39], 0
    v_mfma_f32_32x32x8_bf16 v[64:79], v[160:161], v[46:47], v[64:79]
    s_nop 15
    v_max3_f32 v10, v10, v48, v49
    v_max3_f32 v10, v10, v50, v51
    v_max3_f32 v10, v10, v52, v53
    v_max3_f32 v10, v10, v54, v55
    v_max3_f32 v10, v10, v56, v57
    v_max3_f32 v10, v10, v58, v59
    v_max3_f32 v10, v10, v60, v61
    v_max3_f32 v10, v10, v62, v63
    v_max3_f32 v11, v11, v64, v65
    v_max3_f32 v11, v11, v66, v67
    v_max3_f32 v11, v11, v68, v69
    v_max3_f32 v11, v11, v70, v71
    v_max3_f32 v11, v11, v72, v73
    v_max3_f32 v11, v11, v74, v75
    v_max3_f32 v11, v11, v76, v77
    v_max3_f32 v11, v11, v78, v79
    ds_read_b128 v[156:159], v26 offset:3072
    s_waitcnt lgkmcnt(0)
    v_mfma_f32_32x32x16_bf16 v[48:63], v[156:159], v[32:35], 0
    v_mfma_f32_32x32x8_bf16 v[48:63], v[162:163], v[44:45], v[48:63]
    v_mfma_f32_32x32x16_bf16 v[64:79], v[156:159], v[36:39], 0
    v_mfma_f32_32x32x8_bf16 v[64:79], v[162:163], v[46:47], v[64:79]
    s_nop 15
    v_max3_f32 v10, v10, v48, v49
    v_max3_f32 v10, v10, v50, v51
    v_max3_f32 v10, v10, v52, v53
    v_max3_f32 v10, v10, v54, v55
    v_max3_f32 v10, v10, v56, v57
    v_max3_f32 v10, v10, v58, v59
    v_max3_f32 v10, v10, v60, v61
    v_max3_f32 v10, v10, v62, v63
    v_max3_f32 v11, v11, v64, v65
    v_max3_f32 v11, v11, v66, v67
    v_max3_f32 v11, v11, v68, v69
    v_max3_f32 v11, v11, v70, v71
    v_max3_f32 v11, v11, v72, v73
    v_max3_f32 v11, v11, v74, v75
    v_max3_f32 v11, v11, v76, v77
    v_max3_f32 v11, v11, v78, v79
    v_add_u32 v26, s52, v26
    v_add_u32 v27, s52, v27
    s_add_u32 s36, s36, 1
    s_cmp_lg_u32 s36, 16
    s_cbranch_scc1 L_attn_slow_loop
    v_subrev_u32 v26, 163840, v26
    v_subrev_u32 v27, 163840, v27
    buffer_load_dwordx4 v[152:155], v3, s[8:11], s39 offen sc1
    buffer_load_dwordx2 v[160:161], v27, s[8:11], s38 offen sc1
    v_mov_b64 v[80:81], 0
    v_mov_b64 v[82:83], 0
    v_mov_b64 v[84:85], 0
    v_mov_b64 v[86:87], 0
    v_mov_b64 v[88:89], 0
    v_mov_b64 v[90:91], 0
    v_mov_b64 v[92:93], 0
    v_mov_b64 v[94:95], 0
    v_mov_b64 v[96:97], 0
    v_mov_b64 v[98:99], 0
    v_mov_b64 v[100:101], 0
    v_mov_b64 v[102:103], 0
    v_mov_b64 v[104:105], 0
    v_mov_b64 v[106:107], 0
    v_mov_b64 v[108:109], 0
    v_mov_b64 v[110:111], 0
    v_mov_b64 v[148:149], 0
    v_mov_b64 v[176:177], 0
    v_mov_b64 v[150:151], 0
    v_mov_b64 v[178:179], 0
    s_waitcnt vmcnt(0)
    s_branch L_attn_start
L_raw_qk:
    v_and_b32 v4, 3, v1
    v_bfe_u32 v5, v1, 2, 2
    v_lshlrev_b32 v6, 1, v5
    v_and_b32 v27, 1, v8
    v_lshl_add_u32 v6, v27, 3, v6
    v_lshl_add_u32 v5, v8, 3, v5
    v_lshlrev_b32 v5, 8, v5
    v_add_u32 v5, 0x4000, v5
    v_lshrrev_b32 v27, 1, v4
    v_mul_u32_u24 v27, 40, v27
    v_and_b32 v28, 1, v4
    v_lshl_add_u32 v27, v28, 4, v27
    v_mul_u32_u24 v28, 40, v4
    v_and_b32 v29, 1, v4
    v_mul_u32_u24 v29, 40, v29
    v_add_u32 v30, 0, v27
    v_lshrrev_b32 v31, 4, v30
    v_xor_b32 v31, v31, v6
    v_and_b32 v30, 8, v30
    v_lshl_add_u32 v30, v31, 4, v30
    v_add_u32 v192, v30, v5
    v_add_u32 v30, 8, v27
    v_lshrrev_b32 v31, 4, v30
    v_xor_b32 v31, v31, v6
    v_and_b32 v30, 8, v30
    v_lshl_add_u32 v30, v31, 4, v30
    v_add_u32 v193, v30, v5
    v_add_u32 v30, 80, v27
    v_lshrrev_b32 v31, 4, v30
    v_xor_b32 v31, v31, v6
    v_and_b32 v30, 8, v30
    v_lshl_add_u32 v30, v31, 4, v30
    v_add_u32 v194, v30, v5
    v_add_u32 v30, 88, v27
    v_lshrrev_b32 v31, 4, v30
    v_xor_b32 v31, v31, v6
    v_and_b32 v30, 8, v30
    v_lshl_add_u32 v30, v31, 4, v30
    v_add_u32 v195, v30, v5
    v_add_u32 v30, 160, v27
    v_lshrrev_b32 v31, 4, v30
    v_xor_b32 v31, v31, v6
    v_and_b32 v30, 8, v30
    v_lshl_add_u32 v30, v31, 4, v30
    v_add_u32 v196, v30, v5
    v_add_u32 v30, 168, v27
    v_lshrrev_b32 v31, 4, v30
    v_xor_b32 v31, v31, v6
    v_and_b32 v30, 8, v30
    v_lshl_add_u32 v30, v31, 4, v30
    v_add_u32 v197, v30, v5
    v_add_u32 v30, 32, v28
    v_lshrrev_b32 v31, 4, v30
    v_xor_b32 v31, v31, v6
    v_and_b32 v30, 8, v30
    v_lshl_add_u32 v30, v31, 4, v30
    v_add_u32 v198, v30, v5
    v_add_u32 v30, 192, v29
    v_lshrrev_b32 v31, 4, v30
    v_xor_b32 v31, v31, v6
    v_and_b32 v30, 8, v30
    v_lshl_add_u32 v30, v31, 4, v30
    v_add_u32 v199, v30, v5
    v_mov_b32 v202, v192
    s_cmp_eq_u32 s12, 1
    s_cselect_b64 vcc, -1, 0
    v_cndmask_b32 v202, v202, v194, vcc
    s_cmp_eq_u32 s12, 2
    s_cselect_b64 vcc, -1, 0
    v_cndmask_b32 v202, v202, v196, vcc
    s_cmp_eq_u32 s12, 3
    s_cselect_b64 vcc, -1, 0
    v_cndmask_b32 v202, v202, v198, vcc
    v_mov_b32 v203, v193
    s_cmp_eq_u32 s12, 1
    s_cselect_b64 vcc, -1, 0
    v_cndmask_b32 v203, v203, v195, vcc
    s_cmp_eq_u32 s12, 2
    s_cselect_b64 vcc, -1, 0
    v_cndmask_b32 v203, v203, v197, vcc
    s_cmp_eq_u32 s12, 3
    s_cselect_b64 vcc, -1, 0
    v_cndmask_b32 v203, v203, v199, vcc
    v_lshrrev_b32 v4, 1, v7
    v_xor_b32 v4, v4, v8
    v_lshlrev_b32 v4, 4, v4
    v_lshl_add_u32 v4, v7, 7, v4
    s_lshl_b32 s28, s12, 12
    v_add_u32 v200, s28, v4
    v_xor_b32 v201, 64, v200
    v_mov_b32 v204, 0x3f803f80
    v_mov_b32 v205, 0x3f803f80
    v_mov_b32 v206, 0x3f803f80
    v_mov_b32 v207, 0x3f803f80
    v_mov_b64 v[32:33], 0
    v_mov_b64 v[34:35], 0
    v_mov_b64 v[36:37], 0
    v_mov_b64 v[38:39], 0
    v_mov_b64 v[40:41], 0
    v_mov_b64 v[42:43], 0
    v_mov_b64 v[44:45], 0
    v_mov_b64 v[46:47], 0
    v_mov_b64 v[48:49], 0
    v_mov_b64 v[50:51], 0
    v_mov_b64 v[52:53], 0
    v_mov_b64 v[54:55], 0
    v_mov_b64 v[56:57], 0
    v_mov_b64 v[58:59], 0
    v_mov_b64 v[60:61], 0
    v_mov_b64 v[62:63], 0
    v_mov_b64 v[64:65], 0
    v_mov_b64 v[66:67], 0
    v_mov_b64 v[68:69], 0
    v_mov_b64 v[70:71], 0
    v_mov_b64 v[72:73], 0
    v_mov_b64 v[74:75], 0
    v_mov_b64 v[76:77], 0
    v_mov_b64 v[78:79], 0
    v_mov_b64 v[80:81], 0
    v_mov_b64 v[82:83], 0
    v_mov_b64 v[84:85], 0
    v_mov_b64 v[86:87], 0
    v_mov_b64 v[88:89], 0
    v_mov_b64 v[90:91], 0
    v_mov_b64 v[92:93], 0
    v_mov_b64 v[94:95], 0
    v_mov_b64 v[208:209], 0
    v_mov_b64 v[210:211], 0
    v_mov_b64 v[212:213], 0
    v_mov_b64 v[214:215], 0
    v_mov_b64 v[216:217], 0
    v_mov_b64 v[218:219], 0
    v_mov_b64 v[220:221], 0
    v_mov_b64 v[222:223], 0
    v_mov_b64 v[224:225], 0
    v_mov_b64 v[226:227], 0
    v_mov_b64 v[228:229], 0
    v_mov_b64 v[230:231], 0
    s_mov_b32 s36, 4
    s_barrier
    ds_read_b128 v[96:99], v200 offset:0
    ds_read_b128 v[100:103], v200 offset:2048
    ds_read_b64_tr_b16 v[112:113], v192 offset:0
    ds_read_b64_tr_b16 v[114:115], v192 offset:1024
    ds_read_b64_tr_b16 v[116:117], v193 offset:0
    ds_read_b64_tr_b16 v[118:119], v193 offset:1024
    ds_read_b64_tr_b16 v[120:121], v194 offset:0
    ds_read_b64_tr_b16 v[122:123], v194 offset:1024
    ds_read_b64_tr_b16 v[124:125], v195 offset:0
    ds_read_b64_tr_b16 v[126:127], v195 offset:1024
    ds_read_b64_tr_b16 v[128:129], v196 offset:0
    ds_read_b64_tr_b16 v[130:131], v196 offset:1024
    ds_read_b64_tr_b16 v[132:133], v197 offset:0
    ds_read_b64_tr_b16 v[134:135], v197 offset:1024
    ds_read_b64_tr_b16 v[136:137], v198 offset:0
    ds_read_b64_tr_b16 v[138:139], v198 offset:1024
    ds_read_b64_tr_b16 v[140:141], v199 offset:0
    ds_read_b64_tr_b16 v[142:143], v199 offset:1024
    ds_read_b64_tr_b16 v[232:233], v202 offset:0
    ds_read_b64_tr_b16 v[234:235], v202 offset:1024
    ds_read_b64_tr_b16 v[236:237], v203 offset:0
    ds_read_b64_tr_b16 v[238:239], v203 offset:1024
L_mega_35:
    s_waitcnt lgkmcnt(8)
    v_mfma_f32_16x16x32_bf16 v[32:35], v[112:115], v[96:99], v[32:35]
    ds_read_b128 v[104:107], v201 offset:0
    v_mfma_f32_16x16x32_bf16 v[64:67], v[112:115], v[100:103], v[64:67]
    ds_read_b128 v[108:111], v201 offset:2048
    v_mfma_f32_16x16x32_bf16 v[36:39], v[116:119], v[96:99], v[36:39]
    ds_read_b64_tr_b16 v[144:145], v192 offset:8192
    v_mfma_f32_16x16x32_bf16 v[68:71], v[116:119], v[100:103], v[68:71]
    ds_read_b64_tr_b16 v[146:147], v192 offset:9216
    v_mfma_f32_16x16x32_bf16 v[40:43], v[120:123], v[96:99], v[40:43]
    ds_read_b64_tr_b16 v[148:149], v193 offset:8192
    v_mfma_f32_16x16x32_bf16 v[72:75], v[120:123], v[100:103], v[72:75]
    ds_read_b64_tr_b16 v[150:151], v193 offset:9216
    v_mfma_f32_16x16x32_bf16 v[44:47], v[124:127], v[96:99], v[44:47]
    ds_read_b64_tr_b16 v[152:153], v194 offset:8192
    v_mfma_f32_16x16x32_bf16 v[76:79], v[124:127], v[100:103], v[76:79]
    ds_read_b64_tr_b16 v[154:155], v194 offset:9216
    v_mfma_f32_16x16x32_bf16 v[48:51], v[128:131], v[96:99], v[48:51]
    ds_read_b64_tr_b16 v[156:157], v195 offset:8192
    v_mfma_f32_16x16x32_bf16 v[80:83], v[128:131], v[100:103], v[80:83]
    ds_read_b64_tr_b16 v[158:159], v195 offset:9216
    v_mfma_f32_16x16x32_bf16 v[52:55], v[132:135], v[96:99], v[52:55]
    ds_read_b64_tr_b16 v[160:161], v196 offset:8192
    v_mfma_f32_16x16x32_bf16 v[84:87], v[132:135], v[100:103], v[84:87]
    ds_read_b64_tr_b16 v[162:163], v196 offset:9216
    s_waitcnt lgkmcnt(12)
    v_mfma_f32_16x16x32_bf16 v[56:59], v[136:139], v[96:99], v[56:59]
    ds_read_b64_tr_b16 v[164:165], v197 offset:8192
    v_mfma_f32_16x16x32_bf16 v[88:91], v[136:139], v[100:103], v[88:91]
    ds_read_b64_tr_b16 v[166:167], v197 offset:9216
    v_mfma_f32_16x16x32_bf16 v[60:63], v[140:143], v[96:99], v[60:63]
    ds_read_b64_tr_b16 v[168:169], v198 offset:8192
    v_mfma_f32_16x16x32_bf16 v[92:95], v[140:143], v[100:103], v[92:95]
    ds_read_b64_tr_b16 v[170:171], v198 offset:9216
    v_mfma_f32_16x16x32_bf16 v[216:219], v[204:207], v[96:99], v[216:219]
    ds_read_b64_tr_b16 v[172:173], v199 offset:8192
    v_mfma_f32_16x16x32_bf16 v[224:227], v[96:99], v[96:99], v[224:227]
    ds_read_b64_tr_b16 v[174:175], v199 offset:9216
    v_mfma_f32_16x16x32_bf16 v[208:211], v[204:207], v[232:235], v[208:211]
    ds_read_b64_tr_b16 v[240:241], v202 offset:8192
    v_mfma_f32_16x16x32_bf16 v[220:223], v[204:207], v[100:103], v[220:223]
    ds_read_b64_tr_b16 v[242:243], v202 offset:9216
    v_mfma_f32_16x16x32_bf16 v[228:231], v[100:103], v[100:103], v[228:231]
    ds_read_b64_tr_b16 v[244:245], v203 offset:8192
    v_mfma_f32_16x16x32_bf16 v[212:215], v[204:207], v[236:239], v[212:215]
    ds_read_b64_tr_b16 v[246:247], v203 offset:9216
    s_waitcnt lgkmcnt(8)
    v_mfma_f32_16x16x32_bf16 v[32:35], v[144:147], v[104:107], v[32:35]
    v_mfma_f32_16x16x32_bf16 v[64:67], v[144:147], v[108:111], v[64:67]
    v_mfma_f32_16x16x32_bf16 v[36:39], v[148:151], v[104:107], v[36:39]
    v_mfma_f32_16x16x32_bf16 v[68:71], v[148:151], v[108:111], v[68:71]
    s_waitcnt lgkmcnt(0)
    s_barrier
    v_mfma_f32_16x16x32_bf16 v[40:43], v[152:155], v[104:107], v[40:43]
    ds_read_b128 v[96:99], v200 offset:32768
    ds_read_b128 v[100:103], v200 offset:34816
    v_mfma_f32_16x16x32_bf16 v[72:75], v[152:155], v[108:111], v[72:75]
    ds_read_b64_tr_b16 v[112:113], v192 offset:32768
    ds_read_b64_tr_b16 v[114:115], v192 offset:33792
    v_mfma_f32_16x16x32_bf16 v[44:47], v[156:159], v[104:107], v[44:47]
    ds_read_b64_tr_b16 v[116:117], v193 offset:32768
    ds_read_b64_tr_b16 v[118:119], v193 offset:33792
    v_mfma_f32_16x16x32_bf16 v[76:79], v[156:159], v[108:111], v[76:79]
    ds_read_b64_tr_b16 v[120:121], v194 offset:32768
    ds_read_b64_tr_b16 v[122:123], v194 offset:33792
    v_mfma_f32_16x16x32_bf16 v[48:51], v[160:163], v[104:107], v[48:51]
    ds_read_b64_tr_b16 v[124:125], v195 offset:32768
    v_mfma_f32_16x16x32_bf16 v[80:83], v[160:163], v[108:111], v[80:83]
    ds_read_b64_tr_b16 v[126:127], v195 offset:33792
    v_mfma_f32_16x16x32_bf16 v[52:55], v[164:167], v[104:107], v[52:55]
    ds_read_b64_tr_b16 v[128:129], v196 offset:32768
    v_mfma_f32_16x16x32_bf16 v[84:87], v[164:167], v[108:111], v[84:87]
    ds_read_b64_tr_b16 v[130:131], v196 offset:33792
    v_mfma_f32_16x16x32_bf16 v[56:59], v[168:171], v[104:107], v[56:59]
    ds_read_b64_tr_b16 v[132:133], v197 offset:32768
    v_mfma_f32_16x16x32_bf16 v[88:91], v[168:171], v[108:111], v[88:91]
    ds_read_b64_tr_b16 v[134:135], v197 offset:33792
    v_mfma_f32_16x16x32_bf16 v[60:63], v[172:175], v[104:107], v[60:63]
    ds_read_b64_tr_b16 v[136:137], v198 offset:32768
    v_mfma_f32_16x16x32_bf16 v[92:95], v[172:175], v[108:111], v[92:95]
    ds_read_b64_tr_b16 v[138:139], v198 offset:33792
    v_mfma_f32_16x16x32_bf16 v[216:219], v[204:207], v[104:107], v[216:219]
    ds_read_b64_tr_b16 v[140:141], v199 offset:32768
    v_mfma_f32_16x16x32_bf16 v[224:227], v[104:107], v[104:107], v[224:227]
    ds_read_b64_tr_b16 v[142:143], v199 offset:33792
    v_mfma_f32_16x16x32_bf16 v[208:211], v[204:207], v[240:243], v[208:211]
    ds_read_b64_tr_b16 v[232:233], v202 offset:32768
    v_mfma_f32_16x16x32_bf16 v[220:223], v[204:207], v[108:111], v[220:223]
    ds_read_b64_tr_b16 v[234:235], v202 offset:33792
    v_mfma_f32_16x16x32_bf16 v[228:231], v[108:111], v[108:111], v[228:231]
    ds_read_b64_tr_b16 v[236:237], v203 offset:32768
    v_mfma_f32_16x16x32_bf16 v[212:215], v[204:207], v[244:247], v[212:215]
    ds_read_b64_tr_b16 v[238:239], v203 offset:33792
    s_waitcnt lgkmcnt(8)
    v_mfma_f32_16x16x32_bf16 v[32:35], v[112:115], v[96:99], v[32:35]
    ds_read_b128 v[104:107], v201 offset:32768
    v_mfma_f32_16x16x32_bf16 v[64:67], v[112:115], v[100:103], v[64:67]
    ds_read_b128 v[108:111], v201 offset:34816
    v_mfma_f32_16x16x32_bf16 v[36:39], v[116:119], v[96:99], v[36:39]
    ds_read_b64_tr_b16 v[144:145], v192 offset:40960
    v_mfma_f32_16x16x32_bf16 v[68:71], v[116:119], v[100:103], v[68:71]
    ds_read_b64_tr_b16 v[146:147], v192 offset:41984
    v_mfma_f32_16x16x32_bf16 v[40:43], v[120:123], v[96:99], v[40:43]
    ds_read_b64_tr_b16 v[148:149], v193 offset:40960
    v_mfma_f32_16x16x32_bf16 v[72:75], v[120:123], v[100:103], v[72:75]
    ds_read_b64_tr_b16 v[150:151], v193 offset:41984
    v_mfma_f32_16x16x32_bf16 v[44:47], v[124:127], v[96:99], v[44:47]
    ds_read_b64_tr_b16 v[152:153], v194 offset:40960
    v_mfma_f32_16x16x32_bf16 v[76:79], v[124:127], v[100:103], v[76:79]
    ds_read_b64_tr_b16 v[154:155], v194 offset:41984
    v_mfma_f32_16x16x32_bf16 v[48:51], v[128:131], v[96:99], v[48:51]
    ds_read_b64_tr_b16 v[156:157], v195 offset:40960
    v_mfma_f32_16x16x32_bf16 v[80:83], v[128:131], v[100:103], v[80:83]
    ds_read_b64_tr_b16 v[158:159], v195 offset:41984
    v_mfma_f32_16x16x32_bf16 v[52:55], v[132:135], v[96:99], v[52:55]
    ds_read_b64_tr_b16 v[160:161], v196 offset:40960
    v_mfma_f32_16x16x32_bf16 v[84:87], v[132:135], v[100:103], v[84:87]
    ds_read_b64_tr_b16 v[162:163], v196 offset:41984
    s_waitcnt lgkmcnt(12)
    v_mfma_f32_16x16x32_bf16 v[56:59], v[136:139], v[96:99], v[56:59]
    ds_read_b64_tr_b16 v[164:165], v197 offset:40960
    v_mfma_f32_16x16x32_bf16 v[88:91], v[136:139], v[100:103], v[88:91]
    ds_read_b64_tr_b16 v[166:167], v197 offset:41984
    v_mfma_f32_16x16x32_bf16 v[60:63], v[140:143], v[96:99], v[60:63]
    ds_read_b64_tr_b16 v[168:169], v198 offset:40960
    v_mfma_f32_16x16x32_bf16 v[92:95], v[140:143], v[100:103], v[92:95]
    ds_read_b64_tr_b16 v[170:171], v198 offset:41984
    v_mfma_f32_16x16x32_bf16 v[216:219], v[204:207], v[96:99], v[216:219]
    ds_read_b64_tr_b16 v[172:173], v199 offset:40960
    v_mfma_f32_16x16x32_bf16 v[224:227], v[96:99], v[96:99], v[224:227]
    ds_read_b64_tr_b16 v[174:175], v199 offset:41984
    v_mfma_f32_16x16x32_bf16 v[208:211], v[204:207], v[232:235], v[208:211]
    ds_read_b64_tr_b16 v[240:241], v202 offset:40960
    v_mfma_f32_16x16x32_bf16 v[220:223], v[204:207], v[100:103], v[220:223]
    ds_read_b64_tr_b16 v[242:243], v202 offset:41984
    v_mfma_f32_16x16x32_bf16 v[228:231], v[100:103], v[100:103], v[228:231]
    ds_read_b64_tr_b16 v[244:245], v203 offset:40960
    v_mfma_f32_16x16x32_bf16 v[212:215], v[204:207], v[236:239], v[212:215]
    ds_read_b64_tr_b16 v[246:247], v203 offset:41984
    v_xor_b32 v192, 0x10000, v192
    v_xor_b32 v193, 0x10000, v193
    v_xor_b32 v194, 0x10000, v194
    v_xor_b32 v195, 0x10000, v195
    v_xor_b32 v196, 0x10000, v196
    v_xor_b32 v197, 0x10000, v197
    v_xor_b32 v198, 0x10000, v198
    v_xor_b32 v199, 0x10000, v199
    v_xor_b32 v200, 0x10000, v200
    v_xor_b32 v201, 0x10000, v201
    v_xor_b32 v202, 0x10000, v202
    v_xor_b32 v203, 0x10000, v203
    s_sub_u32 s36, s36, 1
    s_cmp_lg_u32 s36, 0
    s_waitcnt lgkmcnt(8)
    v_mfma_f32_16x16x32_bf16 v[32:35], v[144:147], v[104:107], v[32:35]
    v_mfma_f32_16x16x32_bf16 v[64:67], v[144:147], v[108:111], v[64:67]
    v_mfma_f32_16x16x32_bf16 v[36:39], v[148:151], v[104:107], v[36:39]
    v_mfma_f32_16x16x32_bf16 v[68:71], v[148:151], v[108:111], v[68:71]
    s_waitcnt lgkmcnt(0)
    s_barrier
    v_mfma_f32_16x16x32_bf16 v[40:43], v[152:155], v[104:107], v[40:43]
    ds_read_b128 v[96:99], v200 offset:0
    ds_read_b128 v[100:103], v200 offset:2048
    v_mfma_f32_16x16x32_bf16 v[72:75], v[152:155], v[108:111], v[72:75]
    ds_read_b64_tr_b16 v[112:113], v192 offset:0
    ds_read_b64_tr_b16 v[114:115], v192 offset:1024
    v_mfma_f32_16x16x32_bf16 v[44:47], v[156:159], v[104:107], v[44:47]
    ds_read_b64_tr_b16 v[116:117], v193 offset:0
    ds_read_b64_tr_b16 v[118:119], v193 offset:1024
    v_mfma_f32_16x16x32_bf16 v[76:79], v[156:159], v[108:111], v[76:79]
    ds_read_b64_tr_b16 v[120:121], v194 offset:0
    ds_read_b64_tr_b16 v[122:123], v194 offset:1024
    v_mfma_f32_16x16x32_bf16 v[48:51], v[160:163], v[104:107], v[48:51]
    ds_read_b64_tr_b16 v[124:125], v195 offset:0
    v_mfma_f32_16x16x32_bf16 v[80:83], v[160:163], v[108:111], v[80:83]
    ds_read_b64_tr_b16 v[126:127], v195 offset:1024
    v_mfma_f32_16x16x32_bf16 v[52:55], v[164:167], v[104:107], v[52:55]
    ds_read_b64_tr_b16 v[128:129], v196 offset:0
    v_mfma_f32_16x16x32_bf16 v[84:87], v[164:167], v[108:111], v[84:87]
    ds_read_b64_tr_b16 v[130:131], v196 offset:1024
    v_mfma_f32_16x16x32_bf16 v[56:59], v[168:171], v[104:107], v[56:59]
    ds_read_b64_tr_b16 v[132:133], v197 offset:0
    v_mfma_f32_16x16x32_bf16 v[88:91], v[168:171], v[108:111], v[88:91]
    ds_read_b64_tr_b16 v[134:135], v197 offset:1024
    v_mfma_f32_16x16x32_bf16 v[60:63], v[172:175], v[104:107], v[60:63]
    ds_read_b64_tr_b16 v[136:137], v198 offset:0
    v_mfma_f32_16x16x32_bf16 v[92:95], v[172:175], v[108:111], v[92:95]
    ds_read_b64_tr_b16 v[138:139], v198 offset:1024
    v_mfma_f32_16x16x32_bf16 v[216:219], v[204:207], v[104:107], v[216:219]
    ds_read_b64_tr_b16 v[140:141], v199 offset:0
    v_mfma_f32_16x16x32_bf16 v[224:227], v[104:107], v[104:107], v[224:227]
    ds_read_b64_tr_b16 v[142:143], v199 offset:1024
    v_mfma_f32_16x16x32_bf16 v[208:211], v[204:207], v[240:243], v[208:211]
    ds_read_b64_tr_b16 v[232:233], v202 offset:0
    v_mfma_f32_16x16x32_bf16 v[220:223], v[204:207], v[108:111], v[220:223]
    ds_read_b64_tr_b16 v[234:235], v202 offset:1024
    v_mfma_f32_16x16x32_bf16 v[228:231], v[108:111], v[108:111], v[228:231]
    ds_read_b64_tr_b16 v[236:237], v203 offset:0
    v_mfma_f32_16x16x32_bf16 v[212:215], v[204:207], v[244:247], v[212:215]
    ds_read_b64_tr_b16 v[238:239], v203 offset:1024
    s_cbranch_scc1 L_mega_35
    s_waitcnt lgkmcnt(8)
    v_mfma_f32_16x16x32_bf16 v[32:35], v[112:115], v[96:99], v[32:35]
    ds_read_b128 v[104:107], v201 offset:0
    v_mfma_f32_16x16x32_bf16 v[64:67], v[112:115], v[100:103], v[64:67]
    ds_read_b128 v[108:111], v201 offset:2048
    v_mfma_f32_16x16x32_bf16 v[36:39], v[116:119], v[96:99], v[36:39]
    ds_read_b64_tr_b16 v[144:145], v192 offset:8192
    v_mfma_f32_16x16x32_bf16 v[68:71], v[116:119], v[100:103], v[68:71]
    ds_read_b64_tr_b16 v[146:147], v192 offset:9216
    v_mfma_f32_16x16x32_bf16 v[40:43], v[120:123], v[96:99], v[40:43]
    ds_read_b64_tr_b16 v[148:149], v193 offset:8192
    v_mfma_f32_16x16x32_bf16 v[72:75], v[120:123], v[100:103], v[72:75]
    ds_read_b64_tr_b16 v[150:151], v193 offset:9216
    v_mfma_f32_16x16x32_bf16 v[44:47], v[124:127], v[96:99], v[44:47]
    ds_read_b64_tr_b16 v[152:153], v194 offset:8192
    v_mfma_f32_16x16x32_bf16 v[76:79], v[124:127], v[100:103], v[76:79]
    ds_read_b64_tr_b16 v[154:155], v194 offset:9216
    v_mfma_f32_16x16x32_bf16 v[48:51], v[128:131], v[96:99], v[48:51]
    ds_read_b64_tr_b16 v[156:157], v195 offset:8192
    v_mfma_f32_16x16x32_bf16 v[80:83], v[128:131], v[100:103], v[80:83]
    ds_read_b64_tr_b16 v[158:159], v195 offset:9216
    v_mfma_f32_16x16x32_bf16 v[52:55], v[132:135], v[96:99], v[52:55]
    ds_read_b64_tr_b16 v[160:161], v196 offset:8192
    v_mfma_f32_16x16x32_bf16 v[84:87], v[132:135], v[100:103], v[84:87]
    ds_read_b64_tr_b16 v[162:163], v196 offset:9216
    s_waitcnt lgkmcnt(12)
    v_mfma_f32_16x16x32_bf16 v[56:59], v[136:139], v[96:99], v[56:59]
    ds_read_b64_tr_b16 v[164:165], v197 offset:8192
    v_mfma_f32_16x16x32_bf16 v[88:91], v[136:139], v[100:103], v[88:91]
    ds_read_b64_tr_b16 v[166:167], v197 offset:9216
    v_mfma_f32_16x16x32_bf16 v[60:63], v[140:143], v[96:99], v[60:63]
    ds_read_b64_tr_b16 v[168:169], v198 offset:8192
    v_mfma_f32_16x16x32_bf16 v[92:95], v[140:143], v[100:103], v[92:95]
    ds_read_b64_tr_b16 v[170:171], v198 offset:9216
    v_mfma_f32_16x16x32_bf16 v[216:219], v[204:207], v[96:99], v[216:219]
    ds_read_b64_tr_b16 v[172:173], v199 offset:8192
    v_mfma_f32_16x16x32_bf16 v[224:227], v[96:99], v[96:99], v[224:227]
    ds_read_b64_tr_b16 v[174:175], v199 offset:9216
    v_mfma_f32_16x16x32_bf16 v[208:211], v[204:207], v[232:235], v[208:211]
    ds_read_b64_tr_b16 v[240:241], v202 offset:8192
    v_mfma_f32_16x16x32_bf16 v[220:223], v[204:207], v[100:103], v[220:223]
    ds_read_b64_tr_b16 v[242:243], v202 offset:9216
    v_mfma_f32_16x16x32_bf16 v[228:231], v[100:103], v[100:103], v[228:231]
    ds_read_b64_tr_b16 v[244:245], v203 offset:8192
    v_mfma_f32_16x16x32_bf16 v[212:215], v[204:207], v[236:239], v[212:215]
    ds_read_b64_tr_b16 v[246:247], v203 offset:9216
    s_waitcnt lgkmcnt(8)
    v_mfma_f32_16x16x32_bf16 v[32:35], v[144:147], v[104:107], v[32:35]
    v_mfma_f32_16x16x32_bf16 v[64:67], v[144:147], v[108:111], v[64:67]
    v_mfma_f32_16x16x32_bf16 v[36:39], v[148:151], v[104:107], v[36:39]
    v_mfma_f32_16x16x32_bf16 v[68:71], v[148:151], v[108:111], v[68:71]
    s_waitcnt lgkmcnt(0)
    s_barrier
    v_mfma_f32_16x16x32_bf16 v[40:43], v[152:155], v[104:107], v[40:43]
    ds_read_b128 v[96:99], v200 offset:32768
    ds_read_b128 v[100:103], v200 offset:34816
    v_mfma_f32_16x16x32_bf16 v[72:75], v[152:155], v[108:111], v[72:75]
    ds_read_b64_tr_b16 v[112:113], v192 offset:32768
    ds_read_b64_tr_b16 v[114:115], v192 offset:33792
    v_mfma_f32_16x16x32_bf16 v[44:47], v[156:159], v[104:107], v[44:47]
    ds_read_b64_tr_b16 v[116:117], v193 offset:32768
    ds_read_b64_tr_b16 v[118:119], v193 offset:33792
    v_mfma_f32_16x16x32_bf16 v[76:79], v[156:159], v[108:111], v[76:79]
    ds_read_b64_tr_b16 v[120:121], v194 offset:32768
    ds_read_b64_tr_b16 v[122:123], v194 offset:33792
    v_mfma_f32_16x16x32_bf16 v[48:51], v[160:163], v[104:107], v[48:51]
    ds_read_b64_tr_b16 v[124:125], v195 offset:32768
    v_mfma_f32_16x16x32_bf16 v[80:83], v[160:163], v[108:111], v[80:83]
    ds_read_b64_tr_b16 v[126:127], v195 offset:33792
    v_mfma_f32_16x16x32_bf16 v[52:55], v[164:167], v[104:107], v[52:55]
    ds_read_b64_tr_b16 v[128:129], v196 offset:32768
    v_mfma_f32_16x16x32_bf16 v[84:87], v[164:167], v[108:111], v[84:87]
    ds_read_b64_tr_b16 v[130:131], v196 offset:33792
    v_mfma_f32_16x16x32_bf16 v[56:59], v[168:171], v[104:107], v[56:59]
    ds_read_b64_tr_b16 v[132:133], v197 offset:32768
    v_mfma_f32_16x16x32_bf16 v[88:91], v[168:171], v[108:111], v[88:91]
    ds_read_b64_tr_b16 v[134:135], v197 offset:33792
    v_mfma_f32_16x16x32_bf16 v[60:63], v[172:175], v[104:107], v[60:63]
    ds_read_b64_tr_b16 v[136:137], v198 offset:32768
    v_mfma_f32_16x16x32_bf16 v[92:95], v[172:175], v[108:111], v[92:95]
    ds_read_b64_tr_b16 v[138:139], v198 offset:33792
    v_mfma_f32_16x16x32_bf16 v[216:219], v[204:207], v[104:107], v[216:219]
    ds_read_b64_tr_b16 v[140:141], v199 offset:32768
    v_mfma_f32_16x16x32_bf16 v[224:227], v[104:107], v[104:107], v[224:227]
    ds_read_b64_tr_b16 v[142:143], v199 offset:33792
    v_mfma_f32_16x16x32_bf16 v[208:211], v[204:207], v[240:243], v[208:211]
    ds_read_b64_tr_b16 v[232:233], v202 offset:32768
    v_mfma_f32_16x16x32_bf16 v[220:223], v[204:207], v[108:111], v[220:223]
    ds_read_b64_tr_b16 v[234:235], v202 offset:33792
    v_mfma_f32_16x16x32_bf16 v[228:231], v[108:111], v[108:111], v[228:231]
    ds_read_b64_tr_b16 v[236:237], v203 offset:32768
    v_mfma_f32_16x16x32_bf16 v[212:215], v[204:207], v[244:247], v[212:215]
    ds_read_b64_tr_b16 v[238:239], v203 offset:33792
    s_waitcnt lgkmcnt(8)
    v_mfma_f32_16x16x32_bf16 v[32:35], v[112:115], v[96:99], v[32:35]
    ds_read_b128 v[104:107], v201 offset:32768
    v_mfma_f32_16x16x32_bf16 v[64:67], v[112:115], v[100:103], v[64:67]
    ds_read_b128 v[108:111], v201 offset:34816
    v_mfma_f32_16x16x32_bf16 v[36:39], v[116:119], v[96:99], v[36:39]
    ds_read_b64_tr_b16 v[144:145], v192 offset:40960
    v_mfma_f32_16x16x32_bf16 v[68:71], v[116:119], v[100:103], v[68:71]
    ds_read_b64_tr_b16 v[146:147], v192 offset:41984
    v_mfma_f32_16x16x32_bf16 v[40:43], v[120:123], v[96:99], v[40:43]
    ds_read_b64_tr_b16 v[148:149], v193 offset:40960
    v_mfma_f32_16x16x32_bf16 v[72:75], v[120:123], v[100:103], v[72:75]
    ds_read_b64_tr_b16 v[150:151], v193 offset:41984
    v_mfma_f32_16x16x32_bf16 v[44:47], v[124:127], v[96:99], v[44:47]
    ds_read_b64_tr_b16 v[152:153], v194 offset:40960
    v_mfma_f32_16x16x32_bf16 v[76:79], v[124:127], v[100:103], v[76:79]
    ds_read_b64_tr_b16 v[154:155], v194 offset:41984
    v_mfma_f32_16x16x32_bf16 v[48:51], v[128:131], v[96:99], v[48:51]
    ds_read_b64_tr_b16 v[156:157], v195 offset:40960
    v_mfma_f32_16x16x32_bf16 v[80:83], v[128:131], v[100:103], v[80:83]
    ds_read_b64_tr_b16 v[158:159], v195 offset:41984
    v_mfma_f32_16x16x32_bf16 v[52:55], v[132:135], v[96:99], v[52:55]
    ds_read_b64_tr_b16 v[160:161], v196 offset:40960
    v_mfma_f32_16x16x32_bf16 v[84:87], v[132:135], v[100:103], v[84:87]
    ds_read_b64_tr_b16 v[162:163], v196 offset:41984
    s_waitcnt lgkmcnt(12)
    v_mfma_f32_16x16x32_bf16 v[56:59], v[136:139], v[96:99], v[56:59]
    ds_read_b64_tr_b16 v[164:165], v197 offset:40960
    v_mfma_f32_16x16x32_bf16 v[88:91], v[136:139], v[100:103], v[88:91]
    ds_read_b64_tr_b16 v[166:167], v197 offset:41984
    v_mfma_f32_16x16x32_bf16 v[60:63], v[140:143], v[96:99], v[60:63]
    ds_read_b64_tr_b16 v[168:169], v198 offset:40960
    v_mfma_f32_16x16x32_bf16 v[92:95], v[140:143], v[100:103], v[92:95]
    ds_read_b64_tr_b16 v[170:171], v198 offset:41984
    v_mfma_f32_16x16x32_bf16 v[216:219], v[204:207], v[96:99], v[216:219]
    ds_read_b64_tr_b16 v[172:173], v199 offset:40960
    v_mfma_f32_16x16x32_bf16 v[224:227], v[96:99], v[96:99], v[224:227]
    ds_read_b64_tr_b16 v[174:175], v199 offset:41984
    v_mfma_f32_16x16x32_bf16 v[208:211], v[204:207], v[232:235], v[208:211]
    ds_read_b64_tr_b16 v[240:241], v202 offset:40960
    v_mfma_f32_16x16x32_bf16 v[220:223], v[204:207], v[100:103], v[220:223]
    ds_read_b64_tr_b16 v[242:243], v202 offset:41984
    v_mfma_f32_16x16x32_bf16 v[228:231], v[100:103], v[100:103], v[228:231]
    ds_read_b64_tr_b16 v[244:245], v203 offset:40960
    v_mfma_f32_16x16x32_bf16 v[212:215], v[204:207], v[236:239], v[212:215]
    ds_read_b64_tr_b16 v[246:247], v203 offset:41984
    s_waitcnt lgkmcnt(8)
    v_mfma_f32_16x16x32_bf16 v[32:35], v[144:147], v[104:107], v[32:35]
    v_mfma_f32_16x16x32_bf16 v[64:67], v[144:147], v[108:111], v[64:67]
    v_mfma_f32_16x16x32_bf16 v[36:39], v[148:151], v[104:107], v[36:39]
    v_mfma_f32_16x16x32_bf16 v[68:71], v[148:151], v[108:111], v[68:71]
    v_mfma_f32_16x16x32_bf16 v[40:43], v[152:155], v[104:107], v[40:43]
    v_mfma_f32_16x16x32_bf16 v[72:75], v[152:155], v[108:111], v[72:75]
    v_mfma_f32_16x16x32_bf16 v[44:47], v[156:159], v[104:107], v[44:47]
    v_mfma_f32_16x16x32_bf16 v[76:79], v[156:159], v[108:111], v[76:79]
    v_mfma_f32_16x16x32_bf16 v[48:51], v[160:163], v[104:107], v[48:51]
    v_mfma_f32_16x16x32_bf16 v[80:83], v[160:163], v[108:111], v[80:83]
    v_mfma_f32_16x16x32_bf16 v[52:55], v[164:167], v[104:107], v[52:55]
    v_mfma_f32_16x16x32_bf16 v[84:87], v[164:167], v[108:111], v[84:87]
    s_waitcnt lgkmcnt(0)
    v_mfma_f32_16x16x32_bf16 v[56:59], v[168:171], v[104:107], v[56:59]
    v_mfma_f32_16x16x32_bf16 v[88:91], v[168:171], v[108:111], v[88:91]
    v_mfma_f32_16x16x32_bf16 v[60:63], v[172:175], v[104:107], v[60:63]
    v_mfma_f32_16x16x32_bf16 v[92:95], v[172:175], v[108:111], v[92:95]
    v_mfma_f32_16x16x32_bf16 v[216:219], v[204:207], v[104:107], v[216:219]
    v_mfma_f32_16x16x32_bf16 v[224:227], v[104:107], v[104:107], v[224:227]
    v_mfma_f32_16x16x32_bf16 v[208:211], v[204:207], v[240:243], v[208:211]
    v_mfma_f32_16x16x32_bf16 v[220:223], v[204:207], v[108:111], v[220:223]
    v_mfma_f32_16x16x32_bf16 v[228:231], v[108:111], v[108:111], v[228:231]
    v_mfma_f32_16x16x32_bf16 v[212:215], v[204:207], v[244:247], v[212:215]
    s_lshl_b32 s28, s12, 10
    s_add_u32 s28, s28, 143360
    v_lshl_add_u32 v4, v1, 3, s28
    v_mov_b32 v5, 0x23000
    v_lshl_add_u32 v5, v1, 3, v5
    v_lshrrev_b32 v6, 2, v7
    v_and_b32 v27, 3, v7
    v_cmp_eq_u32 s[56:57], v6, v8
    v_cmp_eq_u32 s[58:59], 0, v8
    s_nop 1
    v_cndmask_b32 v208, 0, v208, s[58:59]
    v_cvt_pk_bf16_f32 v209, v208, v208
    v_and_b32 v209, 0xffff0000, v209
    v_sub_f32 v209, v208, v209
    v_cvt_pk_bf16_f32 v210, v208, v209
    v_cvt_pk_bf16_f32 v211, v208, v209
    ds_write_b64 v4, v[210:211] offset:0
    v_cndmask_b32 v212, 0, v212, s[58:59]
    v_cvt_pk_bf16_f32 v213, v212, v212
    v_and_b32 v213, 0xffff0000, v213
    v_sub_f32 v213, v212, v213
    v_cvt_pk_bf16_f32 v214, v212, v213
    v_cvt_pk_bf16_f32 v215, v212, v213
    ds_write_b64 v4, v[214:215] offset:512
    v_cmp_eq_u32 vcc, 1, v27
    s_nop 1
    v_cndmask_b32 v224, v224, v225, vcc
    v_cmp_eq_u32 vcc, 2, v27
    s_nop 1
    v_cndmask_b32 v224, v224, v226, vcc
    v_cmp_eq_u32 vcc, 3, v27
    s_nop 1
    v_cndmask_b32 v224, v224, v227, vcc
    v_cndmask_b32 v248, 0, v216, s[58:59]
    v_cndmask_b32 v249, 0, v224, s[56:57]
    v_mov_b64 v[250:251], 0
    v_cmp_eq_u32 vcc, 1, v27
    s_nop 1
    v_cndmask_b32 v228, v228, v229, vcc
    v_cmp_eq_u32 vcc, 2, v27
    s_nop 1
    v_cndmask_b32 v228, v228, v230, vcc
    v_cmp_eq_u32 vcc, 3, v27
    s_nop 1
    v_cndmask_b32 v228, v228, v231, vcc
    v_cndmask_b32 v252, 0, v220, s[58:59]
    v_cndmask_b32 v253, 0, v228, s[56:57]
    v_mov_b64 v[254:255], 0
    s_waitcnt lgkmcnt(0)
    s_barrier
    ds_read_b64 v[216:217], v5 offset:0
    ds_read_b64 v[218:219], v5 offset:512
    ds_read_b64 v[220:221], v5 offset:1024
    ds_read_b64 v[222:223], v5 offset:1536
    ds_read_b64 v[224:225], v5 offset:2048
    ds_read_b64 v[226:227], v5 offset:2560
    ds_read_b64 v[228:229], v5 offset:3072
    ds_read_b64 v[230:231], v5 offset:3584
    v_lshlrev_b32 v198, 5, v1
    s_cmp_lg_u32 s12, 3
    s_cbranch_scc1 L_mega_36
    s_mov_b64 exec, 0xff
    buffer_load_dword v199, v198, s[76:79], 0 offen sc1
    s_mov_b64 exec, -1
L_mega_36:
    v_add_f32 v248, v248, v250
    v_add_f32 v249, v249, v251
    v_add_f32 v252, v252, v254
    v_add_f32 v253, v253, v255
    v_mov_b32 v250, v248
    v_mov_b32 v251, v249
    v_mov_b32 v254, v252
    v_mov_b32 v255, v253
    s_nop 1
    v_permlane32_swap_b32 v248, v250
    v_permlane32_swap_b32 v249, v251
    v_permlane32_swap_b32 v252, v254
    v_permlane32_swap_b32 v253, v255
    s_nop 0
    v_add_f32 v248, v248, v250
    v_add_f32 v249, v249, v251
    v_add_f32 v252, v252, v254
    v_add_f32 v253, v253, v255
    v_mov_b32 v250, v248
    v_mov_b32 v251, v249
    v_mov_b32 v254, v252
    v_mov_b32 v255, v253
    s_nop 1
    v_permlane16_swap_b32 v248, v250
    v_permlane16_swap_b32 v249, v251
    v_permlane16_swap_b32 v252, v254
    v_permlane16_swap_b32 v253, v255
    s_nop 0
    v_add_f32 v248, v248, v250
    v_add_f32 v249, v249, v251
    v_add_f32 v252, v252, v254
    v_add_f32 v253, v253, v255
    v_mul_f32 v248, 0xbacccccd, v248
    v_mul_f32 v249, 0x3acccccd, v249
    v_cvt_pk_bf16_f32 v250, v248, v248
    v_fma_f32 v249, -v248, v248, v249
    v_and_b32 v251, 0xffff0000, v250
    v_max_f32 v249, 0, v249
    v_sub_f32 v251, v248, v251
    v_add_f32 v249, 0x3727c5ac, v249
    v_cvt_pk_bf16_f32 v251, v251, v251
    v_rsq_f32 v10, v249
    v_mul_f32 v252, 0xbacccccd, v252
    v_mul_f32 v253, 0x3acccccd, v253
    v_cvt_pk_bf16_f32 v254, v252, v252
    v_fma_f32 v253, -v252, v252, v253
    v_and_b32 v255, 0xffff0000, v254
    v_max_f32 v253, 0, v253
    v_sub_f32 v255, v252, v255
    v_add_f32 v253, 0x3727c5ac, v253
    v_cvt_pk_bf16_f32 v255, v255, v255
    v_rsq_f32 v11, v253
    s_nop 0
    v_mul_f32 v10, 0x3f1166db, v10
    v_mul_f32 v11, 0x3f1166db, v11
    s_waitcnt lgkmcnt(0)
    s_branch L_join_qk
L_raw_v:
    v_and_b32 v4, 3, v1
    v_bfe_u32 v5, v1, 2, 2
    v_lshlrev_b32 v6, 1, v5
    v_and_b32 v27, 1, v8
    v_lshl_add_u32 v6, v27, 3, v6
    v_lshl_add_u32 v5, v8, 3, v5
    v_lshlrev_b32 v5, 8, v5
    v_add_u32 v5, 0x4000, v5
    v_lshlrev_b32 v27, 3, v4
    v_add_u32 v30, 0, v27
    v_lshrrev_b32 v31, 4, v30
    v_xor_b32 v31, v31, v6
    v_and_b32 v30, 8, v30
    v_lshl_add_u32 v30, v31, 4, v30
    v_add_u32 v192, v30, v5
    v_add_u32 v30, 32, v27
    v_lshrrev_b32 v31, 4, v30
    v_xor_b32 v31, v31, v6
    v_and_b32 v30, 8, v30
    v_lshl_add_u32 v30, v31, 4, v30
    v_add_u32 v193, v30, v5
    v_add_u32 v30, 64, v27
    v_lshrrev_b32 v31, 4, v30
    v_xor_b32 v31, v31, v6
    v_and_b32 v30, 8, v30
    v_lshl_add_u32 v30, v31, 4, v30
    v_add_u32 v194, v30, v5
    v_add_u32 v30, 96, v27
    v_lshrrev_b32 v31, 4, v30
    v_xor_b32 v31, v31, v6
    v_and_b32 v30, 8, v30
    v_lshl_add_u32 v30, v31, 4, v30
    v_add_u32 v195, v30, v5
    v_add_u32 v30, 128, v27
    v_lshrrev_b32 v31, 4, v30
    v_xor_b32 v31, v31, v6
    v_and_b32 v30, 8, v30
    v_lshl_add_u32 v30, v31, 4, v30
    v_add_u32 v196, v30, v5
    v_add_u32 v30, 160, v27
    v_lshrrev_b32 v31, 4, v30
    v_xor_b32 v31, v31, v6
    v_and_b32 v30, 8, v30
    v_lshl_add_u32 v30, v31, 4, v30
    v_add_u32 v197, v30, v5
    v_add_u32 v30, 192, v27
    v_lshrrev_b32 v31, 4, v30
    v_xor_b32 v31, v31, v6
    v_and_b32 v30, 8, v30
    v_lshl_add_u32 v30, v31, 4, v30
    v_add_u32 v198, v30, v5
    v_add_u32 v30, 224, v27
    v_lshrrev_b32 v31, 4, v30
    v_xor_b32 v31, v31, v6
    v_and_b32 v30, 8, v30
    v_lshl_add_u32 v30, v31, 4, v30
    v_add_u32 v199, v30, v5
    v_mov_b32 v202, v192
    s_cmp_eq_u32 s12, 1
    s_cselect_b64 vcc, -1, 0
    v_cndmask_b32 v202, v202, v194, vcc
    s_cmp_eq_u32 s12, 2
    s_cselect_b64 vcc, -1, 0
    v_cndmask_b32 v202, v202, v196, vcc
    s_cmp_eq_u32 s12, 3
    s_cselect_b64 vcc, -1, 0
    v_cndmask_b32 v202, v202, v198, vcc
    v_mov_b32 v203, v193
    s_cmp_eq_u32 s12, 1
    s_cselect_b64 vcc, -1, 0
    v_cndmask_b32 v203, v203, v195, vcc
    s_cmp_eq_u32 s12, 2
    s_cselect_b64 vcc, -1, 0
    v_cndmask_b32 v203, v203, v197, vcc
    s_cmp_eq_u32 s12, 3
    s_cselect_b64 vcc, -1, 0
    v_cndmask_b32 v203, v203, v199, vcc
    v_lshrrev_b32 v4, 1, v7
    v_xor_b32 v4, v4, v8
    v_lshlrev_b32 v4, 4, v4
    v_lshl_add_u32 v4, v7, 7, v4
    s_lshl_b32 s28, s12, 12
    v_add_u32 v200, s28, v4
    v_xor_b32 v201, 64, v200
    v_mov_b32 v204, 0x3f803f80
    v_mov_b32 v205, 0x3f803f80
    v_mov_b32 v206, 0x3f803f80
    v_mov_b32 v207, 0x3f803f80
    v_mov_b64 v[32:33], 0
    v_mov_b64 v[34:35], 0
    v_mov_b64 v[36:37], 0
    v_mov_b64 v[38:39], 0
    v_mov_b64 v[40:41], 0
    v_mov_b64 v[42:43], 0
    v_mov_b64 v[44:45], 0
    v_mov_b64 v[46:47], 0
    v_mov_b64 v[48:49], 0
    v_mov_b64 v[50:51], 0
    v_mov_b64 v[52:53], 0
    v_mov_b64 v[54:55], 0
    v_mov_b64 v[56:57], 0
    v_mov_b64 v[58:59], 0
    v_mov_b64 v[60:61], 0
    v_mov_b64 v[62:63], 0
    v_mov_b64 v[64:65], 0
    v_mov_b64 v[66:67], 0
    v_mov_b64 v[68:69], 0
    v_mov_b64 v[70:71], 0
    v_mov_b64 v[72:73], 0
    v_mov_b64 v[74:75], 0
    v_mov_b64 v[76:77], 0
    v_mov_b64 v[78:79], 0
    v_mov_b64 v[80:81], 0
    v_mov_b64 v[82:83], 0
    v_mov_b64 v[84:85], 0
    v_mov_b64 v[86:87], 0
    v_mov_b64 v[88:89], 0
    v_mov_b64 v[90:91], 0
    v_mov_b64 v[92:93], 0
    v_mov_b64 v[94:95], 0
    v_mov_b64 v[208:209], 0
    v_mov_b64 v[210:211], 0
    v_mov_b64 v[212:213], 0
    v_mov_b64 v[214:215], 0
    v_mov_b64 v[216:217], 0
    v_mov_b64 v[218:219], 0
    v_mov_b64 v[220:221], 0
    v_mov_b64 v[222:223], 0
    v_mov_b64 v[224:225], 0
    v_mov_b64 v[226:227], 0
    v_mov_b64 v[228:229], 0
    v_mov_b64 v[230:231], 0
    s_mov_b32 s36, 4
    s_barrier
    ds_read_b128 v[96:99], v200 offset:0
    ds_read_b128 v[100:103], v200 offset:2048
    ds_read_b64_tr_b16 v[112:113], v192 offset:0
    ds_read_b64_tr_b16 v[114:115], v192 offset:1024
    ds_read_b64_tr_b16 v[116:117], v193 offset:0
    ds_read_b64_tr_b16 v[118:119], v193 offset:1024
    ds_read_b64_tr_b16 v[120:121], v194 offset:0
    ds_read_b64_tr_b16 v[122:123], v194 offset:1024
    ds_read_b64_tr_b16 v[124:125], v195 offset:0
    ds_read_b64_tr_b16 v[126:127], v195 offset:1024
    ds_read_b64_tr_b16 v[128:129], v196 offset:0
    ds_read_b64_tr_b16 v[130:131], v196 offset:1024
    ds_read_b64_tr_b16 v[132:133], v197 offset:0
    ds_read_b64_tr_b16 v[134:135], v197 offset:1024
    ds_read_b64_tr_b16 v[136:137], v198 offset:0
    ds_read_b64_tr_b16 v[138:139], v198 offset:1024
    ds_read_b64_tr_b16 v[140:141], v199 offset:0
    ds_read_b64_tr_b16 v[142:143], v199 offset:1024
    ds_read_b64_tr_b16 v[232:233], v202 offset:0
    ds_read_b64_tr_b16 v[234:235], v202 offset:1024
    ds_read_b64_tr_b16 v[236:237], v203 offset:0
    ds_read_b64_tr_b16 v[238:239], v203 offset:1024
L_mega_37:
    s_waitcnt lgkmcnt(8)
    v_mfma_f32_16x16x32_bf16 v[32:35], v[96:99], v[112:115], v[32:35]
    ds_read_b128 v[104:107], v201 offset:0
    v_mfma_f32_16x16x32_bf16 v[64:67], v[100:103], v[112:115], v[64:67]
    ds_read_b128 v[108:111], v201 offset:2048
    v_mfma_f32_16x16x32_bf16 v[36:39], v[96:99], v[116:119], v[36:39]
    ds_read_b64_tr_b16 v[144:145], v192 offset:8192
    v_mfma_f32_16x16x32_bf16 v[68:71], v[100:103], v[116:119], v[68:71]
    ds_read_b64_tr_b16 v[146:147], v192 offset:9216
    v_mfma_f32_16x16x32_bf16 v[40:43], v[96:99], v[120:123], v[40:43]
    ds_read_b64_tr_b16 v[148:149], v193 offset:8192
    v_mfma_f32_16x16x32_bf16 v[72:75], v[100:103], v[120:123], v[72:75]
    ds_read_b64_tr_b16 v[150:151], v193 offset:9216
    v_mfma_f32_16x16x32_bf16 v[44:47], v[96:99], v[124:127], v[44:47]
    ds_read_b64_tr_b16 v[152:153], v194 offset:8192
    v_mfma_f32_16x16x32_bf16 v[76:79], v[100:103], v[124:127], v[76:79]
    ds_read_b64_tr_b16 v[154:155], v194 offset:9216
    v_mfma_f32_16x16x32_bf16 v[48:51], v[96:99], v[128:131], v[48:51]
    ds_read_b64_tr_b16 v[156:157], v195 offset:8192
    v_mfma_f32_16x16x32_bf16 v[80:83], v[100:103], v[128:131], v[80:83]
    ds_read_b64_tr_b16 v[158:159], v195 offset:9216
    v_mfma_f32_16x16x32_bf16 v[52:55], v[96:99], v[132:135], v[52:55]
    ds_read_b64_tr_b16 v[160:161], v196 offset:8192
    v_mfma_f32_16x16x32_bf16 v[84:87], v[100:103], v[132:135], v[84:87]
    ds_read_b64_tr_b16 v[162:163], v196 offset:9216
    s_waitcnt lgkmcnt(12)
    v_mfma_f32_16x16x32_bf16 v[56:59], v[96:99], v[136:139], v[56:59]
    ds_read_b64_tr_b16 v[164:165], v197 offset:8192
    v_mfma_f32_16x16x32_bf16 v[88:91], v[100:103], v[136:139], v[88:91]
    ds_read_b64_tr_b16 v[166:167], v197 offset:9216
    v_mfma_f32_16x16x32_bf16 v[60:63], v[96:99], v[140:143], v[60:63]
    ds_read_b64_tr_b16 v[168:169], v198 offset:8192
    v_mfma_f32_16x16x32_bf16 v[92:95], v[100:103], v[140:143], v[92:95]
    ds_read_b64_tr_b16 v[170:171], v198 offset:9216
    v_mfma_f32_16x16x32_bf16 v[216:219], v[204:207], v[96:99], v[216:219]
    ds_read_b64_tr_b16 v[172:173], v199 offset:8192
    v_mfma_f32_16x16x32_bf16 v[224:227], v[96:99], v[96:99], v[224:227]
    ds_read_b64_tr_b16 v[174:175], v199 offset:9216
    v_mfma_f32_16x16x32_bf16 v[208:211], v[204:207], v[232:235], v[208:211]
    ds_read_b64_tr_b16 v[240:241], v202 offset:8192
    v_mfma_f32_16x16x32_bf16 v[220:223], v[204:207], v[100:103], v[220:223]
    ds_read_b64_tr_b16 v[242:243], v202 offset:9216
    v_mfma_f32_16x16x32_bf16 v[228:231], v[100:103], v[100:103], v[228:231]
    ds_read_b64_tr_b16 v[244:245], v203 offset:8192
    v_mfma_f32_16x16x32_bf16 v[212:215], v[204:207], v[236:239], v[212:215]
    ds_read_b64_tr_b16 v[246:247], v203 offset:9216
    s_waitcnt lgkmcnt(8)
    v_mfma_f32_16x16x32_bf16 v[32:35], v[104:107], v[144:147], v[32:35]
    v_mfma_f32_16x16x32_bf16 v[64:67], v[108:111], v[144:147], v[64:67]
    v_mfma_f32_16x16x32_bf16 v[36:39], v[104:107], v[148:151], v[36:39]
    v_mfma_f32_16x16x32_bf16 v[68:71], v[108:111], v[148:151], v[68:71]
    s_waitcnt lgkmcnt(0)
    s_barrier
    v_mfma_f32_16x16x32_bf16 v[40:43], v[104:107], v[152:155], v[40:43]
    ds_read_b128 v[96:99], v200 offset:32768
    ds_read_b128 v[100:103], v200 offset:34816
    v_mfma_f32_16x16x32_bf16 v[72:75], v[108:111], v[152:155], v[72:75]
    ds_read_b64_tr_b16 v[112:113], v192 offset:32768
    ds_read_b64_tr_b16 v[114:115], v192 offset:33792
    v_mfma_f32_16x16x32_bf16 v[44:47], v[104:107], v[156:159], v[44:47]
    ds_read_b64_tr_b16 v[116:117], v193 offset:32768
    ds_read_b64_tr_b16 v[118:119], v193 offset:33792
    v_mfma_f32_16x16x32_bf16 v[76:79], v[108:111], v[156:159], v[76:79]
    ds_read_b64_tr_b16 v[120:121], v194 offset:32768
    ds_read_b64_tr_b16 v[122:123], v194 offset:33792
    v_mfma_f32_16x16x32_bf16 v[48:51], v[104:107], v[160:163], v[48:51]
    ds_read_b64_tr_b16 v[124:125], v195 offset:32768
    v_mfma_f32_16x16x32_bf16 v[80:83], v[108:111], v[160:163], v[80:83]
    ds_read_b64_tr_b16 v[126:127], v195 offset:33792
    v_mfma_f32_16x16x32_bf16 v[52:55], v[104:107], v[164:167], v[52:55]
    ds_read_b64_tr_b16 v[128:129], v196 offset:32768
    v_mfma_f32_16x16x32_bf16 v[84:87], v[108:111], v[164:167], v[84:87]
    ds_read_b64_tr_b16 v[130:131], v196 offset:33792
    v_mfma_f32_16x16x32_bf16 v[56:59], v[104:107], v[168:171], v[56:59]
    ds_read_b64_tr_b16 v[132:133], v197 offset:32768
    v_mfma_f32_16x16x32_bf16 v[88:91], v[108:111], v[168:171], v[88:91]
    ds_read_b64_tr_b16 v[134:135], v197 offset:33792
    v_mfma_f32_16x16x32_bf16 v[60:63], v[104:107], v[172:175], v[60:63]
    ds_read_b64_tr_b16 v[136:137], v198 offset:32768
    v_mfma_f32_16x16x32_bf16 v[92:95], v[108:111], v[172:175], v[92:95]
    ds_read_b64_tr_b16 v[138:139], v198 offset:33792
    v_mfma_f32_16x16x32_bf16 v[216:219], v[204:207], v[104:107], v[216:219]
    ds_read_b64_tr_b16 v[140:141], v199 offset:32768
    v_mfma_f32_16x16x32_bf16 v[224:227], v[104:107], v[104:107], v[224:227]
    ds_read_b64_tr_b16 v[142:143], v199 offset:33792
    v_mfma_f32_16x16x32_bf16 v[208:211], v[204:207], v[240:243], v[208:211]
    ds_read_b64_tr_b16 v[232:233], v202 offset:32768
    v_mfma_f32_16x16x32_bf16 v[220:223], v[204:207], v[108:111], v[220:223]
    ds_read_b64_tr_b16 v[234:235], v202 offset:33792
    v_mfma_f32_16x16x32_bf16 v[228:231], v[108:111], v[108:111], v[228:231]
    ds_read_b64_tr_b16 v[236:237], v203 offset:32768
    v_mfma_f32_16x16x32_bf16 v[212:215], v[204:207], v[244:247], v[212:215]
    ds_read_b64_tr_b16 v[238:239], v203 offset:33792
    s_waitcnt lgkmcnt(8)
    v_mfma_f32_16x16x32_bf16 v[32:35], v[96:99], v[112:115], v[32:35]
    ds_read_b128 v[104:107], v201 offset:32768
    v_mfma_f32_16x16x32_bf16 v[64:67], v[100:103], v[112:115], v[64:67]
    ds_read_b128 v[108:111], v201 offset:34816
    v_mfma_f32_16x16x32_bf16 v[36:39], v[96:99], v[116:119], v[36:39]
    ds_read_b64_tr_b16 v[144:145], v192 offset:40960
    v_mfma_f32_16x16x32_bf16 v[68:71], v[100:103], v[116:119], v[68:71]
    ds_read_b64_tr_b16 v[146:147], v192 offset:41984
    v_mfma_f32_16x16x32_bf16 v[40:43], v[96:99], v[120:123], v[40:43]
    ds_read_b64_tr_b16 v[148:149], v193 offset:40960
    v_mfma_f32_16x16x32_bf16 v[72:75], v[100:103], v[120:123], v[72:75]
    ds_read_b64_tr_b16 v[150:151], v193 offset:41984
    v_mfma_f32_16x16x32_bf16 v[44:47], v[96:99], v[124:127], v[44:47]
    ds_read_b64_tr_b16 v[152:153], v194 offset:40960
    v_mfma_f32_16x16x32_bf16 v[76:79], v[100:103], v[124:127], v[76:79]
    ds_read_b64_tr_b16 v[154:155], v194 offset:41984
    v_mfma_f32_16x16x32_bf16 v[48:51], v[96:99], v[128:131], v[48:51]
    ds_read_b64_tr_b16 v[156:157], v195 offset:40960
    v_mfma_f32_16x16x32_bf16 v[80:83], v[100:103], v[128:131], v[80:83]
    ds_read_b64_tr_b16 v[158:159], v195 offset:41984
    v_mfma_f32_16x16x32_bf16 v[52:55], v[96:99], v[132:135], v[52:55]
    ds_read_b64_tr_b16 v[160:161], v196 offset:40960
    v_mfma_f32_16x16x32_bf16 v[84:87], v[100:103], v[132:135], v[84:87]
    ds_read_b64_tr_b16 v[162:163], v196 offset:41984
    s_waitcnt lgkmcnt(12)
    v_mfma_f32_16x16x32_bf16 v[56:59], v[96:99], v[136:139], v[56:59]
    ds_read_b64_tr_b16 v[164:165], v197 offset:40960
    v_mfma_f32_16x16x32_bf16 v[88:91], v[100:103], v[136:139], v[88:91]
    ds_read_b64_tr_b16 v[166:167], v197 offset:41984
    v_mfma_f32_16x16x32_bf16 v[60:63], v[96:99], v[140:143], v[60:63]
    ds_read_b64_tr_b16 v[168:169], v198 offset:40960
    v_mfma_f32_16x16x32_bf16 v[92:95], v[100:103], v[140:143], v[92:95]
    ds_read_b64_tr_b16 v[170:171], v198 offset:41984
    v_mfma_f32_16x16x32_bf16 v[216:219], v[204:207], v[96:99], v[216:219]
    ds_read_b64_tr_b16 v[172:173], v199 offset:40960
    v_mfma_f32_16x16x32_bf16 v[224:227], v[96:99], v[96:99], v[224:227]
    ds_read_b64_tr_b16 v[174:175], v199 offset:41984
    v_mfma_f32_16x16x32_bf16 v[208:211], v[204:207], v[232:235], v[208:211]
    ds_read_b64_tr_b16 v[240:241], v202 offset:40960
    v_mfma_f32_16x16x32_bf16 v[220:223], v[204:207], v[100:103], v[220:223]
    ds_read_b64_tr_b16 v[242:243], v202 offset:41984
    v_mfma_f32_16x16x32_bf16 v[228:231], v[100:103], v[100:103], v[228:231]
    ds_read_b64_tr_b16 v[244:245], v203 offset:40960
    v_mfma_f32_16x16x32_bf16 v[212:215], v[204:207], v[236:239], v[212:215]
    ds_read_b64_tr_b16 v[246:247], v203 offset:41984
    v_xor_b32 v192, 0x10000, v192
    v_xor_b32 v193, 0x10000, v193
    v_xor_b32 v194, 0x10000, v194
    v_xor_b32 v195, 0x10000, v195
    v_xor_b32 v196, 0x10000, v196
    v_xor_b32 v197, 0x10000, v197
    v_xor_b32 v198, 0x10000, v198
    v_xor_b32 v199, 0x10000, v199
    v_xor_b32 v200, 0x10000, v200
    v_xor_b32 v201, 0x10000, v201
    v_xor_b32 v202, 0x10000, v202
    v_xor_b32 v203, 0x10000, v203
    s_sub_u32 s36, s36, 1
    s_cmp_lg_u32 s36, 0
    s_waitcnt lgkmcnt(8)
    v_mfma_f32_16x16x32_bf16 v[32:35], v[104:107], v[144:147], v[32:35]
    v_mfma_f32_16x16x32_bf16 v[64:67], v[108:111], v[144:147], v[64:67]
    v_mfma_f32_16x16x32_bf16 v[36:39], v[104:107], v[148:151], v[36:39]
    v_mfma_f32_16x16x32_bf16 v[68:71], v[108:111], v[148:151], v[68:71]
    s_waitcnt lgkmcnt(0)
    s_barrier
    v_mfma_f32_16x16x32_bf16 v[40:43], v[104:107], v[152:155], v[40:43]
    ds_read_b128 v[96:99], v200 offset:0
    ds_read_b128 v[100:103], v200 offset:2048
    v_mfma_f32_16x16x32_bf16 v[72:75], v[108:111], v[152:155], v[72:75]
    ds_read_b64_tr_b16 v[112:113], v192 offset:0
    ds_read_b64_tr_b16 v[114:115], v192 offset:1024
    v_mfma_f32_16x16x32_bf16 v[44:47], v[104:107], v[156:159], v[44:47]
    ds_read_b64_tr_b16 v[116:117], v193 offset:0
    ds_read_b64_tr_b16 v[118:119], v193 offset:1024
    v_mfma_f32_16x16x32_bf16 v[76:79], v[108:111], v[156:159], v[76:79]
    ds_read_b64_tr_b16 v[120:121], v194 offset:0
    ds_read_b64_tr_b16 v[122:123], v194 offset:1024
    v_mfma_f32_16x16x32_bf16 v[48:51], v[104:107], v[160:163], v[48:51]
    ds_read_b64_tr_b16 v[124:125], v195 offset:0
    v_mfma_f32_16x16x32_bf16 v[80:83], v[108:111], v[160:163], v[80:83]
    ds_read_b64_tr_b16 v[126:127], v195 offset:1024
    v_mfma_f32_16x16x32_bf16 v[52:55], v[104:107], v[164:167], v[52:55]
    ds_read_b64_tr_b16 v[128:129], v196 offset:0
    v_mfma_f32_16x16x32_bf16 v[84:87], v[108:111], v[164:167], v[84:87]
    ds_read_b64_tr_b16 v[130:131], v196 offset:1024
    v_mfma_f32_16x16x32_bf16 v[56:59], v[104:107], v[168:171], v[56:59]
    ds_read_b64_tr_b16 v[132:133], v197 offset:0
    v_mfma_f32_16x16x32_bf16 v[88:91], v[108:111], v[168:171], v[88:91]
    ds_read_b64_tr_b16 v[134:135], v197 offset:1024
    v_mfma_f32_16x16x32_bf16 v[60:63], v[104:107], v[172:175], v[60:63]
    ds_read_b64_tr_b16 v[136:137], v198 offset:0
    v_mfma_f32_16x16x32_bf16 v[92:95], v[108:111], v[172:175], v[92:95]
    ds_read_b64_tr_b16 v[138:139], v198 offset:1024
    v_mfma_f32_16x16x32_bf16 v[216:219], v[204:207], v[104:107], v[216:219]
    ds_read_b64_tr_b16 v[140:141], v199 offset:0
    v_mfma_f32_16x16x32_bf16 v[224:227], v[104:107], v[104:107], v[224:227]
    ds_read_b64_tr_b16 v[142:143], v199 offset:1024
    v_mfma_f32_16x16x32_bf16 v[208:211], v[204:207], v[240:243], v[208:211]
    ds_read_b64_tr_b16 v[232:233], v202 offset:0
    v_mfma_f32_16x16x32_bf16 v[220:223], v[204:207], v[108:111], v[220:223]
    ds_read_b64_tr_b16 v[234:235], v202 offset:1024
    v_mfma_f32_16x16x32_bf16 v[228:231], v[108:111], v[108:111], v[228:231]
    ds_read_b64_tr_b16 v[236:237], v203 offset:0
    v_mfma_f32_16x16x32_bf16 v[212:215], v[204:207], v[244:247], v[212:215]
    ds_read_b64_tr_b16 v[238:239], v203 offset:1024
    s_cbranch_scc1 L_mega_37
    s_waitcnt lgkmcnt(8)
    v_mfma_f32_16x16x32_bf16 v[32:35], v[96:99], v[112:115], v[32:35]
    ds_read_b128 v[104:107], v201 offset:0
    v_mfma_f32_16x16x32_bf16 v[64:67], v[100:103], v[112:115], v[64:67]
    ds_read_b128 v[108:111], v201 offset:2048
    v_mfma_f32_16x16x32_bf16 v[36:39], v[96:99], v[116:119], v[36:39]
    ds_read_b64_tr_b16 v[144:145], v192 offset:8192
    v_mfma_f32_16x16x32_bf16 v[68:71], v[100:103], v[116:119], v[68:71]
    ds_read_b64_tr_b16 v[146:147], v192 offset:9216
    v_mfma_f32_16x16x32_bf16 v[40:43], v[96:99], v[120:123], v[40:43]
    ds_read_b64_tr_b16 v[148:149], v193 offset:8192
    v_mfma_f32_16x16x32_bf16 v[72:75], v[100:103], v[120:123], v[72:75]
    ds_read_b64_tr_b16 v[150:151], v193 offset:9216
    v_mfma_f32_16x16x32_bf16 v[44:47], v[96:99], v[124:127], v[44:47]
    ds_read_b64_tr_b16 v[152:153], v194 offset:8192
    v_mfma_f32_16x16x32_bf16 v[76:79], v[100:103], v[124:127], v[76:79]
    ds_read_b64_tr_b16 v[154:155], v194 offset:9216
    v_mfma_f32_16x16x32_bf16 v[48:51], v[96:99], v[128:131], v[48:51]
    ds_read_b64_tr_b16 v[156:157], v195 offset:8192
    v_mfma_f32_16x16x32_bf16 v[80:83], v[100:103], v[128:131], v[80:83]
    ds_read_b64_tr_b16 v[158:159], v195 offset:9216
    v_mfma_f32_16x16x32_bf16 v[52:55], v[96:99], v[132:135], v[52:55]
    ds_read_b64_tr_b16 v[160:161], v196 offset:8192
    v_mfma_f32_16x16x32_bf16 v[84:87], v[100:103], v[132:135], v[84:87]
    ds_read_b64_tr_b16 v[162:163], v196 offset:9216
    s_waitcnt lgkmcnt(12)
    v_mfma_f32_16x16x32_bf16 v[56:59], v[96:99], v[136:139], v[56:59]
    ds_read_b64_tr_b16 v[164:165], v197 offset:8192
    v_mfma_f32_16x16x32_bf16 v[88:91], v[100:103], v[136:139], v[88:91]
    ds_read_b64_tr_b16 v[166:167], v197 offset:9216
    v_mfma_f32_16x16x32_bf16 v[60:63], v[96:99], v[140:143], v[60:63]
    ds_read_b64_tr_b16 v[168:169], v198 offset:8192
    v_mfma_f32_16x16x32_bf16 v[92:95], v[100:103], v[140:143], v[92:95]
    ds_read_b64_tr_b16 v[170:171], v198 offset:9216
    v_mfma_f32_16x16x32_bf16 v[216:219], v[204:207], v[96:99], v[216:219]
    ds_read_b64_tr_b16 v[172:173], v199 offset:8192
    v_mfma_f32_16x16x32_bf16 v[224:227], v[96:99], v[96:99], v[224:227]
    ds_read_b64_tr_b16 v[174:175], v199 offset:9216
    v_mfma_f32_16x16x32_bf16 v[208:211], v[204:207], v[232:235], v[208:211]
    ds_read_b64_tr_b16 v[240:241], v202 offset:8192
    v_mfma_f32_16x16x32_bf16 v[220:223], v[204:207], v[100:103], v[220:223]
    ds_read_b64_tr_b16 v[242:243], v202 offset:9216
    v_mfma_f32_16x16x32_bf16 v[228:231], v[100:103], v[100:103], v[228:231]
    ds_read_b64_tr_b16 v[244:245], v203 offset:8192
    v_mfma_f32_16x16x32_bf16 v[212:215], v[204:207], v[236:239], v[212:215]
    ds_read_b64_tr_b16 v[246:247], v203 offset:9216
    s_waitcnt lgkmcnt(8)
    v_mfma_f32_16x16x32_bf16 v[32:35], v[104:107], v[144:147], v[32:35]
    v_mfma_f32_16x16x32_bf16 v[64:67], v[108:111], v[144:147], v[64:67]
    v_mfma_f32_16x16x32_bf16 v[36:39], v[104:107], v[148:151], v[36:39]
    v_mfma_f32_16x16x32_bf16 v[68:71], v[108:111], v[148:151], v[68:71]
    s_waitcnt lgkmcnt(0)
    s_barrier
    v_mfma_f32_16x16x32_bf16 v[40:43], v[104:107], v[152:155], v[40:43]
    ds_read_b128 v[96:99], v200 offset:32768
    ds_read_b128 v[100:103], v200 offset:34816
    v_mfma_f32_16x16x32_bf16 v[72:75], v[108:111], v[152:155], v[72:75]
    ds_read_b64_tr_b16 v[112:113], v192 offset:32768
    ds_read_b64_tr_b16 v[114:115], v192 offset:33792
    v_mfma_f32_16x16x32_bf16 v[44:47], v[104:107], v[156:159], v[44:47]
    ds_read_b64_tr_b16 v[116:117], v193 offset:32768
    ds_read_b64_tr_b16 v[118:119], v193 offset:33792
    v_mfma_f32_16x16x32_bf16 v[76:79], v[108:111], v[156:159], v[76:79]
    ds_read_b64_tr_b16 v[120:121], v194 offset:32768
    ds_read_b64_tr_b16 v[122:123], v194 offset:33792
    v_mfma_f32_16x16x32_bf16 v[48:51], v[104:107], v[160:163], v[48:51]
    ds_read_b64_tr_b16 v[124:125], v195 offset:32768
    v_mfma_f32_16x16x32_bf16 v[80:83], v[108:111], v[160:163], v[80:83]
    ds_read_b64_tr_b16 v[126:127], v195 offset:33792
    v_mfma_f32_16x16x32_bf16 v[52:55], v[104:107], v[164:167], v[52:55]
    ds_read_b64_tr_b16 v[128:129], v196 offset:32768
    v_mfma_f32_16x16x32_bf16 v[84:87], v[108:111], v[164:167], v[84:87]
    ds_read_b64_tr_b16 v[130:131], v196 offset:33792
    v_mfma_f32_16x16x32_bf16 v[56:59], v[104:107], v[168:171], v[56:59]
    ds_read_b64_tr_b16 v[132:133], v197 offset:32768
    v_mfma_f32_16x16x32_bf16 v[88:91], v[108:111], v[168:171], v[88:91]
    ds_read_b64_tr_b16 v[134:135], v197 offset:33792
    v_mfma_f32_16x16x32_bf16 v[60:63], v[104:107], v[172:175], v[60:63]
    ds_read_b64_tr_b16 v[136:137], v198 offset:32768
    v_mfma_f32_16x16x32_bf16 v[92:95], v[108:111], v[172:175], v[92:95]
    ds_read_b64_tr_b16 v[138:139], v198 offset:33792
    v_mfma_f32_16x16x32_bf16 v[216:219], v[204:207], v[104:107], v[216:219]
    ds_read_b64_tr_b16 v[140:141], v199 offset:32768
    v_mfma_f32_16x16x32_bf16 v[224:227], v[104:107], v[104:107], v[224:227]
    ds_read_b64_tr_b16 v[142:143], v199 offset:33792
    v_mfma_f32_16x16x32_bf16 v[208:211], v[204:207], v[240:243], v[208:211]
    ds_read_b64_tr_b16 v[232:233], v202 offset:32768
    v_mfma_f32_16x16x32_bf16 v[220:223], v[204:207], v[108:111], v[220:223]
    ds_read_b64_tr_b16 v[234:235], v202 offset:33792
    v_mfma_f32_16x16x32_bf16 v[228:231], v[108:111], v[108:111], v[228:231]
    ds_read_b64_tr_b16 v[236:237], v203 offset:32768
    v_mfma_f32_16x16x32_bf16 v[212:215], v[204:207], v[244:247], v[212:215]
    ds_read_b64_tr_b16 v[238:239], v203 offset:33792
    s_waitcnt lgkmcnt(8)
    v_mfma_f32_16x16x32_bf16 v[32:35], v[96:99], v[112:115], v[32:35]
    ds_read_b128 v[104:107], v201 offset:32768
    v_mfma_f32_16x16x32_bf16 v[64:67], v[100:103], v[112:115], v[64:67]
    ds_read_b128 v[108:111], v201 offset:34816
    v_mfma_f32_16x16x32_bf16 v[36:39], v[96:99], v[116:119], v[36:39]
    ds_read_b64_tr_b16 v[144:145], v192 offset:40960
    v_mfma_f32_16x16x32_bf16 v[68:71], v[100:103], v[116:119], v[68:71]
    ds_read_b64_tr_b16 v[146:147], v192 offset:41984
    v_mfma_f32_16x16x32_bf16 v[40:43], v[96:99], v[120:123], v[40:43]
    ds_read_b64_tr_b16 v[148:149], v193 offset:40960
    v_mfma_f32_16x16x32_bf16 v[72:75], v[100:103], v[120:123], v[72:75]
    ds_read_b64_tr_b16 v[150:151], v193 offset:41984
    v_mfma_f32_16x16x32_bf16 v[44:47], v[96:99], v[124:127], v[44:47]
    ds_read_b64_tr_b16 v[152:153], v194 offset:40960
    v_mfma_f32_16x16x32_bf16 v[76:79], v[100:103], v[124:127], v[76:79]
    ds_read_b64_tr_b16 v[154:155], v194 offset:41984
    v_mfma_f32_16x16x32_bf16 v[48:51], v[96:99], v[128:131], v[48:51]
    ds_read_b64_tr_b16 v[156:157], v195 offset:40960
    v_mfma_f32_16x16x32_bf16 v[80:83], v[100:103], v[128:131], v[80:83]
    ds_read_b64_tr_b16 v[158:159], v195 offset:41984
    v_mfma_f32_16x16x32_bf16 v[52:55], v[96:99], v[132:135], v[52:55]
    ds_read_b64_tr_b16 v[160:161], v196 offset:40960
    v_mfma_f32_16x16x32_bf16 v[84:87], v[100:103], v[132:135], v[84:87]
    ds_read_b64_tr_b16 v[162:163], v196 offset:41984
    s_waitcnt lgkmcnt(12)
    v_mfma_f32_16x16x32_bf16 v[56:59], v[96:99], v[136:139], v[56:59]
    ds_read_b64_tr_b16 v[164:165], v197 offset:40960
    v_mfma_f32_16x16x32_bf16 v[88:91], v[100:103], v[136:139], v[88:91]
    ds_read_b64_tr_b16 v[166:167], v197 offset:41984
    v_mfma_f32_16x16x32_bf16 v[60:63], v[96:99], v[140:143], v[60:63]
    ds_read_b64_tr_b16 v[168:169], v198 offset:40960
    v_mfma_f32_16x16x32_bf16 v[92:95], v[100:103], v[140:143], v[92:95]
    ds_read_b64_tr_b16 v[170:171], v198 offset:41984
    v_mfma_f32_16x16x32_bf16 v[216:219], v[204:207], v[96:99], v[216:219]
    ds_read_b64_tr_b16 v[172:173], v199 offset:40960
    v_mfma_f32_16x16x32_bf16 v[224:227], v[96:99], v[96:99], v[224:227]
    ds_read_b64_tr_b16 v[174:175], v199 offset:41984
    v_mfma_f32_16x16x32_bf16 v[208:211], v[204:207], v[232:235], v[208:211]
    ds_read_b64_tr_b16 v[240:241], v202 offset:40960
    v_mfma_f32_16x16x32_bf16 v[220:223], v[204:207], v[100:103], v[220:223]
    ds_read_b64_tr_b16 v[242:243], v202 offset:41984
    v_mfma_f32_16x16x32_bf16 v[228:231], v[100:103], v[100:103], v[228:231]
    ds_read_b64_tr_b16 v[244:245], v203 offset:40960
    v_mfma_f32_16x16x32_bf16 v[212:215], v[204:207], v[236:239], v[212:215]
    ds_read_b64_tr_b16 v[246:247], v203 offset:41984
    s_waitcnt lgkmcnt(8)
    v_mfma_f32_16x16x32_bf16 v[32:35], v[104:107], v[144:147], v[32:35]
    v_mfma_f32_16x16x32_bf16 v[64:67], v[108:111], v[144:147], v[64:67]
    v_mfma_f32_16x16x32_bf16 v[36:39], v[104:107], v[148:151], v[36:39]
    v_mfma_f32_16x16x32_bf16 v[68:71], v[108:111], v[148:151], v[68:71]
    v_mfma_f32_16x16x32_bf16 v[40:43], v[104:107], v[152:155], v[40:43]
    v_mfma_f32_16x16x32_bf16 v[72:75], v[108:111], v[152:155], v[72:75]
    v_mfma_f32_16x16x32_bf16 v[44:47], v[104:107], v[156:159], v[44:47]
    v_mfma_f32_16x16x32_bf16 v[76:79], v[108:111], v[156:159], v[76:79]
    v_mfma_f32_16x16x32_bf16 v[48:51], v[104:107], v[160:163], v[48:51]
    v_mfma_f32_16x16x32_bf16 v[80:83], v[108:111], v[160:163], v[80:83]
    v_mfma_f32_16x16x32_bf16 v[52:55], v[104:107], v[164:167], v[52:55]
    v_mfma_f32_16x16x32_bf16 v[84:87], v[108:111], v[164:167], v[84:87]
    s_waitcnt lgkmcnt(0)
    v_mfma_f32_16x16x32_bf16 v[56:59], v[104:107], v[168:171], v[56:59]
    v_mfma_f32_16x16x32_bf16 v[88:91], v[108:111], v[168:171], v[88:91]
    v_mfma_f32_16x16x32_bf16 v[60:63], v[104:107], v[172:175], v[60:63]
    v_mfma_f32_16x16x32_bf16 v[92:95], v[108:111], v[172:175], v[92:95]
    v_mfma_f32_16x16x32_bf16 v[216:219], v[204:207], v[104:107], v[216:219]
    v_mfma_f32_16x16x32_bf16 v[224:227], v[104:107], v[104:107], v[224:227]
    v_mfma_f32_16x16x32_bf16 v[208:211], v[204:207], v[240:243], v[208:211]
    v_mfma_f32_16x16x32_bf16 v[220:223], v[204:207], v[108:111], v[220:223]
    v_mfma_f32_16x16x32_bf16 v[228:231], v[108:111], v[108:111], v[228:231]
    v_mfma_f32_16x16x32_bf16 v[212:215], v[204:207], v[244:247], v[212:215]
    s_lshl_b32 s28, s12, 10
    s_add_u32 s28, s28, 143360
    v_lshl_add_u32 v4, v1, 3, s28
    v_mov_b32 v5, 0x23000
    v_lshl_add_u32 v5, v1, 3, v5
    v_lshrrev_b32 v6, 2, v7
    v_and_b32 v27, 3, v7
    v_cmp_eq_u32 s[56:57], v6, v8
    v_cmp_eq_u32 s[58:59], 0, v8
    s_nop 1
    v_cndmask_b32 v208, 0, v208, s[58:59]
    v_cvt_pk_bf16_f32 v209, v208, v208
    v_and_b32 v209, 0xffff0000, v209
    v_sub_f32 v209, v208, v209
    v_cvt_pk_bf16_f32 v210, v208, v209
    v_cvt_pk_bf16_f32 v211, v208, v209
    ds_write_b64 v4, v[210:211] offset:0
    v_cndmask_b32 v212, 0, v212, s[58:59]
    v_cvt_pk_bf16_f32 v213, v212, v212
    v_and_b32 v213, 0xffff0000, v213
    v_sub_f32 v213, v212, v213
    v_cvt_pk_bf16_f32 v214, v212, v213
    v_cvt_pk_bf16_f32 v215, v212, v213
    ds_write_b64 v4, v[214:215] offset:512
    v_cmp_eq_u32 vcc, 1, v27
    s_nop 1
    v_cndmask_b32 v224, v224, v225, vcc
    v_cmp_eq_u32 vcc, 2, v27
    s_nop 1
    v_cndmask_b32 v224, v224, v226, vcc
    v_cmp_eq_u32 vcc, 3, v27
    s_nop 1
    v_cndmask_b32 v224, v224, v227, vcc
    v_cndmask_b32 v248, 0, v216, s[58:59]
    v_cndmask_b32 v249, 0, v224, s[56:57]
    v_mov_b64 v[250:251], 0
    v_cmp_eq_u32 vcc, 1, v27
    s_nop 1
    v_cndmask_b32 v228, v228, v229, vcc
    v_cmp_eq_u32 vcc, 2, v27
    s_nop 1
    v_cndmask_b32 v228, v228, v230, vcc
    v_cmp_eq_u32 vcc, 3, v27
    s_nop 1
    v_cndmask_b32 v228, v228, v231, vcc
    v_cndmask_b32 v252, 0, v220, s[58:59]
    v_cndmask_b32 v253, 0, v228, s[56:57]
    v_mov_b64 v[254:255], 0
    s_waitcnt lgkmcnt(0)
    s_barrier
    ds_read_b64 v[216:217], v5 offset:0
    ds_read_b64 v[218:219], v5 offset:512
    ds_read_b64 v[220:221], v5 offset:1024
    ds_read_b64 v[222:223], v5 offset:1536
    ds_read_b64 v[224:225], v5 offset:2048
    ds_read_b64 v[226:227], v5 offset:2560
    ds_read_b64 v[228:229], v5 offset:3072
    ds_read_b64 v[230:231], v5 offset:3584
    v_lshlrev_b32 v198, 5, v1
    s_cmp_lg_u32 s12, 3
    s_cbranch_scc1 L_mega_38
    s_mov_b64 exec, 0xff
    buffer_load_dword v199, v198, s[76:79], 0 offen sc1
    s_mov_b64 exec, -1
L_mega_38:
    v_add_f32 v248, v248, v250
    v_add_f32 v249, v249, v251
    v_add_f32 v252, v252, v254
    v_add_f32 v253, v253, v255
    v_mov_b32 v250, v248
    v_mov_b32 v251, v249
    v_mov_b32 v254, v252
    v_mov_b32 v255, v253
    s_nop 1
    v_permlane32_swap_b32 v248, v250
    v_permlane32_swap_b32 v249, v251
    v_permlane32_swap_b32 v252, v254
    v_permlane32_swap_b32 v253, v255
    s_nop 0
    v_add_f32 v248, v248, v250
    v_add_f32 v249, v249, v251
    v_add_f32 v252, v252, v254
    v_add_f32 v253, v253, v255
    v_mov_b32 v250, v248
    v_mov_b32 v251, v249
    v_mov_b32 v254, v252
    v_mov_b32 v255, v253
    s_nop 1
    v_permlane16_swap_b32 v248, v250
    v_permlane16_swap_b32 v249, v251
    v_permlane16_swap_b32 v252, v254
    v_permlane16_swap_b32 v253, v255
    s_nop 0
    v_add_f32 v248, v248, v250
    v_add_f32 v249, v249, v251
    v_add_f32 v252, v252, v254
    v_add_f32 v253, v253, v255
    v_mul_f32 v248, 0xbacccccd, v248
    v_mul_f32 v249, 0x3acccccd, v249
    v_cvt_pk_bf16_f32 v250, v248, v248
    v_fma_f32 v249, -v248, v248, v249
    v_and_b32 v251, 0xffff0000, v250
    v_max_f32 v249, 0, v249
    v_sub_f32 v251, v248, v251
    v_add_f32 v249, 0x3727c5ac, v249
    v_cvt_pk_bf16_f32 v251, v251, v251
    v_rsq_f32 v10, v249
    v_mul_f32 v252, 0xbacccccd, v252
    v_mul_f32 v253, 0x3acccccd, v253
    v_cvt_pk_bf16_f32 v254, v252, v252
    v_fma_f32 v253, -v252, v252, v253
    v_and_b32 v255, 0xffff0000, v254
    v_max_f32 v253, 0, v253
    v_sub_f32 v255, v252, v255
    v_add_f32 v253, 0x3727c5ac, v253
    v_cvt_pk_bf16_f32 v255, v255, v255
    v_rsq_f32 v11, v253
    s_nop 0
    ds_write_b32 v12, v10
    ds_write_b32 v12, v11 offset:64
    s_waitcnt lgkmcnt(0)
    s_branch L_join_v
L_mega_last:
    s_endpgm
.section .rodata,"a"
.p2align 6
.amdhsa_kernel mega_kernel
  .amdhsa_next_free_vgpr 256
  .amdhsa_next_free_sgpr 102
  .amdhsa_accum_offset 256
  .amdhsa_group_segment_fixed_size 0
  .amdhsa_kernarg_size 80
  .amdhsa_user_sgpr_count 2
  .amdhsa_user_sgpr_kernarg_segment_ptr 1
  .amdhsa_system_sgpr_workgroup_id_x 1
.end_amdhsa_kernel
```
